```python
import torch

def _softmax(x, axis=-1):
    return torch.softmax(x, dim=axis)

def _gelu(x):
    return torch.nn.functional.gelu(x, approximate='tanh')

def _silu(x):
    return torch.nn.functional.silu(x)

def _sigmoid(x):
    return torch.sigmoid(x)

def _layernorm(x, axis=-1, eps=1e-05):
    m = x.mean(dim=axis, keepdim=True)
    v = x.var(dim=axis, keepdim=True, unbiased=False)
    return (x - m) / torch.sqrt(v + eps)

def _scatter_add(tgt, idx, src, axis=0):
    return tgt.clone().index_add_(axis, idx, src)

def _segment_sum(src, seg, n):
    out = torch.zeros((n,) + src.shape[1:], dtype=src.dtype)
    return out.index_add_(0, seg, src)

def _pad(x, pw):
    flat = tuple((v for pair in reversed(pw) for v in pair))
    return torch.nn.functional.pad(x, flat)
kernel_name = 'adaLN_cond__sliding_block_cached__glu_gated_geglu__prompt'

def setup_inputs():

    _w = lambda a: (lambda t: t.to(torch.bfloat16) if t.is_floating_point() else t)(torch.as_tensor(a))

    def _A_setup():
        B, Sq, D = (1, 2048, 576)
        Hq, Hkv, Sk, Dh = (32, 16, 2048, 128)
        assert Hq % Hkv == 0, (Hq, Hkv)
        return {'x': _w((lambda *s: torch.randn(*s, dtype=torch.bfloat16) * 0.05)(B, Sq, D)), 'k_cache': _w((lambda *s: torch.randn(*s, dtype=torch.bfloat16) * 1.6)(B, Hkv, Sk, Dh)), 'v_cache': _w((lambda *s: torch.randn(*s, dtype=torch.bfloat16) * 0.8)(B, Hkv, Sk, Dh)), 'wq': _w((lambda *s: torch.randn(*s, dtype=torch.bfloat16) * 1.6)(D, Hq * Dh) * D ** (-0.5)), 'wo': _w((lambda *s: torch.randn(*s, dtype=torch.bfloat16) * 0.8)(Hq * Dh, D) * (Hq * Dh) ** (-0.5))}
    _A_in = _A_setup()

    def _B_setup():
        B, S, Dm, Df = (1, 2048, 576, 4608)
        return {'x': _w((lambda *s: torch.randn(*s, dtype=torch.bfloat16) * 0.05)(B, S, Dm)), 'w_gate': _w((lambda *s: torch.randn(*s, dtype=torch.bfloat16) * 0.8)(Dm, Df) * Dm ** (-0.5)), 'w_up': _w((lambda *s: torch.randn(*s, dtype=torch.bfloat16) * 0.8)(Dm, Df) * Dm ** (-0.5)), 'w_down': _w((lambda *s: torch.randn(*s, dtype=torch.bfloat16) * 0.8)(Df, Dm) * Df ** (-0.5))}
    _B_in = _B_setup()
    return {'A_x': _A_in['x'], 'A_k_cache': _A_in['k_cache'], 'A_v_cache': _A_in['v_cache'], 'A_wq': _A_in['wq'], 'A_wo': _A_in['wo'], 'B_x': _B_in['x'], 'B_w_gate': _B_in['w_gate'], 'B_w_up': _B_in['w_up'], 'B_w_down': _B_in['w_down'], 'c': _w((lambda *s: torch.randn(*s, dtype=torch.bfloat16) * 0.1)(1, 576) * 8.0), 'w_mod': _w((lambda *s: torch.randn(*s, dtype=torch.bfloat16) * 0.1)(576, 6 * 576) * 576 ** (-0.5) * 8.0)}

def reference(A_x, A_k_cache, A_v_cache, A_wq, A_wo, B_x, B_w_gate, B_w_up, B_w_down, c, w_mod):

    def _A_ref(x, k_cache, v_cache, wq, wo):
        B, Sq, D = x.shape
        Hq, Dh = (32, 128)
        Hkv, Sk = (k_cache.shape[1], k_cache.shape[2])
        W = min(4096, max(256, Sk // 4))
        rep = Hq // Hkv
        q = (lambda x, *d: x.permute(*d))((x @ wq).reshape(B, Sq, Hq, Dh), 0, 2, 1, 3)
        k = (lambda x, n, axis: torch.repeat_interleave(x, n, dim=axis))(k_cache[:, :, Sk - W:, :], rep, axis=1)
        v = (lambda x, n, axis: torch.repeat_interleave(x, n, dim=axis))(v_cache[:, :, Sk - W:, :], rep, axis=1)
        scores = torch.einsum('bhqd,bhkd->bhqk', q, k) * Dh ** (-0.5)
        p = _softmax(scores, axis=-1)
        o = torch.einsum('bhqk,bhkd->bhqd', p, v)
        return (lambda x, *d: x.permute(*d))(o, 0, 2, 1, 3).reshape(B, Sq, Hq * Dh) @ wo

    def _B_ref(x, w_gate, w_up, w_down):
        g = torch.einsum('bsd,df->bsf', x, w_gate)
        u = torch.einsum('bsd,df->bsf', x, w_up)
        h = _gelu(g) * u
        return torch.einsum('bsf,fd->bsd', h, w_down)
    x = A_x
    mod = (_silu(c) @ w_mod).reshape(c.shape[0], 6, 1, -1)
    sa, ca, ga, sb, cb, gb = (mod[:, 0].clone(), mod[:, 1].clone(), mod[:, 2].clone(), mod[:, 3].clone(), mod[:, 4].clone(), mod[:, 5].clone())
    h = _layernorm(x, axis=-1) * (1 + ca) + sa
    x = x + ga * _A_ref(h, A_k_cache, A_v_cache, A_wq, A_wo)
    h = _layernorm(x, axis=-1) * (1 + cb) + sb
    x = x + gb * _B_ref(h, B_w_gate, B_w_up, B_w_down)
    return x
```

```asm
; @launch kernel=k1_kernel grid=(312,1,1) block=(576,1,1) lds=20736
; @launch kernel=k2_kernel grid=(256,1,1) block=(512,1,1) lds=163840
.amdgcn_target "amdgcn-amd-amdhsa--gfx950"
.text
.globl k1_kernel
.p2align 8
.type k1_kernel,@function
k1_kernel:
  s_cmp_lt_u32 s2, 54
  s_cbranch_scc0 k1_ln1
  s_load_dwordx2 s[4:5], s[0:1], 72
  s_mov_b32 s6, 1152
  s_mov_b32 s7, 0x00020000
  s_load_dwordx2 s[8:9], s[0:1], 80
  s_mov_b32 s10, 3981312
  s_mov_b32 s11, 0x00020000
  s_load_dwordx2 s[12:13], s[0:1], 104
  s_mov_b32 s14, 134217728
  s_mov_b32 s15, 0x00020000
  s_load_dwordx2 s[20:21], s[0:1], 96
  s_mov_b32 s22, 256
  s_mov_b32 s23, 0x00020000
  v_lshrrev_b32 v1, 3, v0
  v_and_b32 v2, 7, v0
  v_lshlrev_b32 v3, 4, v1
  s_mov_b32 s16, 55296
  v_mul_lo_u32 v4, v1, s16
  v_lshl_add_u32 v4, v2, 4, v4
  s_lshl_b32 s17, s2, 7
  s_waitcnt lgkmcnt(0)
  buffer_load_dwordx4 v[8:11], v3, s[4:7], 0 offen
  buffer_load_dwordx4 v[16:19], v4, s[8:11], s17 offen
  s_add_u32 s17, s17, 6912
  buffer_load_dwordx4 v[20:23], v4, s[8:11], s17 offen
  s_add_u32 s17, s17, 6912
  buffer_load_dwordx4 v[24:27], v4, s[8:11], s17 offen
  s_add_u32 s17, s17, 6912
  buffer_load_dwordx4 v[28:31], v4, s[8:11], s17 offen
  s_add_u32 s17, s17, 6912
  buffer_load_dwordx4 v[32:35], v4, s[8:11], s17 offen
  s_add_u32 s17, s17, 6912
  buffer_load_dwordx4 v[36:39], v4, s[8:11], s17 offen
  s_add_u32 s17, s17, 6912
  buffer_load_dwordx4 v[40:43], v4, s[8:11], s17 offen
  s_add_u32 s17, s17, 6912
  buffer_load_dwordx4 v[44:47], v4, s[8:11], s17 offen
  s_add_u32 s17, s17, 6912
  s_waitcnt vmcnt(8)
  v_lshlrev_b32 v48, 16, v8
  v_and_b32 v49, 0xffff0000, v8
  v_lshlrev_b32 v50, 16, v9
  v_and_b32 v51, 0xffff0000, v9
  v_lshlrev_b32 v52, 16, v10
  v_and_b32 v53, 0xffff0000, v10
  v_lshlrev_b32 v54, 16, v11
  v_and_b32 v55, 0xffff0000, v11
  v_mul_f32 v56, 0xbfb8aa3b, v48
  v_exp_f32 v56, v56
  s_nop 0
  v_add_f32 v56, 1.0, v56
  v_rcp_f32 v56, v56
  s_nop 0
  v_mul_f32 v48, v48, v56
  v_mul_f32 v57, 0xbfb8aa3b, v49
  v_exp_f32 v57, v57
  s_nop 0
  v_add_f32 v57, 1.0, v57
  v_rcp_f32 v57, v57
  s_nop 0
  v_mul_f32 v49, v49, v57
  v_mul_f32 v58, 0xbfb8aa3b, v50
  v_exp_f32 v58, v58
  s_nop 0
  v_add_f32 v58, 1.0, v58
  v_rcp_f32 v58, v58
  s_nop 0
  v_mul_f32 v50, v50, v58
  v_mul_f32 v59, 0xbfb8aa3b, v51
  v_exp_f32 v59, v59
  s_nop 0
  v_add_f32 v59, 1.0, v59
  v_rcp_f32 v59, v59
  s_nop 0
  v_mul_f32 v51, v51, v59
  v_mul_f32 v60, 0xbfb8aa3b, v52
  v_exp_f32 v60, v60
  s_nop 0
  v_add_f32 v60, 1.0, v60
  v_rcp_f32 v60, v60
  s_nop 0
  v_mul_f32 v52, v52, v60
  v_mul_f32 v61, 0xbfb8aa3b, v53
  v_exp_f32 v61, v61
  s_nop 0
  v_add_f32 v61, 1.0, v61
  v_rcp_f32 v61, v61
  s_nop 0
  v_mul_f32 v53, v53, v61
  v_mul_f32 v62, 0xbfb8aa3b, v54
  v_exp_f32 v62, v62
  s_nop 0
  v_add_f32 v62, 1.0, v62
  v_rcp_f32 v62, v62
  s_nop 0
  v_mul_f32 v54, v54, v62
  v_mul_f32 v63, 0xbfb8aa3b, v55
  v_exp_f32 v63, v63
  s_nop 0
  v_add_f32 v63, 1.0, v63
  v_rcp_f32 v63, v63
  s_nop 0
  v_mul_f32 v55, v55, v63
  v_cvt_pk_bf16_f32 v8, v48, v49
  v_cvt_pk_bf16_f32 v9, v50, v51
  v_cvt_pk_bf16_f32 v10, v52, v53
  v_cvt_pk_bf16_f32 v11, v54, v55
  v_lshlrev_b32 v48, 16, v8
  v_and_b32 v49, 0xffff0000, v8
  v_lshlrev_b32 v50, 16, v9
  v_and_b32 v51, 0xffff0000, v9
  v_lshlrev_b32 v52, 16, v10
  v_and_b32 v53, 0xffff0000, v10
  v_lshlrev_b32 v54, 16, v11
  v_and_b32 v55, 0xffff0000, v11
  s_waitcnt vmcnt(7)
  v_lshlrev_b32 v56, 16, v16
  v_and_b32 v57, 0xffff0000, v16
  v_lshlrev_b32 v58, 16, v17
  v_and_b32 v59, 0xffff0000, v17
  v_lshlrev_b32 v60, 16, v18
  v_and_b32 v61, 0xffff0000, v18
  v_lshlrev_b32 v62, 16, v19
  v_and_b32 v63, 0xffff0000, v19
  v_mul_f32 v64, v48, v56
  v_mul_f32 v65, v48, v57
  v_mul_f32 v66, v48, v58
  v_mul_f32 v67, v48, v59
  v_mul_f32 v68, v48, v60
  v_mul_f32 v69, v48, v61
  v_mul_f32 v70, v48, v62
  v_mul_f32 v71, v48, v63
  s_waitcnt vmcnt(6)
  v_lshlrev_b32 v56, 16, v20
  v_and_b32 v57, 0xffff0000, v20
  v_lshlrev_b32 v58, 16, v21
  v_and_b32 v59, 0xffff0000, v21
  v_lshlrev_b32 v60, 16, v22
  v_and_b32 v61, 0xffff0000, v22
  v_lshlrev_b32 v62, 16, v23
  v_and_b32 v63, 0xffff0000, v23
  v_fmac_f32 v64, v49, v56
  v_fmac_f32 v65, v49, v57
  v_fmac_f32 v66, v49, v58
  v_fmac_f32 v67, v49, v59
  v_fmac_f32 v68, v49, v60
  v_fmac_f32 v69, v49, v61
  v_fmac_f32 v70, v49, v62
  v_fmac_f32 v71, v49, v63
  s_waitcnt vmcnt(5)
  v_lshlrev_b32 v56, 16, v24
  v_and_b32 v57, 0xffff0000, v24
  v_lshlrev_b32 v58, 16, v25
  v_and_b32 v59, 0xffff0000, v25
  v_lshlrev_b32 v60, 16, v26
  v_and_b32 v61, 0xffff0000, v26
  v_lshlrev_b32 v62, 16, v27
  v_and_b32 v63, 0xffff0000, v27
  v_fmac_f32 v64, v50, v56
  v_fmac_f32 v65, v50, v57
  v_fmac_f32 v66, v50, v58
  v_fmac_f32 v67, v50, v59
  v_fmac_f32 v68, v50, v60
  v_fmac_f32 v69, v50, v61
  v_fmac_f32 v70, v50, v62
  v_fmac_f32 v71, v50, v63
  s_waitcnt vmcnt(4)
  v_lshlrev_b32 v56, 16, v28
  v_and_b32 v57, 0xffff0000, v28
  v_lshlrev_b32 v58, 16, v29
  v_and_b32 v59, 0xffff0000, v29
  v_lshlrev_b32 v60, 16, v30
  v_and_b32 v61, 0xffff0000, v30
  v_lshlrev_b32 v62, 16, v31
  v_and_b32 v63, 0xffff0000, v31
  v_fmac_f32 v64, v51, v56
  v_fmac_f32 v65, v51, v57
  v_fmac_f32 v66, v51, v58
  v_fmac_f32 v67, v51, v59
  v_fmac_f32 v68, v51, v60
  v_fmac_f32 v69, v51, v61
  v_fmac_f32 v70, v51, v62
  v_fmac_f32 v71, v51, v63
  s_waitcnt vmcnt(3)
  v_lshlrev_b32 v56, 16, v32
  v_and_b32 v57, 0xffff0000, v32
  v_lshlrev_b32 v58, 16, v33
  v_and_b32 v59, 0xffff0000, v33
  v_lshlrev_b32 v60, 16, v34
  v_and_b32 v61, 0xffff0000, v34
  v_lshlrev_b32 v62, 16, v35
  v_and_b32 v63, 0xffff0000, v35
  v_fmac_f32 v64, v52, v56
  v_fmac_f32 v65, v52, v57
  v_fmac_f32 v66, v52, v58
  v_fmac_f32 v67, v52, v59
  v_fmac_f32 v68, v52, v60
  v_fmac_f32 v69, v52, v61
  v_fmac_f32 v70, v52, v62
  v_fmac_f32 v71, v52, v63
  s_waitcnt vmcnt(2)
  v_lshlrev_b32 v56, 16, v36
  v_and_b32 v57, 0xffff0000, v36
  v_lshlrev_b32 v58, 16, v37
  v_and_b32 v59, 0xffff0000, v37
  v_lshlrev_b32 v60, 16, v38
  v_and_b32 v61, 0xffff0000, v38
  v_lshlrev_b32 v62, 16, v39
  v_and_b32 v63, 0xffff0000, v39
  v_fmac_f32 v64, v53, v56
  v_fmac_f32 v65, v53, v57
  v_fmac_f32 v66, v53, v58
  v_fmac_f32 v67, v53, v59
  v_fmac_f32 v68, v53, v60
  v_fmac_f32 v69, v53, v61
  v_fmac_f32 v70, v53, v62
  v_fmac_f32 v71, v53, v63
  s_waitcnt vmcnt(1)
  v_lshlrev_b32 v56, 16, v40
  v_and_b32 v57, 0xffff0000, v40
  v_lshlrev_b32 v58, 16, v41
  v_and_b32 v59, 0xffff0000, v41
  v_lshlrev_b32 v60, 16, v42
  v_and_b32 v61, 0xffff0000, v42
  v_lshlrev_b32 v62, 16, v43
  v_and_b32 v63, 0xffff0000, v43
  v_fmac_f32 v64, v54, v56
  v_fmac_f32 v65, v54, v57
  v_fmac_f32 v66, v54, v58
  v_fmac_f32 v67, v54, v59
  v_fmac_f32 v68, v54, v60
  v_fmac_f32 v69, v54, v61
  v_fmac_f32 v70, v54, v62
  v_fmac_f32 v71, v54, v63
  s_waitcnt vmcnt(0)
  v_lshlrev_b32 v56, 16, v44
  v_and_b32 v57, 0xffff0000, v44
  v_lshlrev_b32 v58, 16, v45
  v_and_b32 v59, 0xffff0000, v45
  v_lshlrev_b32 v60, 16, v46
  v_and_b32 v61, 0xffff0000, v46
  v_lshlrev_b32 v62, 16, v47
  v_and_b32 v63, 0xffff0000, v47
  v_fmac_f32 v64, v55, v56
  v_fmac_f32 v65, v55, v57
  v_fmac_f32 v66, v55, v58
  v_fmac_f32 v67, v55, v59
  v_fmac_f32 v68, v55, v60
  v_fmac_f32 v69, v55, v61
  v_fmac_f32 v70, v55, v62
  v_fmac_f32 v71, v55, v63
  v_lshlrev_b32 v5, 5, v0
  ds_write_b128 v5, v[64:67]
  ds_write_b128 v5, v[68:71] offset:16
  v_and_b32 v6, 63, v0
  v_lshrrev_b32 v7, 6, v0
  v_lshlrev_b32 v6, 2, v6
  v_lshl_add_u32 v7, v7, 11, v6
  s_waitcnt lgkmcnt(0)
  s_barrier
  ds_read_b32 v16, v7 offset:0
  ds_read_b32 v17, v7 offset:256
  ds_read_b32 v18, v7 offset:512
  ds_read_b32 v19, v7 offset:768
  ds_read_b32 v20, v7 offset:1024
  ds_read_b32 v21, v7 offset:1280
  ds_read_b32 v22, v7 offset:1536
  ds_read_b32 v23, v7 offset:1792
  s_waitcnt lgkmcnt(0)
  v_add_f32 v16, v16, v17
  v_add_f32 v16, v16, v18
  v_add_f32 v16, v16, v19
  v_add_f32 v16, v16, v20
  v_add_f32 v16, v16, v21
  v_add_f32 v16, v16, v22
  v_add_f32 v16, v16, v23
  v_lshlrev_b32 v5, 2, v0
  ds_write_b32 v5, v16 offset:18432
  s_waitcnt lgkmcnt(0)
  s_barrier
  v_readfirstlane_b32 s18, v0
  s_cmp_lt_u32 s18, 64
  s_cbranch_scc1 k1_kmod_fin
  s_endpgm
k1_kmod_fin:
  ds_read_b32 v16, v6 offset:18432
  ds_read_b32 v17, v6 offset:18688
  ds_read_b32 v18, v6 offset:18944
  ds_read_b32 v19, v6 offset:19200
  ds_read_b32 v20, v6 offset:19456
  ds_read_b32 v21, v6 offset:19712
  ds_read_b32 v22, v6 offset:19968
  ds_read_b32 v23, v6 offset:20224
  ds_read_b32 v24, v6 offset:20480
  s_waitcnt lgkmcnt(0)
  v_add_f32 v16, v16, v17
  v_add_f32 v16, v16, v18
  v_add_f32 v16, v16, v19
  v_add_f32 v16, v16, v20
  v_add_f32 v16, v16, v21
  v_add_f32 v16, v16, v22
  v_add_f32 v16, v16, v23
  v_add_f32 v16, v16, v24
  v_cvt_pk_bf16_f32 v16, v16, v16
  v_lshlrev_b32 v16, 16, v16
  s_sub_u32 s19, s2, 9
  s_cmp_lt_u32 s19, 9
  s_cselect_b32 s24, 1.0, 0
  s_sub_u32 s19, s2, 36
  s_cmp_lt_u32 s19, 9
  s_cselect_b32 s24, 1.0, s24
  v_add_f32 v16, s24, v16
  v_cvt_pk_bf16_f32 v16, v16, v16
  v_lshlrev_b32 v16, 16, v16
  s_lshl_b32 s17, s2, 8
  buffer_store_dword v16, v6, s[12:15], s17 offen
  s_cmp_lt_u32 s2, 18
  s_cbranch_scc0 k1_kmod_end
  s_cmp_lt_u32 s2, 9
  s_cselect_b32 s17, 32, 0
  s_cselect_b32 s18, 0, 9
  s_sub_u32 s18, s2, s18
  s_lshl_b32 s18, s18, 9
  s_add_u32 s17, s17, s18
  s_add_u32 s17, s17, 0x4000
  v_lshrrev_b32 v1, 3, v0
  v_and_b32 v2, 7, v0
  v_lshlrev_b32 v2, 2, v2
  v_lshl_add_u32 v1, v1, 6, v2
  buffer_store_dword v16, v1, s[12:15], s17 offen
k1_kmod_end:
  s_endpgm
k1_ln1:
  s_cmp_eq_u32 s2, 54
  s_cbranch_scc0 k1_ln1b
  s_load_dwordx2 s[12:13], s[0:1], 104
  s_mov_b32 s14, 134217728
  s_mov_b32 s15, 0x00020000
  v_lshrrev_b32 v1, 4, v0
  v_lshlrev_b32 v1, 8, v1
  v_and_b32 v2, 15, v0
  v_lshl_add_u32 v1, v2, 3, v1
  v_mov_b32 v2, 0
  v_mov_b32 v3, 0
  v_cmp_gt_u32 vcc, 0x200, v0
  s_and_saveexec_b64 s[40:41], vcc
  s_mov_b32 s17, 0x8000
  s_waitcnt lgkmcnt(0)
  buffer_store_dwordx2 v[2:3], v1, s[12:15], s17 offen
  s_endpgm
k1_ln1b:
  s_sub_u32 s2, s2, 56
  s_load_dwordx2 s[20:21], s[0:1], 96
  s_mov_b32 s22, 256
  s_mov_b32 s23, 0x00020000
  s_load_dwordx2 s[24:25], s[0:1], 24
  s_mov_b32 s26, 4718592
  s_mov_b32 s27, 0x00020000
  s_load_dwordx2 s[28:29], s[0:1], 8
  s_mov_b32 s30, 8388608
  s_mov_b32 s31, 0x00020000
  s_load_dwordx2 s[32:33], s[0:1], 16
  s_mov_b32 s34, 8388608
  s_mov_b32 s35, 0x00020000
  s_load_dwordx2 s[36:37], s[0:1], 32
  s_mov_b32 s38, 4718592
  s_mov_b32 s39, 0x00020000
  s_cmp_lt_u32 s2, 256
  s_cbranch_scc1 k1_go_1
  s_endpgm
k1_go_1:
  s_load_dwordx2 s[4:5], s[0:1], 0
  s_mov_b32 s6, 2359296
  s_mov_b32 s7, 0x00020000
  s_load_dwordx2 s[12:13], s[0:1], 104
  s_mov_b32 s14, 134217728
  s_mov_b32 s15, 0x00020000
  s_load_dwordx2 s[8:9], s[0:1], 88
  s_mov_b32 s10, 2359296
  s_mov_b32 s11, 0x00020000
  v_lshlrev_b32 v1, 4, v0
  v_and_b32 v2, 7, v0
  v_lshrrev_b32 v5, 3, v0
  s_movk_i32 s16, 1152
  v_mul_lo_u32 v4, v2, s16
  v_lshl_add_u32 v4, v5, 4, v4
  v_lshlrev_b32 v5, 5, v5
  v_lshlrev_b32 v2, 6, v2
  v_lshrrev_b32 v3, 6, v0
  v_lshl_add_u32 v3, v3, 2, v2
  s_mul_i32 s16, s2, 9216
  s_waitcnt lgkmcnt(0)
  buffer_load_dwordx4 v[8:11], v4, s[4:7], s16 offen
  v_lshlrev_b32 v50, 7, v0
  v_cmp_gt_u32 vcc, 0x90, v0
  s_and_saveexec_b64 s[40:41], vcc
  s_cbranch_execz k1_pf_kv
  s_mul_i32 s17, s2, 18432
  buffer_load_dword v51, v50, s[24:27], s17 offen
  s_mov_b64 exec, s[40:41]
  s_waitcnt vmcnt(1)
  s_branch k1_pf_end
k1_pf_kv:
  s_mov_b64 exec, s[40:41]
  v_readfirstlane_b32 s18, v0
  s_branch k1_pf_done
  v_and_b32 v50, 63, v0
  v_lshlrev_b32 v50, 7, v50
  s_lshr_b32 s17, s2, 4
  s_lshl_b32 s17, s17, 19
  s_and_b32 s18, s2, 15
  s_lshl_b32 s18, s18, 13
  s_add_u32 s17, s17, s18
  s_add_u32 s17, s17, 393216
  buffer_load_dword v51, v50, s[28:31], s17 offen
  buffer_load_dword v51, v50, s[32:35], s17 offen
  s_waitcnt vmcnt(2)
  s_branch k1_pf_end
k1_pf_done:
  s_waitcnt vmcnt(0)
k1_pf_end:
  v_lshlrev_b32 v32, 16, v8
  v_and_b32 v33, 0xffff0000, v8
  v_lshlrev_b32 v34, 16, v9
  v_and_b32 v35, 0xffff0000, v9
  v_lshlrev_b32 v36, 16, v10
  v_and_b32 v37, 0xffff0000, v10
  v_lshlrev_b32 v38, 16, v11
  v_and_b32 v39, 0xffff0000, v11
  v_add_f32 v6, v32, v33
  v_add_f32 v6, v6, v34
  v_add_f32 v6, v6, v35
  v_add_f32 v6, v6, v36
  v_add_f32 v6, v6, v37
  v_add_f32 v6, v6, v38
  v_add_f32 v6, v6, v39
  s_nop 1
  v_add_f32_dpp v6, v6, v6 row_ror:8 row_mask:0xf bank_mask:0xf
  ds_swizzle_b32 v40, v6 offset:0x401F
  s_waitcnt lgkmcnt(0)
  v_add_f32 v6, v6, v40
  v_mov_b32 v40, v6
  s_nop 1
  v_permlane32_swap_b32 v6, v40
  v_add_f32 v6, v6, v40
  ds_write_b32 v3, v6 offset:0
  s_waitcnt lgkmcnt(0)
  s_barrier
  ds_read_b128 v[40:43], v2 offset:0
  ds_read_b128 v[44:47], v2 offset:16
  ds_read_b32 v6, v2 offset:32
  s_waitcnt lgkmcnt(0)
  v_add_f32 v40, v40, v41
  v_add_f32 v42, v42, v43
  v_add_f32 v44, v44, v45
  v_add_f32 v46, v46, v47
  v_add_f32 v40, v40, v42
  v_add_f32 v44, v44, v46
  v_add_f32 v6, v6, v40
  v_add_f32 v6, v6, v44
  v_mul_f32 v6, 0x3ae38e39, v6
  v_sub_f32 v32, v32, v6
  v_sub_f32 v33, v33, v6
  v_sub_f32 v34, v34, v6
  v_sub_f32 v35, v35, v6
  v_sub_f32 v36, v36, v6
  v_sub_f32 v37, v37, v6
  v_sub_f32 v38, v38, v6
  v_sub_f32 v39, v39, v6
  v_mul_f32 v6, v32, v32
  v_fmac_f32 v6, v33, v33
  v_fmac_f32 v6, v34, v34
  v_fmac_f32 v6, v35, v35
  v_fmac_f32 v6, v36, v36
  v_fmac_f32 v6, v37, v37
  v_fmac_f32 v6, v38, v38
  v_fmac_f32 v6, v39, v39
  s_nop 1
  v_add_f32_dpp v6, v6, v6 row_ror:8 row_mask:0xf bank_mask:0xf
  ds_swizzle_b32 v40, v6 offset:0x401F
  s_waitcnt lgkmcnt(0)
  v_add_f32 v6, v6, v40
  v_mov_b32 v40, v6
  s_nop 1
  v_permlane32_swap_b32 v6, v40
  v_add_f32 v6, v6, v40
  ds_write_b32 v3, v6 offset:512
  s_waitcnt lgkmcnt(0)
  s_barrier
  ds_read_b128 v[40:43], v2 offset:512
  ds_read_b128 v[44:47], v2 offset:528
  ds_read_b32 v6, v2 offset:544
  s_waitcnt lgkmcnt(0)
  v_add_f32 v40, v40, v41
  v_add_f32 v42, v42, v43
  v_add_f32 v44, v44, v45
  v_add_f32 v46, v46, v47
  v_add_f32 v40, v40, v42
  v_add_f32 v44, v44, v46
  v_add_f32 v6, v6, v40
  v_add_f32 v6, v6, v44
  v_mov_b32 v7, 0x3727c5ac
  v_fmac_f32 v7, 0x3ae38e39, v6
  v_rsq_f32 v7, v7
  s_nop 0
  v_mul_f32 v32, v32, v7
  v_mul_f32 v33, v33, v7
  v_mul_f32 v34, v34, v7
  v_mul_f32 v35, v35, v7
  v_mul_f32 v36, v36, v7
  v_mul_f32 v37, v37, v7
  v_mul_f32 v38, v38, v7
  v_mul_f32 v39, v39, v7
  v_cvt_pk_bf16_f32 v12, v32, v33
  v_cvt_pk_bf16_f32 v13, v34, v35
  v_cvt_pk_bf16_f32 v14, v36, v37
  v_cvt_pk_bf16_f32 v15, v38, v39
  s_add_u32 s17, s16, 65536
  buffer_store_dwordx4 v[12:15], v1, s[12:15], s17 offen
  s_endpgm
.globl k2_kernel
.p2align 8
.type k2_kernel,@function
k2_kernel:
  s_cmp_lt_u32 s2, 256
  s_cbranch_scc1 k2_go_1
  s_endpgm
k2_go_1:
  s_load_dwordx2 s[4:5], s[0:1], 24
  s_mov_b32 s6, 4718592
  s_mov_b32 s7, 0x00020000
  s_load_dwordx2 s[8:9], s[0:1], 8
  s_mov_b32 s10, 8388608
  s_mov_b32 s11, 0x00020000
  s_load_dwordx2 s[12:13], s[0:1], 16
  s_mov_b32 s14, 8388608
  s_mov_b32 s15, 0x00020000
  s_load_dwordx2 s[16:17], s[0:1], 32
  s_mov_b32 s18, 4718592
  s_mov_b32 s19, 0x00020000
  s_load_dwordx2 s[20:21], s[0:1], 104
  s_mov_b32 s22, 134217728
  s_mov_b32 s23, 0x00020000
  v_and_b32 v1, 63, v0
  v_lshrrev_b32 v8, 6, v0
  s_nop 0
  v_readfirstlane_b32 s24, v8
  v_lshrrev_b32 v8, 5, v1
  v_bfe_u32 v9, v1, 2, 2
  v_bfe_u32 v10, v1, 4, 1
  v_and_b32 v11, 3, v1
  v_lshlrev_b32 v12, 1, v11
  v_lshrrev_b32 v13, 1, v11
  v_or_b32 v12, v12, v13
  v_and_b32 v12, 3, v12
  v_bfe_u32 v13, v1, 3, 2
  v_mul_u32_u24 v2, 9216, v13
  v_lshl_add_u32 v2, v8, 7, v2
  v_and_b32 v13, 7, v1
  v_lshl_add_u32 v2, v13, 4, v2
  s_cmp_lt_u32 s24, 4
  s_cbranch_scc1 k2_prio_2
  s_setprio 1
k2_prio_2:
  s_and_b32 s25, s2, 7
  s_bfe_u32 s26, s2, 0x10003
  s_lshl_b32 s26, s26, 3
  s_add_u32 s25, s25, s26
  s_lshr_b32 s26, s2, 4
  s_and_b32 s28, s24, 3
  s_lshr_b32 s29, s24, 2
  s_lshl_b32 s30, s24, 10
  s_lshl_b32 s31, s26, 2
  s_add_u32 s31, s31, s28
  s_mul_i32 s31, s31, 36864
  s_add_u32 s32, s31, 65536
  s_mul_i32 s33, s25, 2359296
  s_add_u32 s33, s33, s31
  s_lshl_b32 s34, s29, 9
  s_add_u32 s33, s33, s34
  s_add_u32 s33, s33, 16777216
  s_lshl_b32 s34, s25, 9
  s_lshl_b32 s35, s25, 19
  s_add_u32 s35, s35, 393216
  s_mul_i32 s36, s25, 294912
  s_mul_i32 s32, s26, 147456
  s_lshl_b32 s37, s24, 7
  s_add_u32 s32, s32, s37
  s_add_u32 s32, s32, 65536
  s_lshl_b32 s47, s24, 6
  s_add_u32 s47, s47, 0x4000
  v_lshrrev_b32 v13, 3, v1
  v_mul_u32_u24 v253, 9216, v13
  v_and_b32 v13, 7, v1
  v_lshl_add_u32 v253, v13, 4, v253
  v_and_b32 v13, 31, v1
  v_lshlrev_b32 v252, 12, v8
  v_lshl_add_u32 v252, v13, 4, v252
  s_lshl_b32 s37, s24, 9
  s_add_u32 s37, s37, 49152
  v_add_u32 v252, s37, v252
  s_lshl_b32 s37, s24, 1
  v_add_u32 v13, s37, v8
  v_and_b32 v14, 3, v13
  v_bfe_u32 v15, v1, 2, 3
  v_xor_b32 v14, v14, v15
  v_lshlrev_b32 v3, 13, v13
  v_lshl_add_u32 v3, v14, 6, v3
  v_lshl_add_u32 v3, v11, 4, v3
  s_waitcnt lgkmcnt(0)
  s_add_u32 s38, s32, 0
  buffer_load_dwordx4 v[136:139], v253, s[20:23], s38 offen
  s_add_u32 s38, s32, 73728
  buffer_load_dwordx4 v[140:143], v253, s[20:23], s38 offen
  s_add_u32 s46, s47, 0
  s_load_dwordx16 s[84:99], s[20:21], s46
  s_add_u32 s46, s47, 512
  s_load_dwordx16 s[64:79], s[20:21], s46
  s_add_u32 s38, s32, 1024
  buffer_load_dwordx4 v[144:147], v253, s[20:23], s38 offen
  s_add_u32 s38, s32, 74752
  buffer_load_dwordx4 v[148:151], v253, s[20:23], s38 offen
  s_add_u32 m0, s30, 16384
  s_add_u32 s38, s34, 0
  buffer_load_dwordx4 v3, s[4:7], s38 offen lds
  s_add_u32 m0, s30, 24576
  s_add_u32 s38, s34, 131072
  buffer_load_dwordx4 v3, s[4:7], s38 offen lds
  s_add_u32 m0, s30, 32768
  s_add_u32 s38, s34, 262144
  buffer_load_dwordx4 v3, s[4:7], s38 offen lds
  s_add_u32 m0, s30, 40960
  s_add_u32 s38, s34, 393216
  buffer_load_dwordx4 v3, s[4:7], s38 offen lds
  s_lshl_b32 s37, s24, 2
  v_lshrrev_b32 v13, 4, v1
  v_add_u32 v14, s37, v13
  v_and_b32 v15, 15, v1
  v_xor_b32 v7, v15, v14
  v_and_b32 v7, 15, v7
  v_lshlrev_b32 v4, 8, v14
  v_lshl_add_u32 v5, v15, 4, v4
  v_lshl_add_u32 v4, v7, 4, v4
  v_lshlrev_b32 v13, 6, v13
  v_xor_b32 v5, v5, v13
  s_lshl_b32 s37, s24, 3
  v_lshrrev_b32 v13, 3, v1
  v_add_u32 v13, s37, v13
  v_mul_u32_u24 v6, 1152, v13
  v_bfe_u32 v13, v1, 2, 1
  v_xor_b32 v13, v13, v10
  v_lshl_add_u32 v6, v13, 6, v6
  v_lshl_add_u32 v6, v11, 4, v6
  v_lshl_add_u32 v13, v8, 3, v9
  v_lshlrev_b32 v16, 9, v13
  s_lshl_b32 s37, s29, 2
  v_xor_b32 v13, s37, v9
  v_lshl_add_u32 v16, v13, 6, v16
  v_lshl_add_u32 v16, v10, 5, v16
  v_lshl_add_u32 v16, v12, 3, v16
  v_add_u32 v16, 16384, v16
  v_xor_b32 v17, 64, v16
  v_xor_b32 v18, 0x80, v16
  v_xor_b32 v19, 0xc0, v16
  v_lshl_add_u32 v13, v8, 2, v9
  v_lshlrev_b32 v20, 8, v13
  v_lshl_add_u32 v20, v9, 6, v20
  v_lshl_add_u32 v20, v10, 5, v20
  v_lshl_add_u32 v20, v11, 3, v20
  v_add_u32 v20, 131072, v20
  v_xor_b32 v21, 64, v20
  v_xor_b32 v22, 0x80, v20
  v_xor_b32 v23, 0xc0, v20
  v_and_b32 v13, 31, v1
  v_lshlrev_b32 v24, 8, v13
  v_and_b32 v13, 15, v1
  v_xor_b32 v13, v13, v8
  v_lshl_add_u32 v24, v13, 4, v24
  v_xor_b32 v25, 32, v24
  v_xor_b32 v26, 64, v24
  v_xor_b32 v27, 96, v24
  v_xor_b32 v28, 128, v24
  v_xor_b32 v29, 160, v24
  v_xor_b32 v30, 192, v24
  v_xor_b32 v31, 224, v24
  v_lshl_add_u32 v13, v8, 2, v9
  v_lshlrev_b32 v15, 7, v13
  v_lshrrev_b32 v13, 1, v9
  v_xor_b32 v13, s29, v13
  v_lshl_add_u32 v15, v13, 6, v15
  v_lshl_add_u32 v15, v10, 5, v15
  v_lshl_add_u32 v15, v12, 3, v15
  v_lshlrev_b32 v14, 4, v1
  s_lshl_b32 s37, s28, 12
  s_add_u32 s37, s37, 49152
  v_add_u32 v13, s37, v14
  s_add_u32 s38, s32, 2048
  buffer_load_dwordx4 v[152:155], v253, s[20:23], s38 offen
  s_add_u32 s38, s32, 75776
  buffer_load_dwordx4 v[156:159], v253, s[20:23], s38 offen
  s_add_u32 m0, s30, 65536
  s_add_u32 s38, s34, 524288
  buffer_load_dwordx4 v3, s[4:7], s38 offen lds
  s_add_u32 m0, s30, 73728
  s_add_u32 s38, s34, 655360
  buffer_load_dwordx4 v3, s[4:7], s38 offen lds
  s_add_u32 m0, s30, 81920
  s_add_u32 s38, s34, 786432
  buffer_load_dwordx4 v3, s[4:7], s38 offen lds
  s_add_u32 m0, s30, 90112
  s_add_u32 s38, s34, 917504
  buffer_load_dwordx4 v3, s[4:7], s38 offen lds
  s_waitcnt vmcnt(12)
  s_waitcnt lgkmcnt(0)
  v_mov_b32 v168, s92
  v_mov_b32 v169, s93
  v_mov_b32 v170, s94
  v_mov_b32 v171, s95
  v_mov_b32 v172, s96
  v_mov_b32 v173, s97
  v_mov_b32 v174, s98
  v_mov_b32 v175, s99
  v_lshlrev_b32 v160, 16, v136
  v_and_b32 v161, 0xffff0000, v136
  v_fma_f32 v160, v160, s84, v168
  v_fma_f32 v161, v161, s85, v169
  v_cvt_pk_bf16_f32 v136, v160, v161
  v_lshlrev_b32 v162, 16, v137
  v_and_b32 v163, 0xffff0000, v137
  v_fma_f32 v162, v162, s86, v170
  v_fma_f32 v163, v163, s87, v171
  v_cvt_pk_bf16_f32 v137, v162, v163
  v_lshlrev_b32 v164, 16, v138
  v_and_b32 v165, 0xffff0000, v138
  v_fma_f32 v164, v164, s88, v172
  v_fma_f32 v165, v165, s89, v173
  v_cvt_pk_bf16_f32 v138, v164, v165
  v_lshlrev_b32 v166, 16, v139
  v_and_b32 v167, 0xffff0000, v139
  v_fma_f32 v166, v166, s90, v174
  v_fma_f32 v167, v167, s91, v175
  v_cvt_pk_bf16_f32 v139, v166, v167
  ds_write_b128 v252, v[136:139] offset:0
  v_lshlrev_b32 v160, 16, v140
  v_and_b32 v161, 0xffff0000, v140
  v_fma_f32 v160, v160, s84, v168
  v_fma_f32 v161, v161, s85, v169
  v_cvt_pk_bf16_f32 v140, v160, v161
  v_lshlrev_b32 v162, 16, v141
  v_and_b32 v163, 0xffff0000, v141
  v_fma_f32 v162, v162, s86, v170
  v_fma_f32 v163, v163, s87, v171
  v_cvt_pk_bf16_f32 v141, v162, v163
  v_lshlrev_b32 v164, 16, v142
  v_and_b32 v165, 0xffff0000, v142
  v_fma_f32 v164, v164, s88, v172
  v_fma_f32 v165, v165, s89, v173
  v_cvt_pk_bf16_f32 v142, v164, v165
  v_lshlrev_b32 v166, 16, v143
  v_and_b32 v167, 0xffff0000, v143
  v_fma_f32 v166, v166, s90, v174
  v_fma_f32 v167, v167, s91, v175
  v_cvt_pk_bf16_f32 v143, v166, v167
  ds_write_b128 v252, v[140:143] offset:8192
  s_waitcnt vmcnt(6)
  s_waitcnt lgkmcnt(0)
  s_barrier
  ds_read_b64_tr_b16 v[32:33], v16 offset:0
  ds_read_b64_tr_b16 v[34:35], v16 offset:2048
  ds_read_b128 v[112:115], v13 offset:0
  ds_read_b64_tr_b16 v[36:37], v17 offset:0
  ds_read_b64_tr_b16 v[38:39], v17 offset:2048
  ds_read_b64_tr_b16 v[40:41], v18 offset:0
  ds_read_b64_tr_b16 v[42:43], v18 offset:2048
  ds_read_b64_tr_b16 v[44:45], v19 offset:0
  ds_read_b64_tr_b16 v[46:47], v19 offset:2048
  s_waitcnt lgkmcnt(6)
  v_mfma_f32_32x32x16_bf16 v[48:63], v[32:35], v[112:115], 0
  ds_read_b64_tr_b16 v[128:129], v16 offset:8192
  ds_read_b64_tr_b16 v[130:131], v16 offset:10240
  ds_read_b128 v[116:119], v13 offset:1024
  s_add_u32 s46, s47, 1024
  s_load_dwordx16 s[84:99], s[20:21], s46
  v_mov_b32 v168, s72
  v_mov_b32 v169, s73
  v_mov_b32 v170, s74
  s_waitcnt lgkmcnt(7)
  v_mfma_f32_32x32x16_bf16 v[64:79], v[36:39], v[112:115], 0
  ds_read_b64_tr_b16 v[132:133], v17 offset:8192
  ds_read_b64_tr_b16 v[134:135], v17 offset:10240
  v_mov_b32 v171, s75
  v_mov_b32 v172, s76
  v_mov_b32 v173, s77
  v_mov_b32 v174, s78
  s_waitcnt lgkmcnt(7)
  v_mfma_f32_32x32x16_bf16 v[80:95], v[40:43], v[112:115], 0
  ds_read_b64_tr_b16 v[32:33], v18 offset:8192
  ds_read_b64_tr_b16 v[34:35], v18 offset:10240
  v_mov_b32 v175, s79
  v_add_u32 v252, 49152, v252
  v_lshlrev_b32 v160, 16, v144
  v_and_b32 v161, 0xffff0000, v144
  s_add_u32 s38, s32, 3072
  buffer_load_dwordx4 v[136:139], v253, s[20:23], s38 offen
  s_waitcnt lgkmcnt(7)
  v_mfma_f32_32x32x16_bf16 v[96:111], v[44:47], v[112:115], 0
  ds_read_b64_tr_b16 v[36:37], v19 offset:8192
  ds_read_b64_tr_b16 v[38:39], v19 offset:10240
  v_fma_f32 v160, v160, s64, v168
  v_fma_f32 v161, v161, s65, v169
  v_cvt_pk_bf16_f32 v144, v160, v161
  v_lshlrev_b32 v162, 16, v145
  s_waitcnt lgkmcnt(6)
  v_mfma_f32_32x32x16_bf16 v[48:63], v[128:131], v[116:119], v[48:63]
  ds_read_b64_tr_b16 v[40:41], v16 offset:16384
  ds_read_b64_tr_b16 v[42:43], v16 offset:18432
  ds_read_b128 v[120:123], v13 offset:2048
  v_and_b32 v163, 0xffff0000, v145
  v_fma_f32 v162, v162, s66, v170
  v_fma_f32 v163, v163, s67, v171
  v_cvt_pk_bf16_f32 v145, v162, v163
  s_waitcnt lgkmcnt(7)
  v_mfma_f32_32x32x16_bf16 v[64:79], v[132:135], v[116:119], v[64:79]
  ds_read_b64_tr_b16 v[44:45], v17 offset:16384
  ds_read_b64_tr_b16 v[46:47], v17 offset:18432
  v_lshlrev_b32 v164, 16, v146
  v_and_b32 v165, 0xffff0000, v146
  v_fma_f32 v164, v164, s68, v172
  v_fma_f32 v165, v165, s69, v173
  s_add_u32 s38, s32, 76800
  buffer_load_dwordx4 v[140:143], v253, s[20:23], s38 offen
  s_waitcnt lgkmcnt(7)
  v_mfma_f32_32x32x16_bf16 v[80:95], v[32:35], v[116:119], v[80:95]
  ds_read_b64_tr_b16 v[128:129], v18 offset:16384
  ds_read_b64_tr_b16 v[130:131], v18 offset:18432
  v_cvt_pk_bf16_f32 v146, v164, v165
  v_lshlrev_b32 v166, 16, v147
  v_and_b32 v167, 0xffff0000, v147
  v_fma_f32 v166, v166, s70, v174
  s_waitcnt lgkmcnt(7)
  v_mfma_f32_32x32x16_bf16 v[96:111], v[36:39], v[116:119], v[96:111]
  ds_read_b64_tr_b16 v[132:133], v19 offset:16384
  ds_read_b64_tr_b16 v[134:135], v19 offset:18432
  v_fma_f32 v167, v167, s71, v175
  v_cvt_pk_bf16_f32 v147, v166, v167
  ds_write_b128 v252, v[144:147] offset:0
  v_lshlrev_b32 v160, 16, v148
  s_add_u32 m0, s30, 114688
  s_add_u32 s38, s34, 1048576
  buffer_load_dwordx4 v3, s[4:7], s38 offen lds
  s_waitcnt lgkmcnt(7)
  v_mfma_f32_32x32x16_bf16 v[48:63], v[40:43], v[120:123], v[48:63]
  ds_read_b64_tr_b16 v[32:33], v16 offset:24576
  ds_read_b64_tr_b16 v[34:35], v16 offset:26624
  ds_read_b128 v[124:127], v13 offset:3072
  v_and_b32 v161, 0xffff0000, v148
  v_fma_f32 v160, v160, s64, v168
  v_fma_f32 v161, v161, s65, v169
  v_cvt_pk_bf16_f32 v148, v160, v161
  s_waitcnt lgkmcnt(8)
  v_mfma_f32_32x32x16_bf16 v[64:79], v[44:47], v[120:123], v[64:79]
  ds_read_b64_tr_b16 v[36:37], v17 offset:24576
  ds_read_b64_tr_b16 v[38:39], v17 offset:26624
  v_lshlrev_b32 v162, 16, v149
  v_and_b32 v163, 0xffff0000, v149
  v_fma_f32 v162, v162, s66, v170
  v_fma_f32 v163, v163, s67, v171
  s_waitcnt lgkmcnt(8)
  v_mfma_f32_32x32x16_bf16 v[80:95], v[128:131], v[120:123], v[80:95]
  ds_read_b64_tr_b16 v[40:41], v18 offset:24576
  ds_read_b64_tr_b16 v[42:43], v18 offset:26624
  v_cvt_pk_bf16_f32 v149, v162, v163
  v_lshlrev_b32 v164, 16, v150
  v_and_b32 v165, 0xffff0000, v150
  v_fma_f32 v164, v164, s68, v172
  s_add_u32 m0, s30, 122880
  s_add_u32 s38, s34, 1179648
  buffer_load_dwordx4 v3, s[4:7], s38 offen lds
  s_waitcnt lgkmcnt(8)
  v_mfma_f32_32x32x16_bf16 v[96:111], v[132:135], v[120:123], v[96:111]
  ds_read_b64_tr_b16 v[44:45], v19 offset:24576
  ds_read_b64_tr_b16 v[46:47], v19 offset:26624
  v_fma_f32 v165, v165, s69, v173
  v_cvt_pk_bf16_f32 v150, v164, v165
  v_lshlrev_b32 v166, 16, v151
  v_and_b32 v167, 0xffff0000, v151
  s_waitcnt lgkmcnt(6)
  v_mfma_f32_32x32x16_bf16 v[48:63], v[32:35], v[124:127], v[48:63]
  v_fma_f32 v166, v166, s70, v174
  v_fma_f32 v167, v167, s71, v175
  v_cvt_pk_bf16_f32 v151, v166, v167
  ds_write_b128 v252, v[148:151] offset:8192
  s_waitcnt vmcnt(4)
  s_waitcnt lgkmcnt(0)
  s_barrier
  v_add_u32 v13, 49152, v13
  v_add_u32 v16, 49152, v16
  v_add_u32 v17, 49152, v17
  v_add_u32 v18, 49152, v18
  v_add_u32 v19, 49152, v19
  ds_read_b64_tr_b16 v[128:129], v16 offset:0
  ds_read_b64_tr_b16 v[130:131], v16 offset:2048
  ds_read_b128 v[112:115], v13 offset:0
  s_add_u32 s46, s47, 1536
  s_load_dwordx16 s[64:79], s[20:21], s46
  v_mov_b32 v168, s92
  v_mov_b32 v169, s93
  v_mov_b32 v170, s94
  v_mfma_f32_32x32x16_bf16 v[64:79], v[36:39], v[124:127], v[64:79]
  ds_read_b64_tr_b16 v[132:133], v17 offset:0
  ds_read_b64_tr_b16 v[134:135], v17 offset:2048
  v_mov_b32 v171, s95
  v_mov_b32 v172, s96
  v_mov_b32 v173, s97
  v_mov_b32 v174, s98
  s_add_u32 m0, s30, 131072
  s_add_u32 s38, s34, 1310720
  buffer_load_dwordx4 v3, s[4:7], s38 offen lds
  v_mfma_f32_32x32x16_bf16 v[80:95], v[40:43], v[124:127], v[80:95]
  ds_read_b64_tr_b16 v[32:33], v18 offset:0
  ds_read_b64_tr_b16 v[34:35], v18 offset:2048
  v_mov_b32 v175, s99
  v_add_u32 v252, 49152, v252
  v_lshlrev_b32 v160, 16, v152
  v_and_b32 v161, 0xffff0000, v152
  v_mfma_f32_32x32x16_bf16 v[96:111], v[44:47], v[124:127], v[96:111]
  ds_read_b64_tr_b16 v[36:37], v19 offset:0
  ds_read_b64_tr_b16 v[38:39], v19 offset:2048
  v_fma_f32 v160, v160, s84, v168
  v_fma_f32 v161, v161, s85, v169
  v_cvt_pk_bf16_f32 v152, v160, v161
  v_lshlrev_b32 v162, 16, v153
  s_add_u32 m0, s30, 139264
  s_add_u32 s38, s34, 1441792
  buffer_load_dwordx4 v3, s[4:7], s38 offen lds
  s_waitcnt lgkmcnt(6)
  v_mfma_f32_32x32x16_bf16 v[48:63], v[128:131], v[112:115], v[48:63]
  ds_read_b64_tr_b16 v[40:41], v16 offset:8192
  ds_read_b64_tr_b16 v[42:43], v16 offset:10240
  ds_read_b128 v[116:119], v13 offset:1024
  v_and_b32 v163, 0xffff0000, v153
  v_fma_f32 v162, v162, s86, v170
  v_fma_f32 v163, v163, s87, v171
  v_cvt_pk_bf16_f32 v153, v162, v163
  s_waitcnt lgkmcnt(7)
  v_mfma_f32_32x32x16_bf16 v[64:79], v[132:135], v[112:115], v[64:79]
  ds_read_b64_tr_b16 v[44:45], v17 offset:8192
  ds_read_b64_tr_b16 v[46:47], v17 offset:10240
  v_lshlrev_b32 v164, 16, v154
  v_and_b32 v165, 0xffff0000, v154
  v_fma_f32 v164, v164, s88, v172
  v_fma_f32 v165, v165, s89, v173
  s_waitcnt lgkmcnt(7)
  v_mfma_f32_32x32x16_bf16 v[80:95], v[32:35], v[112:115], v[80:95]
  ds_read_b64_tr_b16 v[128:129], v18 offset:8192
  ds_read_b64_tr_b16 v[130:131], v18 offset:10240
  v_cvt_pk_bf16_f32 v154, v164, v165
  v_lshlrev_b32 v166, 16, v155
  v_and_b32 v167, 0xffff0000, v155
  v_fma_f32 v166, v166, s90, v174
  s_add_u32 s38, s32, 4096
  buffer_load_dwordx4 v[144:147], v253, s[20:23], s38 offen
  s_waitcnt lgkmcnt(7)
  v_mfma_f32_32x32x16_bf16 v[96:111], v[36:39], v[112:115], v[96:111]
  ds_read_b64_tr_b16 v[132:133], v19 offset:8192
  ds_read_b64_tr_b16 v[134:135], v19 offset:10240
  v_fma_f32 v167, v167, s91, v175
  v_cvt_pk_bf16_f32 v155, v166, v167
  ds_write_b128 v252, v[152:155] offset:0
  v_lshlrev_b32 v160, 16, v156
  s_waitcnt lgkmcnt(7)
  v_mfma_f32_32x32x16_bf16 v[48:63], v[40:43], v[116:119], v[48:63]
  ds_read_b64_tr_b16 v[32:33], v16 offset:16384
  ds_read_b64_tr_b16 v[34:35], v16 offset:18432
  ds_read_b128 v[120:123], v13 offset:2048
  v_and_b32 v161, 0xffff0000, v156
  v_fma_f32 v160, v160, s84, v168
  v_fma_f32 v161, v161, s85, v169
  v_cvt_pk_bf16_f32 v156, v160, v161
  s_waitcnt lgkmcnt(8)
  v_mfma_f32_32x32x16_bf16 v[64:79], v[44:47], v[116:119], v[64:79]
  ds_read_b64_tr_b16 v[36:37], v17 offset:16384
  ds_read_b64_tr_b16 v[38:39], v17 offset:18432
  v_lshlrev_b32 v162, 16, v157
  v_and_b32 v163, 0xffff0000, v157
  v_fma_f32 v162, v162, s86, v170
  v_fma_f32 v163, v163, s87, v171
  s_add_u32 s38, s32, 77824
  buffer_load_dwordx4 v[148:151], v253, s[20:23], s38 offen
  s_waitcnt lgkmcnt(8)
  v_mfma_f32_32x32x16_bf16 v[80:95], v[128:131], v[116:119], v[80:95]
  ds_read_b64_tr_b16 v[40:41], v18 offset:16384
  ds_read_b64_tr_b16 v[42:43], v18 offset:18432
  v_cvt_pk_bf16_f32 v157, v162, v163
  v_lshlrev_b32 v164, 16, v158
  v_and_b32 v165, 0xffff0000, v158
  v_fma_f32 v164, v164, s88, v172
  s_waitcnt lgkmcnt(8)
  v_mfma_f32_32x32x16_bf16 v[96:111], v[132:135], v[116:119], v[96:111]
  ds_read_b64_tr_b16 v[44:45], v19 offset:16384
  ds_read_b64_tr_b16 v[46:47], v19 offset:18432
  v_fma_f32 v165, v165, s89, v173
  v_cvt_pk_bf16_f32 v158, v164, v165
  v_lshlrev_b32 v166, 16, v159
  v_and_b32 v167, 0xffff0000, v159
  s_add_u32 m0, s30, 16384
  s_add_u32 s38, s34, 1572864
  buffer_load_dwordx4 v3, s[4:7], s38 offen lds
  s_waitcnt lgkmcnt(6)
  v_mfma_f32_32x32x16_bf16 v[48:63], v[32:35], v[120:123], v[48:63]
  ds_read_b64_tr_b16 v[128:129], v16 offset:24576
  ds_read_b64_tr_b16 v[130:131], v16 offset:26624
  ds_read_b128 v[124:127], v13 offset:3072
  v_fma_f32 v166, v166, s90, v174
  v_fma_f32 v167, v167, s91, v175
  v_cvt_pk_bf16_f32 v159, v166, v167
  ds_write_b128 v252, v[156:159] offset:8192
  s_waitcnt lgkmcnt(8)
  v_mfma_f32_32x32x16_bf16 v[64:79], v[36:39], v[120:123], v[64:79]
  ds_read_b64_tr_b16 v[132:133], v17 offset:24576
  ds_read_b64_tr_b16 v[134:135], v17 offset:26624
  s_waitcnt lgkmcnt(8)
  v_mfma_f32_32x32x16_bf16 v[80:95], v[40:43], v[120:123], v[80:95]
  ds_read_b64_tr_b16 v[32:33], v18 offset:24576
  ds_read_b64_tr_b16 v[34:35], v18 offset:26624
  s_add_u32 m0, s30, 24576
  s_add_u32 s38, s34, 1703936
  buffer_load_dwordx4 v3, s[4:7], s38 offen lds
  s_waitcnt lgkmcnt(8)
  v_mfma_f32_32x32x16_bf16 v[96:111], v[44:47], v[120:123], v[96:111]
  ds_read_b64_tr_b16 v[36:37], v19 offset:24576
  ds_read_b64_tr_b16 v[38:39], v19 offset:26624
  s_waitcnt lgkmcnt(7)
  v_mfma_f32_32x32x16_bf16 v[48:63], v[128:131], v[124:127], v[48:63]
  s_waitcnt vmcnt(4)
  s_waitcnt lgkmcnt(0)
  s_barrier
  v_add_u32 v13, 49152, v13
  v_add_u32 v16, 49152, v16
  v_add_u32 v17, 49152, v17
  v_add_u32 v18, 49152, v18
  v_add_u32 v19, 49152, v19
  ds_read_b64_tr_b16 v[40:41], v16 offset:0
  ds_read_b64_tr_b16 v[42:43], v16 offset:2048
  ds_read_b128 v[112:115], v13 offset:0
  s_add_u32 s46, s47, 2048
  s_load_dwordx16 s[84:99], s[20:21], s46
  v_mov_b32 v168, s72
  v_mov_b32 v169, s73
  v_mov_b32 v170, s74
  v_mfma_f32_32x32x16_bf16 v[64:79], v[132:135], v[124:127], v[64:79]
  ds_read_b64_tr_b16 v[44:45], v17 offset:0
  ds_read_b64_tr_b16 v[46:47], v17 offset:2048
  v_mov_b32 v171, s75
  v_mov_b32 v172, s76
  v_mov_b32 v173, s77
  v_mov_b32 v174, s78
  s_add_u32 m0, s30, 32768
  s_add_u32 s38, s34, 1835008
  buffer_load_dwordx4 v3, s[4:7], s38 offen lds
  v_mfma_f32_32x32x16_bf16 v[80:95], v[32:35], v[124:127], v[80:95]
  ds_read_b64_tr_b16 v[128:129], v18 offset:0
  ds_read_b64_tr_b16 v[130:131], v18 offset:2048
  v_mov_b32 v175, s79
  v_add_u32 v252, 4294868992, v252
  v_lshlrev_b32 v160, 16, v136
  v_and_b32 v161, 0xffff0000, v136
  v_mfma_f32_32x32x16_bf16 v[96:111], v[36:39], v[124:127], v[96:111]
  ds_read_b64_tr_b16 v[132:133], v19 offset:0
  ds_read_b64_tr_b16 v[134:135], v19 offset:2048
  v_fma_f32 v160, v160, s64, v168
  v_fma_f32 v161, v161, s65, v169
  v_cvt_pk_bf16_f32 v136, v160, v161
  v_lshlrev_b32 v162, 16, v137
  s_add_u32 m0, s30, 40960
  s_add_u32 s38, s34, 1966080
  buffer_load_dwordx4 v3, s[4:7], s38 offen lds
  s_waitcnt lgkmcnt(6)
  v_mfma_f32_32x32x16_bf16 v[48:63], v[40:43], v[112:115], v[48:63]
  ds_read_b64_tr_b16 v[32:33], v16 offset:8192
  ds_read_b64_tr_b16 v[34:35], v16 offset:10240
  ds_read_b128 v[116:119], v13 offset:1024
  v_and_b32 v163, 0xffff0000, v137
  v_fma_f32 v162, v162, s66, v170
  v_fma_f32 v163, v163, s67, v171
  v_cvt_pk_bf16_f32 v137, v162, v163
  s_waitcnt lgkmcnt(7)
  v_mfma_f32_32x32x16_bf16 v[64:79], v[44:47], v[112:115], v[64:79]
  ds_read_b64_tr_b16 v[36:37], v17 offset:8192
  ds_read_b64_tr_b16 v[38:39], v17 offset:10240
  v_lshlrev_b32 v164, 16, v138
  v_and_b32 v165, 0xffff0000, v138
  v_fma_f32 v164, v164, s68, v172
  v_fma_f32 v165, v165, s69, v173
  s_waitcnt lgkmcnt(7)
  v_mfma_f32_32x32x16_bf16 v[80:95], v[128:131], v[112:115], v[80:95]
  ds_read_b64_tr_b16 v[40:41], v18 offset:8192
  ds_read_b64_tr_b16 v[42:43], v18 offset:10240
  v_cvt_pk_bf16_f32 v138, v164, v165
  v_lshlrev_b32 v166, 16, v139
  v_and_b32 v167, 0xffff0000, v139
  v_fma_f32 v166, v166, s70, v174
  s_add_u32 s38, s32, 5120
  buffer_load_dwordx4 v[152:155], v253, s[20:23], s38 offen
  s_waitcnt lgkmcnt(7)
  v_mfma_f32_32x32x16_bf16 v[96:111], v[132:135], v[112:115], v[96:111]
  ds_read_b64_tr_b16 v[44:45], v19 offset:8192
  ds_read_b64_tr_b16 v[46:47], v19 offset:10240
  v_fma_f32 v167, v167, s71, v175
  v_cvt_pk_bf16_f32 v139, v166, v167
  ds_write_b128 v252, v[136:139] offset:0
  v_lshlrev_b32 v160, 16, v140
  s_waitcnt lgkmcnt(7)
  v_mfma_f32_32x32x16_bf16 v[48:63], v[32:35], v[116:119], v[48:63]
  ds_read_b64_tr_b16 v[128:129], v16 offset:16384
  ds_read_b64_tr_b16 v[130:131], v16 offset:18432
  ds_read_b128 v[120:123], v13 offset:2048
  v_and_b32 v161, 0xffff0000, v140
  v_fma_f32 v160, v160, s64, v168
  v_fma_f32 v161, v161, s65, v169
  v_cvt_pk_bf16_f32 v140, v160, v161
  s_waitcnt lgkmcnt(8)
  v_mfma_f32_32x32x16_bf16 v[64:79], v[36:39], v[116:119], v[64:79]
  ds_read_b64_tr_b16 v[132:133], v17 offset:16384
  ds_read_b64_tr_b16 v[134:135], v17 offset:18432
  v_lshlrev_b32 v162, 16, v141
  v_and_b32 v163, 0xffff0000, v141
  v_fma_f32 v162, v162, s66, v170
  v_fma_f32 v163, v163, s67, v171
  s_add_u32 s38, s32, 78848
  buffer_load_dwordx4 v[156:159], v253, s[20:23], s38 offen
  s_waitcnt lgkmcnt(8)
  v_mfma_f32_32x32x16_bf16 v[80:95], v[40:43], v[116:119], v[80:95]
  ds_read_b64_tr_b16 v[32:33], v18 offset:16384
  ds_read_b64_tr_b16 v[34:35], v18 offset:18432
  v_cvt_pk_bf16_f32 v141, v162, v163
  v_lshlrev_b32 v164, 16, v142
  v_and_b32 v165, 0xffff0000, v142
  v_fma_f32 v164, v164, s68, v172
  s_waitcnt lgkmcnt(8)
  v_mfma_f32_32x32x16_bf16 v[96:111], v[44:47], v[116:119], v[96:111]
  ds_read_b64_tr_b16 v[36:37], v19 offset:16384
  ds_read_b64_tr_b16 v[38:39], v19 offset:18432
  v_fma_f32 v165, v165, s69, v173
  v_cvt_pk_bf16_f32 v142, v164, v165
  v_lshlrev_b32 v166, 16, v143
  v_and_b32 v167, 0xffff0000, v143
  s_add_u32 m0, s30, 65536
  s_add_u32 s38, s34, 2097152
  buffer_load_dwordx4 v3, s[4:7], s38 offen lds
  s_waitcnt lgkmcnt(6)
  v_mfma_f32_32x32x16_bf16 v[48:63], v[128:131], v[120:123], v[48:63]
  ds_read_b64_tr_b16 v[40:41], v16 offset:24576
  ds_read_b64_tr_b16 v[42:43], v16 offset:26624
  ds_read_b128 v[124:127], v13 offset:3072
  v_fma_f32 v166, v166, s70, v174
  v_fma_f32 v167, v167, s71, v175
  v_cvt_pk_bf16_f32 v143, v166, v167
  ds_write_b128 v252, v[140:143] offset:8192
  s_waitcnt lgkmcnt(8)
  v_mfma_f32_32x32x16_bf16 v[64:79], v[132:135], v[120:123], v[64:79]
  ds_read_b64_tr_b16 v[44:45], v17 offset:24576
  ds_read_b64_tr_b16 v[46:47], v17 offset:26624
  s_waitcnt lgkmcnt(8)
  v_mfma_f32_32x32x16_bf16 v[80:95], v[32:35], v[120:123], v[80:95]
  ds_read_b64_tr_b16 v[128:129], v18 offset:24576
  ds_read_b64_tr_b16 v[130:131], v18 offset:26624
  s_add_u32 m0, s30, 73728
  s_add_u32 s38, s34, 2228224
  buffer_load_dwordx4 v3, s[4:7], s38 offen lds
  s_waitcnt lgkmcnt(8)
  v_mfma_f32_32x32x16_bf16 v[96:111], v[36:39], v[120:123], v[96:111]
  ds_read_b64_tr_b16 v[132:133], v19 offset:24576
  ds_read_b64_tr_b16 v[134:135], v19 offset:26624
  s_waitcnt lgkmcnt(7)
  v_mfma_f32_32x32x16_bf16 v[48:63], v[40:43], v[124:127], v[48:63]
  s_waitcnt vmcnt(4)
  s_waitcnt lgkmcnt(0)
  s_barrier
  v_add_u32 v13, 4294868992, v13
  v_add_u32 v16, 4294868992, v16
  v_add_u32 v17, 4294868992, v17
  v_add_u32 v18, 4294868992, v18
  v_add_u32 v19, 4294868992, v19
  ds_read_b64_tr_b16 v[32:33], v16 offset:0
  ds_read_b64_tr_b16 v[34:35], v16 offset:2048
  ds_read_b128 v[112:115], v13 offset:0
  s_add_u32 s46, s47, 2560
  s_load_dwordx16 s[64:79], s[20:21], s46
  v_mov_b32 v168, s92
  v_mov_b32 v169, s93
  v_mov_b32 v170, s94
  v_mfma_f32_32x32x16_bf16 v[64:79], v[44:47], v[124:127], v[64:79]
  ds_read_b64_tr_b16 v[36:37], v17 offset:0
  ds_read_b64_tr_b16 v[38:39], v17 offset:2048
  v_mov_b32 v171, s95
  v_mov_b32 v172, s96
  v_mov_b32 v173, s97
  v_mov_b32 v174, s98
  s_add_u32 m0, s30, 81920
  s_add_u32 s38, s34, 2359296
  buffer_load_dwordx4 v3, s[4:7], s38 offen lds
  v_mfma_f32_32x32x16_bf16 v[80:95], v[128:131], v[124:127], v[80:95]
  ds_read_b64_tr_b16 v[40:41], v18 offset:0
  ds_read_b64_tr_b16 v[42:43], v18 offset:2048
  v_mov_b32 v175, s99
  v_add_u32 v252, 49152, v252
  v_lshlrev_b32 v160, 16, v144
  v_and_b32 v161, 0xffff0000, v144
  v_mfma_f32_32x32x16_bf16 v[96:111], v[132:135], v[124:127], v[96:111]
  ds_read_b64_tr_b16 v[44:45], v19 offset:0
  ds_read_b64_tr_b16 v[46:47], v19 offset:2048
  v_fma_f32 v160, v160, s84, v168
  v_fma_f32 v161, v161, s85, v169
  v_cvt_pk_bf16_f32 v144, v160, v161
  v_lshlrev_b32 v162, 16, v145
  s_add_u32 m0, s30, 90112
  s_add_u32 s38, s34, 2490368
  buffer_load_dwordx4 v3, s[4:7], s38 offen lds
  s_waitcnt lgkmcnt(6)
  v_mfma_f32_32x32x16_bf16 v[48:63], v[32:35], v[112:115], v[48:63]
  ds_read_b64_tr_b16 v[128:129], v16 offset:8192
  ds_read_b64_tr_b16 v[130:131], v16 offset:10240
  ds_read_b128 v[116:119], v13 offset:1024
  v_and_b32 v163, 0xffff0000, v145
  v_fma_f32 v162, v162, s86, v170
  v_fma_f32 v163, v163, s87, v171
  v_cvt_pk_bf16_f32 v145, v162, v163
  s_waitcnt lgkmcnt(7)
  v_mfma_f32_32x32x16_bf16 v[64:79], v[36:39], v[112:115], v[64:79]
  ds_read_b64_tr_b16 v[132:133], v17 offset:8192
  ds_read_b64_tr_b16 v[134:135], v17 offset:10240
  v_lshlrev_b32 v164, 16, v146
  v_and_b32 v165, 0xffff0000, v146
  v_fma_f32 v164, v164, s88, v172
  v_fma_f32 v165, v165, s89, v173
  s_waitcnt lgkmcnt(7)
  v_mfma_f32_32x32x16_bf16 v[80:95], v[40:43], v[112:115], v[80:95]
  ds_read_b64_tr_b16 v[32:33], v18 offset:8192
  ds_read_b64_tr_b16 v[34:35], v18 offset:10240
  v_cvt_pk_bf16_f32 v146, v164, v165
  v_lshlrev_b32 v166, 16, v147
  v_and_b32 v167, 0xffff0000, v147
  v_fma_f32 v166, v166, s90, v174
  s_add_u32 s38, s32, 6144
  buffer_load_dwordx4 v[136:139], v253, s[20:23], s38 offen
  s_waitcnt lgkmcnt(7)
  v_mfma_f32_32x32x16_bf16 v[96:111], v[44:47], v[112:115], v[96:111]
  ds_read_b64_tr_b16 v[36:37], v19 offset:8192
  ds_read_b64_tr_b16 v[38:39], v19 offset:10240
  v_fma_f32 v167, v167, s91, v175
  v_cvt_pk_bf16_f32 v147, v166, v167
  ds_write_b128 v252, v[144:147] offset:0
  v_lshlrev_b32 v160, 16, v148
  s_waitcnt lgkmcnt(7)
  v_mfma_f32_32x32x16_bf16 v[48:63], v[128:131], v[116:119], v[48:63]
  ds_read_b64_tr_b16 v[40:41], v16 offset:16384
  ds_read_b64_tr_b16 v[42:43], v16 offset:18432
  ds_read_b128 v[120:123], v13 offset:2048
  v_and_b32 v161, 0xffff0000, v148
  v_fma_f32 v160, v160, s84, v168
  v_fma_f32 v161, v161, s85, v169
  v_cvt_pk_bf16_f32 v148, v160, v161
  s_waitcnt lgkmcnt(8)
  v_mfma_f32_32x32x16_bf16 v[64:79], v[132:135], v[116:119], v[64:79]
  ds_read_b64_tr_b16 v[44:45], v17 offset:16384
  ds_read_b64_tr_b16 v[46:47], v17 offset:18432
  v_lshlrev_b32 v162, 16, v149
  v_and_b32 v163, 0xffff0000, v149
  v_fma_f32 v162, v162, s86, v170
  v_fma_f32 v163, v163, s87, v171
  s_add_u32 s38, s32, 79872
  buffer_load_dwordx4 v[140:143], v253, s[20:23], s38 offen
  s_waitcnt lgkmcnt(8)
  v_mfma_f32_32x32x16_bf16 v[80:95], v[32:35], v[116:119], v[80:95]
  ds_read_b64_tr_b16 v[128:129], v18 offset:16384
  ds_read_b64_tr_b16 v[130:131], v18 offset:18432
  v_cvt_pk_bf16_f32 v149, v162, v163
  v_lshlrev_b32 v164, 16, v150
  v_and_b32 v165, 0xffff0000, v150
  v_fma_f32 v164, v164, s88, v172
  s_waitcnt lgkmcnt(8)
  v_mfma_f32_32x32x16_bf16 v[96:111], v[36:39], v[116:119], v[96:111]
  ds_read_b64_tr_b16 v[132:133], v19 offset:16384
  ds_read_b64_tr_b16 v[134:135], v19 offset:18432
  v_fma_f32 v165, v165, s89, v173
  v_cvt_pk_bf16_f32 v150, v164, v165
  v_lshlrev_b32 v166, 16, v151
  v_and_b32 v167, 0xffff0000, v151
  s_add_u32 m0, s30, 114688
  s_add_u32 s38, s34, 2621440
  buffer_load_dwordx4 v3, s[4:7], s38 offen lds
  s_waitcnt lgkmcnt(6)
  v_mfma_f32_32x32x16_bf16 v[48:63], v[40:43], v[120:123], v[48:63]
  ds_read_b64_tr_b16 v[32:33], v16 offset:24576
  ds_read_b64_tr_b16 v[34:35], v16 offset:26624
  ds_read_b128 v[124:127], v13 offset:3072
  v_fma_f32 v166, v166, s90, v174
  v_fma_f32 v167, v167, s91, v175
  v_cvt_pk_bf16_f32 v151, v166, v167
  ds_write_b128 v252, v[148:151] offset:8192
  s_waitcnt lgkmcnt(8)
  v_mfma_f32_32x32x16_bf16 v[64:79], v[44:47], v[120:123], v[64:79]
  ds_read_b64_tr_b16 v[36:37], v17 offset:24576
  ds_read_b64_tr_b16 v[38:39], v17 offset:26624
  s_waitcnt lgkmcnt(8)
  v_mfma_f32_32x32x16_bf16 v[80:95], v[128:131], v[120:123], v[80:95]
  ds_read_b64_tr_b16 v[40:41], v18 offset:24576
  ds_read_b64_tr_b16 v[42:43], v18 offset:26624
  s_add_u32 m0, s30, 122880
  s_add_u32 s38, s34, 2752512
  buffer_load_dwordx4 v3, s[4:7], s38 offen lds
  s_waitcnt lgkmcnt(8)
  v_mfma_f32_32x32x16_bf16 v[96:111], v[132:135], v[120:123], v[96:111]
  ds_read_b64_tr_b16 v[44:45], v19 offset:24576
  ds_read_b64_tr_b16 v[46:47], v19 offset:26624
  s_waitcnt lgkmcnt(7)
  v_mfma_f32_32x32x16_bf16 v[48:63], v[32:35], v[124:127], v[48:63]
  s_waitcnt vmcnt(4)
  s_waitcnt lgkmcnt(0)
  s_barrier
  v_add_u32 v13, 49152, v13
  v_add_u32 v16, 49152, v16
  v_add_u32 v17, 49152, v17
  v_add_u32 v18, 49152, v18
  v_add_u32 v19, 49152, v19
  ds_read_b64_tr_b16 v[128:129], v16 offset:0
  ds_read_b64_tr_b16 v[130:131], v16 offset:2048
  ds_read_b128 v[112:115], v13 offset:0
  s_add_u32 s46, s47, 3072
  s_load_dwordx16 s[84:99], s[20:21], s46
  v_mov_b32 v168, s72
  v_mov_b32 v169, s73
  v_mov_b32 v170, s74
  v_mfma_f32_32x32x16_bf16 v[64:79], v[36:39], v[124:127], v[64:79]
  ds_read_b64_tr_b16 v[132:133], v17 offset:0
  ds_read_b64_tr_b16 v[134:135], v17 offset:2048
  v_mov_b32 v171, s75
  v_mov_b32 v172, s76
  v_mov_b32 v173, s77
  v_mov_b32 v174, s78
  s_add_u32 m0, s30, 131072
  s_add_u32 s38, s34, 2883584
  buffer_load_dwordx4 v3, s[4:7], s38 offen lds
  v_mfma_f32_32x32x16_bf16 v[80:95], v[40:43], v[124:127], v[80:95]
  ds_read_b64_tr_b16 v[32:33], v18 offset:0
  ds_read_b64_tr_b16 v[34:35], v18 offset:2048
  v_mov_b32 v175, s79
  v_add_u32 v252, 49152, v252
  v_lshlrev_b32 v160, 16, v152
  v_and_b32 v161, 0xffff0000, v152
  v_mfma_f32_32x32x16_bf16 v[96:111], v[44:47], v[124:127], v[96:111]
  ds_read_b64_tr_b16 v[36:37], v19 offset:0
  ds_read_b64_tr_b16 v[38:39], v19 offset:2048
  v_fma_f32 v160, v160, s64, v168
  v_fma_f32 v161, v161, s65, v169
  v_cvt_pk_bf16_f32 v152, v160, v161
  v_lshlrev_b32 v162, 16, v153
  s_add_u32 m0, s30, 139264
  s_add_u32 s38, s34, 3014656
  buffer_load_dwordx4 v3, s[4:7], s38 offen lds
  s_waitcnt lgkmcnt(6)
  v_mfma_f32_32x32x16_bf16 v[48:63], v[128:131], v[112:115], v[48:63]
  ds_read_b64_tr_b16 v[40:41], v16 offset:8192
  ds_read_b64_tr_b16 v[42:43], v16 offset:10240
  ds_read_b128 v[116:119], v13 offset:1024
  v_and_b32 v163, 0xffff0000, v153
  v_fma_f32 v162, v162, s66, v170
  v_fma_f32 v163, v163, s67, v171
  v_cvt_pk_bf16_f32 v153, v162, v163
  s_waitcnt lgkmcnt(7)
  v_mfma_f32_32x32x16_bf16 v[64:79], v[132:135], v[112:115], v[64:79]
  ds_read_b64_tr_b16 v[44:45], v17 offset:8192
  ds_read_b64_tr_b16 v[46:47], v17 offset:10240
  v_lshlrev_b32 v164, 16, v154
  v_and_b32 v165, 0xffff0000, v154
  v_fma_f32 v164, v164, s68, v172
  v_fma_f32 v165, v165, s69, v173
  s_waitcnt lgkmcnt(7)
  v_mfma_f32_32x32x16_bf16 v[80:95], v[32:35], v[112:115], v[80:95]
  ds_read_b64_tr_b16 v[128:129], v18 offset:8192
  ds_read_b64_tr_b16 v[130:131], v18 offset:10240
  v_cvt_pk_bf16_f32 v154, v164, v165
  v_lshlrev_b32 v166, 16, v155
  v_and_b32 v167, 0xffff0000, v155
  v_fma_f32 v166, v166, s70, v174
  s_add_u32 s38, s32, 7168
  buffer_load_dwordx4 v[144:147], v253, s[20:23], s38 offen
  s_waitcnt lgkmcnt(7)
  v_mfma_f32_32x32x16_bf16 v[96:111], v[36:39], v[112:115], v[96:111]
  ds_read_b64_tr_b16 v[132:133], v19 offset:8192
  ds_read_b64_tr_b16 v[134:135], v19 offset:10240
  v_fma_f32 v167, v167, s71, v175
  v_cvt_pk_bf16_f32 v155, v166, v167
  ds_write_b128 v252, v[152:155] offset:0
  v_lshlrev_b32 v160, 16, v156
  s_waitcnt lgkmcnt(7)
  v_mfma_f32_32x32x16_bf16 v[48:63], v[40:43], v[116:119], v[48:63]
  ds_read_b64_tr_b16 v[32:33], v16 offset:16384
  ds_read_b64_tr_b16 v[34:35], v16 offset:18432
  ds_read_b128 v[120:123], v13 offset:2048
  v_and_b32 v161, 0xffff0000, v156
  v_fma_f32 v160, v160, s64, v168
  v_fma_f32 v161, v161, s65, v169
  v_cvt_pk_bf16_f32 v156, v160, v161
  s_waitcnt lgkmcnt(8)
  v_mfma_f32_32x32x16_bf16 v[64:79], v[44:47], v[116:119], v[64:79]
  ds_read_b64_tr_b16 v[36:37], v17 offset:16384
  ds_read_b64_tr_b16 v[38:39], v17 offset:18432
  v_lshlrev_b32 v162, 16, v157
  v_and_b32 v163, 0xffff0000, v157
  v_fma_f32 v162, v162, s66, v170
  v_fma_f32 v163, v163, s67, v171
  s_add_u32 s38, s32, 80896
  buffer_load_dwordx4 v[148:151], v253, s[20:23], s38 offen
  s_waitcnt lgkmcnt(8)
  v_mfma_f32_32x32x16_bf16 v[80:95], v[128:131], v[116:119], v[80:95]
  ds_read_b64_tr_b16 v[40:41], v18 offset:16384
  ds_read_b64_tr_b16 v[42:43], v18 offset:18432
  v_cvt_pk_bf16_f32 v157, v162, v163
  v_lshlrev_b32 v164, 16, v158
  v_and_b32 v165, 0xffff0000, v158
  v_fma_f32 v164, v164, s68, v172
  s_waitcnt lgkmcnt(8)
  v_mfma_f32_32x32x16_bf16 v[96:111], v[132:135], v[116:119], v[96:111]
  ds_read_b64_tr_b16 v[44:45], v19 offset:16384
  ds_read_b64_tr_b16 v[46:47], v19 offset:18432
  v_fma_f32 v165, v165, s69, v173
  v_cvt_pk_bf16_f32 v158, v164, v165
  v_lshlrev_b32 v166, 16, v159
  v_and_b32 v167, 0xffff0000, v159
  s_add_u32 m0, s30, 16384
  s_add_u32 s38, s34, 3145728
  buffer_load_dwordx4 v3, s[4:7], s38 offen lds
  s_waitcnt lgkmcnt(6)
  v_mfma_f32_32x32x16_bf16 v[48:63], v[32:35], v[120:123], v[48:63]
  ds_read_b64_tr_b16 v[128:129], v16 offset:24576
  ds_read_b64_tr_b16 v[130:131], v16 offset:26624
  ds_read_b128 v[124:127], v13 offset:3072
  v_fma_f32 v166, v166, s70, v174
  v_fma_f32 v167, v167, s71, v175
  v_cvt_pk_bf16_f32 v159, v166, v167
  ds_write_b128 v252, v[156:159] offset:8192
  s_waitcnt lgkmcnt(8)
  v_mfma_f32_32x32x16_bf16 v[64:79], v[36:39], v[120:123], v[64:79]
  ds_read_b64_tr_b16 v[132:133], v17 offset:24576
  ds_read_b64_tr_b16 v[134:135], v17 offset:26624
  s_waitcnt lgkmcnt(8)
  v_mfma_f32_32x32x16_bf16 v[80:95], v[40:43], v[120:123], v[80:95]
  ds_read_b64_tr_b16 v[32:33], v18 offset:24576
  ds_read_b64_tr_b16 v[34:35], v18 offset:26624
  s_add_u32 m0, s30, 24576
  s_add_u32 s38, s34, 3276800
  buffer_load_dwordx4 v3, s[4:7], s38 offen lds
  s_waitcnt lgkmcnt(8)
  v_mfma_f32_32x32x16_bf16 v[96:111], v[44:47], v[120:123], v[96:111]
  ds_read_b64_tr_b16 v[36:37], v19 offset:24576
  ds_read_b64_tr_b16 v[38:39], v19 offset:26624
  s_waitcnt lgkmcnt(7)
  v_mfma_f32_32x32x16_bf16 v[48:63], v[128:131], v[124:127], v[48:63]
  s_waitcnt vmcnt(4)
  s_waitcnt lgkmcnt(0)
  s_barrier
  v_add_u32 v13, 49152, v13
  v_add_u32 v16, 49152, v16
  v_add_u32 v17, 49152, v17
  v_add_u32 v18, 49152, v18
  v_add_u32 v19, 49152, v19
  ds_read_b64_tr_b16 v[40:41], v16 offset:0
  ds_read_b64_tr_b16 v[42:43], v16 offset:2048
  ds_read_b128 v[112:115], v13 offset:0
  s_add_u32 s46, s47, 3584
  s_load_dwordx16 s[64:79], s[20:21], s46
  v_mov_b32 v168, s92
  v_mov_b32 v169, s93
  v_mov_b32 v170, s94
  v_mfma_f32_32x32x16_bf16 v[64:79], v[132:135], v[124:127], v[64:79]
  ds_read_b64_tr_b16 v[44:45], v17 offset:0
  ds_read_b64_tr_b16 v[46:47], v17 offset:2048
  v_mov_b32 v171, s95
  v_mov_b32 v172, s96
  v_mov_b32 v173, s97
  v_mov_b32 v174, s98
  s_add_u32 m0, s30, 32768
  s_add_u32 s38, s34, 3407872
  buffer_load_dwordx4 v3, s[4:7], s38 offen lds
  v_mfma_f32_32x32x16_bf16 v[80:95], v[32:35], v[124:127], v[80:95]
  ds_read_b64_tr_b16 v[128:129], v18 offset:0
  ds_read_b64_tr_b16 v[130:131], v18 offset:2048
  v_mov_b32 v175, s99
  v_add_u32 v252, 4294868992, v252
  v_lshlrev_b32 v160, 16, v136
  v_and_b32 v161, 0xffff0000, v136
  v_mfma_f32_32x32x16_bf16 v[96:111], v[36:39], v[124:127], v[96:111]
  ds_read_b64_tr_b16 v[132:133], v19 offset:0
  ds_read_b64_tr_b16 v[134:135], v19 offset:2048
  v_fma_f32 v160, v160, s84, v168
  v_fma_f32 v161, v161, s85, v169
  v_cvt_pk_bf16_f32 v136, v160, v161
  v_lshlrev_b32 v162, 16, v137
  s_add_u32 m0, s30, 40960
  s_add_u32 s38, s34, 3538944
  buffer_load_dwordx4 v3, s[4:7], s38 offen lds
  s_waitcnt lgkmcnt(6)
  v_mfma_f32_32x32x16_bf16 v[48:63], v[40:43], v[112:115], v[48:63]
  ds_read_b64_tr_b16 v[32:33], v16 offset:8192
  ds_read_b64_tr_b16 v[34:35], v16 offset:10240
  ds_read_b128 v[116:119], v13 offset:1024
  v_and_b32 v163, 0xffff0000, v137
  v_fma_f32 v162, v162, s86, v170
  v_fma_f32 v163, v163, s87, v171
  v_cvt_pk_bf16_f32 v137, v162, v163
  s_waitcnt lgkmcnt(7)
  v_mfma_f32_32x32x16_bf16 v[64:79], v[44:47], v[112:115], v[64:79]
  ds_read_b64_tr_b16 v[36:37], v17 offset:8192
  ds_read_b64_tr_b16 v[38:39], v17 offset:10240
  v_lshlrev_b32 v164, 16, v138
  v_and_b32 v165, 0xffff0000, v138
  v_fma_f32 v164, v164, s88, v172
  v_fma_f32 v165, v165, s89, v173
  s_waitcnt lgkmcnt(7)
  v_mfma_f32_32x32x16_bf16 v[80:95], v[128:131], v[112:115], v[80:95]
  ds_read_b64_tr_b16 v[40:41], v18 offset:8192
  ds_read_b64_tr_b16 v[42:43], v18 offset:10240
  v_cvt_pk_bf16_f32 v138, v164, v165
  v_lshlrev_b32 v166, 16, v139
  v_and_b32 v167, 0xffff0000, v139
  v_fma_f32 v166, v166, s90, v174
  s_add_u32 s38, s32, 8192
  buffer_load_dwordx4 v[152:155], v253, s[20:23], s38 offen
  s_waitcnt lgkmcnt(7)
  v_mfma_f32_32x32x16_bf16 v[96:111], v[132:135], v[112:115], v[96:111]
  ds_read_b64_tr_b16 v[44:45], v19 offset:8192
  ds_read_b64_tr_b16 v[46:47], v19 offset:10240
  v_fma_f32 v167, v167, s91, v175
  v_cvt_pk_bf16_f32 v139, v166, v167
  ds_write_b128 v252, v[136:139] offset:0
  v_lshlrev_b32 v160, 16, v140
  s_waitcnt lgkmcnt(7)
  v_mfma_f32_32x32x16_bf16 v[48:63], v[32:35], v[116:119], v[48:63]
  ds_read_b64_tr_b16 v[128:129], v16 offset:16384
  ds_read_b64_tr_b16 v[130:131], v16 offset:18432
  ds_read_b128 v[120:123], v13 offset:2048
  v_and_b32 v161, 0xffff0000, v140
  v_fma_f32 v160, v160, s84, v168
  v_fma_f32 v161, v161, s85, v169
  v_cvt_pk_bf16_f32 v140, v160, v161
  s_waitcnt lgkmcnt(8)
  v_mfma_f32_32x32x16_bf16 v[64:79], v[36:39], v[116:119], v[64:79]
  ds_read_b64_tr_b16 v[132:133], v17 offset:16384
  ds_read_b64_tr_b16 v[134:135], v17 offset:18432
  v_lshlrev_b32 v162, 16, v141
  v_and_b32 v163, 0xffff0000, v141
  v_fma_f32 v162, v162, s86, v170
  v_fma_f32 v163, v163, s87, v171
  s_add_u32 s38, s32, 81920
  buffer_load_dwordx4 v[156:159], v253, s[20:23], s38 offen
  s_waitcnt lgkmcnt(8)
  v_mfma_f32_32x32x16_bf16 v[80:95], v[40:43], v[116:119], v[80:95]
  ds_read_b64_tr_b16 v[32:33], v18 offset:16384
  ds_read_b64_tr_b16 v[34:35], v18 offset:18432
  v_cvt_pk_bf16_f32 v141, v162, v163
  v_lshlrev_b32 v164, 16, v142
  v_and_b32 v165, 0xffff0000, v142
  v_fma_f32 v164, v164, s88, v172
  s_waitcnt lgkmcnt(8)
  v_mfma_f32_32x32x16_bf16 v[96:111], v[44:47], v[116:119], v[96:111]
  ds_read_b64_tr_b16 v[36:37], v19 offset:16384
  ds_read_b64_tr_b16 v[38:39], v19 offset:18432
  v_fma_f32 v165, v165, s89, v173
  v_cvt_pk_bf16_f32 v142, v164, v165
  v_lshlrev_b32 v166, 16, v143
  v_and_b32 v167, 0xffff0000, v143
  s_add_u32 m0, s30, 65536
  s_add_u32 s38, s34, 3670016
  buffer_load_dwordx4 v3, s[4:7], s38 offen lds
  s_waitcnt lgkmcnt(6)
  v_mfma_f32_32x32x16_bf16 v[48:63], v[128:131], v[120:123], v[48:63]
  ds_read_b64_tr_b16 v[40:41], v16 offset:24576
  ds_read_b64_tr_b16 v[42:43], v16 offset:26624
  ds_read_b128 v[124:127], v13 offset:3072
  v_fma_f32 v166, v166, s90, v174
  v_fma_f32 v167, v167, s91, v175
  v_cvt_pk_bf16_f32 v143, v166, v167
  ds_write_b128 v252, v[140:143] offset:8192
  s_waitcnt lgkmcnt(8)
  v_mfma_f32_32x32x16_bf16 v[64:79], v[132:135], v[120:123], v[64:79]
  ds_read_b64_tr_b16 v[44:45], v17 offset:24576
  ds_read_b64_tr_b16 v[46:47], v17 offset:26624
  s_waitcnt lgkmcnt(8)
  v_mfma_f32_32x32x16_bf16 v[80:95], v[32:35], v[120:123], v[80:95]
  ds_read_b64_tr_b16 v[128:129], v18 offset:24576
  ds_read_b64_tr_b16 v[130:131], v18 offset:26624
  s_add_u32 m0, s30, 73728
  s_add_u32 s38, s34, 3801088
  buffer_load_dwordx4 v3, s[4:7], s38 offen lds
  s_waitcnt lgkmcnt(8)
  v_mfma_f32_32x32x16_bf16 v[96:111], v[36:39], v[120:123], v[96:111]
  ds_read_b64_tr_b16 v[132:133], v19 offset:24576
  ds_read_b64_tr_b16 v[134:135], v19 offset:26624
  s_waitcnt lgkmcnt(7)
  v_mfma_f32_32x32x16_bf16 v[48:63], v[40:43], v[124:127], v[48:63]
  s_waitcnt vmcnt(4)
  s_waitcnt lgkmcnt(0)
  s_barrier
  v_add_u32 v13, 4294868992, v13
  v_add_u32 v16, 4294868992, v16
  v_add_u32 v17, 4294868992, v17
  v_add_u32 v18, 4294868992, v18
  v_add_u32 v19, 4294868992, v19
  ds_read_b64_tr_b16 v[32:33], v16 offset:0
  ds_read_b64_tr_b16 v[34:35], v16 offset:2048
  ds_read_b128 v[112:115], v13 offset:0
  s_add_u32 s46, s47, 4096
  s_load_dwordx16 s[84:99], s[20:21], s46
  v_mov_b32 v168, s72
  v_mov_b32 v169, s73
  v_mov_b32 v170, s74
  v_mfma_f32_32x32x16_bf16 v[64:79], v[44:47], v[124:127], v[64:79]
  ds_read_b64_tr_b16 v[36:37], v17 offset:0
  ds_read_b64_tr_b16 v[38:39], v17 offset:2048
  v_mov_b32 v171, s75
  v_mov_b32 v172, s76
  v_mov_b32 v173, s77
  v_mov_b32 v174, s78
  s_add_u32 m0, s30, 81920
  s_add_u32 s38, s34, 3932160
  buffer_load_dwordx4 v3, s[4:7], s38 offen lds
  v_mfma_f32_32x32x16_bf16 v[80:95], v[128:131], v[124:127], v[80:95]
  ds_read_b64_tr_b16 v[40:41], v18 offset:0
  ds_read_b64_tr_b16 v[42:43], v18 offset:2048
  v_mov_b32 v175, s79
  v_add_u32 v252, 49152, v252
  v_lshlrev_b32 v160, 16, v144
  v_and_b32 v161, 0xffff0000, v144
  v_mfma_f32_32x32x16_bf16 v[96:111], v[132:135], v[124:127], v[96:111]
  ds_read_b64_tr_b16 v[44:45], v19 offset:0
  ds_read_b64_tr_b16 v[46:47], v19 offset:2048
  v_fma_f32 v160, v160, s64, v168
  v_fma_f32 v161, v161, s65, v169
  v_cvt_pk_bf16_f32 v144, v160, v161
  v_lshlrev_b32 v162, 16, v145
  s_add_u32 m0, s30, 90112
  s_add_u32 s38, s34, 4063232
  buffer_load_dwordx4 v3, s[4:7], s38 offen lds
  s_waitcnt lgkmcnt(6)
  v_mfma_f32_32x32x16_bf16 v[48:63], v[32:35], v[112:115], v[48:63]
  ds_read_b64_tr_b16 v[128:129], v16 offset:8192
  ds_read_b64_tr_b16 v[130:131], v16 offset:10240
  ds_read_b128 v[116:119], v13 offset:1024
  v_and_b32 v163, 0xffff0000, v145
  v_fma_f32 v162, v162, s66, v170
  v_fma_f32 v163, v163, s67, v171
  v_cvt_pk_bf16_f32 v145, v162, v163
  s_waitcnt lgkmcnt(7)
  v_mfma_f32_32x32x16_bf16 v[64:79], v[36:39], v[112:115], v[64:79]
  ds_read_b64_tr_b16 v[132:133], v17 offset:8192
  ds_read_b64_tr_b16 v[134:135], v17 offset:10240
  v_lshlrev_b32 v164, 16, v146
  v_and_b32 v165, 0xffff0000, v146
  v_fma_f32 v164, v164, s68, v172
  v_fma_f32 v165, v165, s69, v173
  s_waitcnt lgkmcnt(7)
  v_mfma_f32_32x32x16_bf16 v[80:95], v[40:43], v[112:115], v[80:95]
  ds_read_b64_tr_b16 v[32:33], v18 offset:8192
  ds_read_b64_tr_b16 v[34:35], v18 offset:10240
  v_cvt_pk_bf16_f32 v146, v164, v165
  v_lshlrev_b32 v166, 16, v147
  v_and_b32 v167, 0xffff0000, v147
  v_fma_f32 v166, v166, s70, v174
  s_add_u32 m0, s30, 0
  s_add_u32 s38, s35, 0
  buffer_load_dwordx4 v4, s[8:11], s38 offen lds
  s_waitcnt lgkmcnt(7)
  v_mfma_f32_32x32x16_bf16 v[96:111], v[44:47], v[112:115], v[96:111]
  ds_read_b64_tr_b16 v[36:37], v19 offset:8192
  ds_read_b64_tr_b16 v[38:39], v19 offset:10240
  v_fma_f32 v167, v167, s71, v175
  v_cvt_pk_bf16_f32 v147, v166, v167
  ds_write_b128 v252, v[144:147] offset:0
  v_lshlrev_b32 v160, 16, v148
  s_waitcnt lgkmcnt(7)
  v_mfma_f32_32x32x16_bf16 v[48:63], v[128:131], v[116:119], v[48:63]
  ds_read_b64_tr_b16 v[40:41], v16 offset:16384
  ds_read_b64_tr_b16 v[42:43], v16 offset:18432
  ds_read_b128 v[120:123], v13 offset:2048
  v_and_b32 v161, 0xffff0000, v148
  v_fma_f32 v160, v160, s64, v168
  v_fma_f32 v161, v161, s65, v169
  v_cvt_pk_bf16_f32 v148, v160, v161
  s_waitcnt lgkmcnt(8)
  v_mfma_f32_32x32x16_bf16 v[64:79], v[132:135], v[116:119], v[64:79]
  ds_read_b64_tr_b16 v[44:45], v17 offset:16384
  ds_read_b64_tr_b16 v[46:47], v17 offset:18432
  v_lshlrev_b32 v162, 16, v149
  v_and_b32 v163, 0xffff0000, v149
  v_fma_f32 v162, v162, s66, v170
  v_fma_f32 v163, v163, s67, v171
  s_add_u32 m0, s30, 8192
  s_add_u32 s38, s35, 8192
  buffer_load_dwordx4 v4, s[8:11], s38 offen lds
  s_waitcnt lgkmcnt(8)
  v_mfma_f32_32x32x16_bf16 v[80:95], v[32:35], v[116:119], v[80:95]
  ds_read_b64_tr_b16 v[128:129], v18 offset:16384
  ds_read_b64_tr_b16 v[130:131], v18 offset:18432
  v_cvt_pk_bf16_f32 v149, v162, v163
  v_lshlrev_b32 v164, 16, v150
  v_and_b32 v165, 0xffff0000, v150
  v_fma_f32 v164, v164, s68, v172
  s_waitcnt lgkmcnt(8)
  v_mfma_f32_32x32x16_bf16 v[96:111], v[36:39], v[116:119], v[96:111]
  ds_read_b64_tr_b16 v[132:133], v19 offset:16384
  ds_read_b64_tr_b16 v[134:135], v19 offset:18432
  v_fma_f32 v165, v165, s69, v173
  v_cvt_pk_bf16_f32 v150, v164, v165
  v_lshlrev_b32 v166, 16, v151
  v_and_b32 v167, 0xffff0000, v151
  s_add_u32 m0, s30, 114688
  s_add_u32 s38, s34, 4194304
  buffer_load_dwordx4 v3, s[4:7], s38 offen lds
  s_waitcnt lgkmcnt(6)
  v_mfma_f32_32x32x16_bf16 v[48:63], v[40:43], v[120:123], v[48:63]
  ds_read_b64_tr_b16 v[32:33], v16 offset:24576
  ds_read_b64_tr_b16 v[34:35], v16 offset:26624
  ds_read_b128 v[124:127], v13 offset:3072
  v_fma_f32 v166, v166, s70, v174
  v_fma_f32 v167, v167, s71, v175
  v_cvt_pk_bf16_f32 v151, v166, v167
  ds_write_b128 v252, v[148:151] offset:8192
  s_waitcnt lgkmcnt(8)
  v_mfma_f32_32x32x16_bf16 v[64:79], v[44:47], v[120:123], v[64:79]
  ds_read_b64_tr_b16 v[36:37], v17 offset:24576
  ds_read_b64_tr_b16 v[38:39], v17 offset:26624
  s_waitcnt lgkmcnt(8)
  v_mfma_f32_32x32x16_bf16 v[80:95], v[128:131], v[120:123], v[80:95]
  ds_read_b64_tr_b16 v[40:41], v18 offset:24576
  ds_read_b64_tr_b16 v[42:43], v18 offset:26624
  s_add_u32 m0, s30, 122880
  s_add_u32 s38, s34, 4325376
  buffer_load_dwordx4 v3, s[4:7], s38 offen lds
  s_waitcnt lgkmcnt(8)
  v_mfma_f32_32x32x16_bf16 v[96:111], v[132:135], v[120:123], v[96:111]
  ds_read_b64_tr_b16 v[44:45], v19 offset:24576
  ds_read_b64_tr_b16 v[46:47], v19 offset:26624
  s_waitcnt lgkmcnt(7)
  v_mfma_f32_32x32x16_bf16 v[48:63], v[32:35], v[124:127], v[48:63]
  s_waitcnt vmcnt(4)
  s_waitcnt lgkmcnt(0)
  s_barrier
  v_add_u32 v13, 49152, v13
  v_add_u32 v16, 49152, v16
  v_add_u32 v17, 49152, v17
  v_add_u32 v18, 49152, v18
  v_add_u32 v19, 49152, v19
  ds_read_b64_tr_b16 v[128:129], v16 offset:0
  ds_read_b64_tr_b16 v[130:131], v16 offset:2048
  ds_read_b128 v[112:115], v13 offset:0
  v_mov_b32 v168, s92
  v_mov_b32 v169, s93
  v_mov_b32 v170, s94
  v_mov_b32 v171, s95
  v_mfma_f32_32x32x16_bf16 v[64:79], v[36:39], v[124:127], v[64:79]
  ds_read_b64_tr_b16 v[132:133], v17 offset:0
  ds_read_b64_tr_b16 v[134:135], v17 offset:2048
  v_mov_b32 v172, s96
  v_mov_b32 v173, s97
  v_mov_b32 v174, s98
  v_mov_b32 v175, s99
  s_add_u32 m0, s30, 131072
  s_add_u32 s38, s34, 4456448
  buffer_load_dwordx4 v3, s[4:7], s38 offen lds
  v_mfma_f32_32x32x16_bf16 v[80:95], v[40:43], v[124:127], v[80:95]
  ds_read_b64_tr_b16 v[32:33], v18 offset:0
  ds_read_b64_tr_b16 v[34:35], v18 offset:2048
  v_add_u32 v252, 49152, v252
  v_lshlrev_b32 v160, 16, v152
  v_and_b32 v161, 0xffff0000, v152
  v_fma_f32 v160, v160, s84, v168
  v_mfma_f32_32x32x16_bf16 v[96:111], v[44:47], v[124:127], v[96:111]
  ds_read_b64_tr_b16 v[36:37], v19 offset:0
  ds_read_b64_tr_b16 v[38:39], v19 offset:2048
  v_fma_f32 v161, v161, s85, v169
  v_cvt_pk_bf16_f32 v152, v160, v161
  v_lshlrev_b32 v162, 16, v153
  v_and_b32 v163, 0xffff0000, v153
  s_add_u32 m0, s30, 139264
  s_add_u32 s38, s34, 4587520
  buffer_load_dwordx4 v3, s[4:7], s38 offen lds
  s_waitcnt lgkmcnt(6)
  v_mfma_f32_32x32x16_bf16 v[48:63], v[128:131], v[112:115], v[48:63]
  ds_read_b64_tr_b16 v[40:41], v16 offset:8192
  ds_read_b64_tr_b16 v[42:43], v16 offset:10240
  ds_read_b128 v[116:119], v13 offset:1024
  v_fma_f32 v162, v162, s86, v170
  v_fma_f32 v163, v163, s87, v171
  v_cvt_pk_bf16_f32 v153, v162, v163
  v_lshlrev_b32 v164, 16, v154
  s_waitcnt lgkmcnt(7)
  v_mfma_f32_32x32x16_bf16 v[64:79], v[132:135], v[112:115], v[64:79]
  ds_read_b64_tr_b16 v[44:45], v17 offset:8192
  ds_read_b64_tr_b16 v[46:47], v17 offset:10240
  v_and_b32 v165, 0xffff0000, v154
  v_fma_f32 v164, v164, s88, v172
  v_fma_f32 v165, v165, s89, v173
  v_cvt_pk_bf16_f32 v154, v164, v165
  s_waitcnt lgkmcnt(7)
  v_mfma_f32_32x32x16_bf16 v[80:95], v[32:35], v[112:115], v[80:95]
  ds_read_b64_tr_b16 v[128:129], v18 offset:8192
  ds_read_b64_tr_b16 v[130:131], v18 offset:10240
  v_lshlrev_b32 v166, 16, v155
  v_and_b32 v167, 0xffff0000, v155
  v_fma_f32 v166, v166, s90, v174
  v_fma_f32 v167, v167, s91, v175
  s_add_u32 m0, s30, 32768
  s_add_u32 s38, s35, 0
  buffer_load_dwordx4 v5, s[12:15], s38 offen lds
  s_waitcnt lgkmcnt(7)
  v_mfma_f32_32x32x16_bf16 v[96:111], v[36:39], v[112:115], v[96:111]
  ds_read_b64_tr_b16 v[132:133], v19 offset:8192
  ds_read_b64_tr_b16 v[134:135], v19 offset:10240
  v_cvt_pk_bf16_f32 v155, v166, v167
  ds_write_b128 v252, v[152:155] offset:0
  v_lshlrev_b32 v160, 16, v156
  v_and_b32 v161, 0xffff0000, v156
  s_waitcnt lgkmcnt(7)
  v_mfma_f32_32x32x16_bf16 v[48:63], v[40:43], v[116:119], v[48:63]
  ds_read_b64_tr_b16 v[32:33], v16 offset:16384
  ds_read_b64_tr_b16 v[34:35], v16 offset:18432
  ds_read_b128 v[120:123], v13 offset:2048
  v_fma_f32 v160, v160, s84, v168
  v_fma_f32 v161, v161, s85, v169
  v_cvt_pk_bf16_f32 v156, v160, v161
  v_lshlrev_b32 v162, 16, v157
  s_waitcnt lgkmcnt(8)
  v_mfma_f32_32x32x16_bf16 v[64:79], v[44:47], v[116:119], v[64:79]
  ds_read_b64_tr_b16 v[36:37], v17 offset:16384
  ds_read_b64_tr_b16 v[38:39], v17 offset:18432
  v_and_b32 v163, 0xffff0000, v157
  v_fma_f32 v162, v162, s86, v170
  v_fma_f32 v163, v163, s87, v171
  v_cvt_pk_bf16_f32 v157, v162, v163
  s_add_u32 m0, s30, 40960
  s_add_u32 s38, s35, 8192
  buffer_load_dwordx4 v5, s[12:15], s38 offen lds
  s_waitcnt lgkmcnt(8)
  v_mfma_f32_32x32x16_bf16 v[80:95], v[128:131], v[116:119], v[80:95]
  ds_read_b64_tr_b16 v[40:41], v18 offset:16384
  ds_read_b64_tr_b16 v[42:43], v18 offset:18432
  v_lshlrev_b32 v164, 16, v158
  v_and_b32 v165, 0xffff0000, v158
  v_fma_f32 v164, v164, s88, v172
  v_fma_f32 v165, v165, s89, v173
  s_waitcnt lgkmcnt(8)
  v_mfma_f32_32x32x16_bf16 v[96:111], v[132:135], v[116:119], v[96:111]
  ds_read_b64_tr_b16 v[44:45], v19 offset:16384
  ds_read_b64_tr_b16 v[46:47], v19 offset:18432
  v_cvt_pk_bf16_f32 v158, v164, v165
  v_lshlrev_b32 v166, 16, v159
  v_and_b32 v167, 0xffff0000, v159
  v_fma_f32 v166, v166, s90, v174
  s_add_u32 m0, s30, 49152
  s_add_u32 s38, s35, 16384
  buffer_load_dwordx4 v4, s[8:11], s38 offen lds
  s_waitcnt lgkmcnt(6)
  v_mfma_f32_32x32x16_bf16 v[48:63], v[32:35], v[120:123], v[48:63]
  ds_read_b64_tr_b16 v[128:129], v16 offset:24576
  ds_read_b64_tr_b16 v[130:131], v16 offset:26624
  ds_read_b128 v[124:127], v13 offset:3072
  v_fma_f32 v167, v167, s91, v175
  v_cvt_pk_bf16_f32 v159, v166, v167
  ds_write_b128 v252, v[156:159] offset:8192
  s_waitcnt lgkmcnt(8)
  v_mfma_f32_32x32x16_bf16 v[64:79], v[36:39], v[120:123], v[64:79]
  ds_read_b64_tr_b16 v[132:133], v17 offset:24576
  ds_read_b64_tr_b16 v[134:135], v17 offset:26624
  s_waitcnt lgkmcnt(8)
  v_mfma_f32_32x32x16_bf16 v[80:95], v[40:43], v[120:123], v[80:95]
  ds_read_b64_tr_b16 v[32:33], v18 offset:24576
  ds_read_b64_tr_b16 v[34:35], v18 offset:26624
  s_add_u32 m0, s30, 57344
  s_add_u32 s38, s35, 24576
  buffer_load_dwordx4 v4, s[8:11], s38 offen lds
  s_waitcnt lgkmcnt(8)
  v_mfma_f32_32x32x16_bf16 v[96:111], v[44:47], v[120:123], v[96:111]
  ds_read_b64_tr_b16 v[36:37], v19 offset:24576
  ds_read_b64_tr_b16 v[38:39], v19 offset:26624
  s_waitcnt lgkmcnt(7)
  v_mfma_f32_32x32x16_bf16 v[48:63], v[128:131], v[124:127], v[48:63]
  s_waitcnt vmcnt(4)
  s_waitcnt lgkmcnt(0)
  s_barrier
  v_add_u32 v13, 49152, v13
  v_add_u32 v16, 49152, v16
  v_add_u32 v17, 49152, v17
  v_add_u32 v18, 49152, v18
  v_add_u32 v19, 49152, v19
  ds_read_b64_tr_b16 v[40:41], v16 offset:0
  ds_read_b64_tr_b16 v[42:43], v16 offset:2048
  ds_read_b128 v[112:115], v13 offset:0
  v_mfma_f32_32x32x16_bf16 v[64:79], v[132:135], v[124:127], v[64:79]
  ds_read_b64_tr_b16 v[44:45], v17 offset:0
  ds_read_b64_tr_b16 v[46:47], v17 offset:2048
  s_add_u32 m0, s30, 65536
  s_add_u32 s38, s35, 16384
  buffer_load_dwordx4 v5, s[12:15], s38 offen lds
  v_mfma_f32_32x32x16_bf16 v[80:95], v[32:35], v[124:127], v[80:95]
  ds_read_b64_tr_b16 v[128:129], v18 offset:0
  ds_read_b64_tr_b16 v[130:131], v18 offset:2048
  v_mfma_f32_32x32x16_bf16 v[96:111], v[36:39], v[124:127], v[96:111]
  ds_read_b64_tr_b16 v[132:133], v19 offset:0
  ds_read_b64_tr_b16 v[134:135], v19 offset:2048
  s_add_u32 m0, s30, 73728
  s_add_u32 s38, s35, 24576
  buffer_load_dwordx4 v5, s[12:15], s38 offen lds
  s_waitcnt lgkmcnt(6)
  v_mfma_f32_32x32x16_bf16 v[48:63], v[40:43], v[112:115], v[48:63]
  ds_read_b64_tr_b16 v[32:33], v16 offset:8192
  ds_read_b64_tr_b16 v[34:35], v16 offset:10240
  ds_read_b128 v[116:119], v13 offset:1024
  s_waitcnt lgkmcnt(7)
  v_mfma_f32_32x32x16_bf16 v[64:79], v[44:47], v[112:115], v[64:79]
  ds_read_b64_tr_b16 v[36:37], v17 offset:8192
  ds_read_b64_tr_b16 v[38:39], v17 offset:10240
  s_waitcnt lgkmcnt(7)
  v_mfma_f32_32x32x16_bf16 v[80:95], v[128:131], v[112:115], v[80:95]
  ds_read_b64_tr_b16 v[40:41], v18 offset:8192
  ds_read_b64_tr_b16 v[42:43], v18 offset:10240
  s_add_u32 m0, s30, 81920
  s_add_u32 s38, s35, 32768
  buffer_load_dwordx4 v4, s[8:11], s38 offen lds
  s_waitcnt lgkmcnt(7)
  v_mfma_f32_32x32x16_bf16 v[96:111], v[132:135], v[112:115], v[96:111]
  ds_read_b64_tr_b16 v[44:45], v19 offset:8192
  ds_read_b64_tr_b16 v[46:47], v19 offset:10240
  s_waitcnt lgkmcnt(6)
  v_mfma_f32_32x32x16_bf16 v[48:63], v[32:35], v[116:119], v[48:63]
  ds_read_b64_tr_b16 v[128:129], v16 offset:16384
  ds_read_b64_tr_b16 v[130:131], v16 offset:18432
  ds_read_b128 v[120:123], v13 offset:2048
  s_waitcnt lgkmcnt(7)
  v_mfma_f32_32x32x16_bf16 v[64:79], v[36:39], v[116:119], v[64:79]
  ds_read_b64_tr_b16 v[132:133], v17 offset:16384
  ds_read_b64_tr_b16 v[134:135], v17 offset:18432
  s_add_u32 m0, s30, 90112
  s_add_u32 s38, s35, 40960
  buffer_load_dwordx4 v4, s[8:11], s38 offen lds
  s_waitcnt lgkmcnt(7)
  v_mfma_f32_32x32x16_bf16 v[80:95], v[40:43], v[116:119], v[80:95]
  ds_read_b64_tr_b16 v[32:33], v18 offset:16384
  ds_read_b64_tr_b16 v[34:35], v18 offset:18432
  s_waitcnt lgkmcnt(7)
  v_mfma_f32_32x32x16_bf16 v[96:111], v[44:47], v[116:119], v[96:111]
  ds_read_b64_tr_b16 v[36:37], v19 offset:16384
  ds_read_b64_tr_b16 v[38:39], v19 offset:18432
  s_waitcnt lgkmcnt(6)
  v_mfma_f32_32x32x16_bf16 v[48:63], v[128:131], v[120:123], v[48:63]
  ds_read_b64_tr_b16 v[40:41], v16 offset:24576
  ds_read_b64_tr_b16 v[42:43], v16 offset:26624
  ds_read_b128 v[124:127], v13 offset:3072
  s_waitcnt lgkmcnt(7)
  v_mfma_f32_32x32x16_bf16 v[64:79], v[132:135], v[120:123], v[64:79]
  ds_read_b64_tr_b16 v[44:45], v17 offset:24576
  ds_read_b64_tr_b16 v[46:47], v17 offset:26624
  s_waitcnt lgkmcnt(7)
  v_mfma_f32_32x32x16_bf16 v[80:95], v[32:35], v[120:123], v[80:95]
  ds_read_b64_tr_b16 v[128:129], v18 offset:24576
  ds_read_b64_tr_b16 v[130:131], v18 offset:26624
  s_waitcnt lgkmcnt(7)
  v_mfma_f32_32x32x16_bf16 v[96:111], v[36:39], v[120:123], v[96:111]
  ds_read_b64_tr_b16 v[132:133], v19 offset:24576
  ds_read_b64_tr_b16 v[134:135], v19 offset:26624
  s_waitcnt lgkmcnt(6)
  v_mfma_f32_32x32x16_bf16 v[48:63], v[40:43], v[124:127], v[48:63]
  s_waitcnt lgkmcnt(4)
  v_mfma_f32_32x32x16_bf16 v[64:79], v[44:47], v[124:127], v[64:79]
  s_waitcnt lgkmcnt(2)
  v_mfma_f32_32x32x16_bf16 v[80:95], v[128:131], v[124:127], v[80:95]
  s_waitcnt lgkmcnt(0)
  v_mfma_f32_32x32x16_bf16 v[96:111], v[132:135], v[124:127], v[96:111]
  s_barrier
  s_add_u32 m0, s30, 98304
  s_add_u32 s38, s35, 32768
  buffer_load_dwordx4 v5, s[12:15], s38 offen lds
  s_add_u32 m0, s30, 106496
  s_add_u32 s38, s35, 40960
  buffer_load_dwordx4 v5, s[12:15], s38 offen lds
  s_add_u32 m0, s30, 114688
  s_add_u32 s38, s35, 49152
  buffer_load_dwordx4 v4, s[8:11], s38 offen lds
  s_add_u32 m0, s30, 122880
  s_add_u32 s38, s35, 57344
  buffer_load_dwordx4 v4, s[8:11], s38 offen lds
  ds_read_b128 v[168:171], v24 offset:0
  ds_read_b128 v[172:175], v25 offset:0
  ds_read_b128 v[176:179], v26 offset:0
  ds_read_b128 v[180:183], v27 offset:0
  ds_read_b128 v[184:187], v28 offset:0
  ds_read_b128 v[188:191], v29 offset:0
  ds_read_b128 v[192:195], v30 offset:0
  ds_read_b128 v[196:199], v31 offset:0
  s_mov_b32 s38, 0x3e0293ee
  v_mul_f32 v48, s38, v48
  v_mul_f32 v49, s38, v49
  v_cvt_pk_bf16_f32 v224, v48, v49
  v_mul_f32 v50, s38, v50
  v_mul_f32 v51, s38, v51
  v_cvt_pk_bf16_f32 v225, v50, v51
  v_mul_f32 v52, s38, v52
  v_mul_f32 v53, s38, v53
  v_cvt_pk_bf16_f32 v226, v52, v53
  v_mul_f32 v54, s38, v54
  v_mul_f32 v55, s38, v55
  v_cvt_pk_bf16_f32 v227, v54, v55
  v_mul_f32 v56, s38, v56
  v_mul_f32 v57, s38, v57
  v_cvt_pk_bf16_f32 v228, v56, v57
  v_mul_f32 v58, s38, v58
  v_mul_f32 v59, s38, v59
  v_cvt_pk_bf16_f32 v229, v58, v59
  v_mul_f32 v60, s38, v60
  v_mul_f32 v61, s38, v61
  v_cvt_pk_bf16_f32 v230, v60, v61
  v_mul_f32 v62, s38, v62
  v_mul_f32 v63, s38, v63
  v_cvt_pk_bf16_f32 v231, v62, v63
  v_mul_f32 v64, s38, v64
  v_mul_f32 v65, s38, v65
  v_cvt_pk_bf16_f32 v232, v64, v65
  v_mul_f32 v66, s38, v66
  v_mul_f32 v67, s38, v67
  v_cvt_pk_bf16_f32 v233, v66, v67
  v_mul_f32 v68, s38, v68
  v_mul_f32 v69, s38, v69
  v_cvt_pk_bf16_f32 v234, v68, v69
  v_mul_f32 v70, s38, v70
  v_mul_f32 v71, s38, v71
  v_cvt_pk_bf16_f32 v235, v70, v71
  v_mul_f32 v72, s38, v72
  v_mul_f32 v73, s38, v73
  v_cvt_pk_bf16_f32 v236, v72, v73
  v_mul_f32 v74, s38, v74
  v_mul_f32 v75, s38, v75
  v_cvt_pk_bf16_f32 v237, v74, v75
  v_mul_f32 v76, s38, v76
  v_mul_f32 v77, s38, v77
  v_cvt_pk_bf16_f32 v238, v76, v77
  v_mul_f32 v78, s38, v78
  v_mul_f32 v79, s38, v79
  v_cvt_pk_bf16_f32 v239, v78, v79
  v_mul_f32 v80, s38, v80
  v_mul_f32 v81, s38, v81
  v_cvt_pk_bf16_f32 v240, v80, v81
  v_mul_f32 v82, s38, v82
  v_mul_f32 v83, s38, v83
  v_cvt_pk_bf16_f32 v241, v82, v83
  v_mul_f32 v84, s38, v84
  v_mul_f32 v85, s38, v85
  v_cvt_pk_bf16_f32 v242, v84, v85
  v_mul_f32 v86, s38, v86
  v_mul_f32 v87, s38, v87
  v_cvt_pk_bf16_f32 v243, v86, v87
  v_mul_f32 v88, s38, v88
  v_mul_f32 v89, s38, v89
  v_cvt_pk_bf16_f32 v244, v88, v89
  v_mul_f32 v90, s38, v90
  v_mul_f32 v91, s38, v91
  v_cvt_pk_bf16_f32 v245, v90, v91
  v_mul_f32 v92, s38, v92
  v_mul_f32 v93, s38, v93
  v_cvt_pk_bf16_f32 v246, v92, v93
  v_mul_f32 v94, s38, v94
  v_mul_f32 v95, s38, v95
  v_cvt_pk_bf16_f32 v247, v94, v95
  v_mul_f32 v96, s38, v96
  v_mul_f32 v97, s38, v97
  v_cvt_pk_bf16_f32 v248, v96, v97
  v_mul_f32 v98, s38, v98
  v_mul_f32 v99, s38, v99
  v_cvt_pk_bf16_f32 v249, v98, v99
  v_mul_f32 v100, s38, v100
  v_mul_f32 v101, s38, v101
  v_cvt_pk_bf16_f32 v250, v100, v101
  v_mul_f32 v102, s38, v102
  v_mul_f32 v103, s38, v103
  v_cvt_pk_bf16_f32 v251, v102, v103
  v_mul_f32 v104, s38, v104
  v_mul_f32 v105, s38, v105
  v_cvt_pk_bf16_f32 v252, v104, v105
  v_mul_f32 v106, s38, v106
  v_mul_f32 v107, s38, v107
  v_cvt_pk_bf16_f32 v253, v106, v107
  v_mul_f32 v108, s38, v108
  v_mul_f32 v109, s38, v109
  v_cvt_pk_bf16_f32 v254, v108, v109
  v_mul_f32 v110, s38, v110
  v_mul_f32 v111, s38, v111
  v_cvt_pk_bf16_f32 v255, v110, v111
  s_waitcnt lgkmcnt(4)
  v_mfma_f32_32x32x16_bf16 v[112:127], v[168:171], v[224:227], 0
  v_mov_b32 v48, 0
  v_mov_b32 v49, 0
  v_mov_b32 v50, 0
  v_mov_b32 v51, 0
  v_mov_b32 v52, 0
  v_mov_b32 v53, 0
  v_mov_b32 v54, 0
  v_mov_b32 v55, 0
  v_mfma_f32_32x32x16_bf16 v[112:127], v[172:175], v[228:231], v[112:127]
  v_mov_b32 v56, 0
  v_mov_b32 v57, 0
  v_mov_b32 v58, 0
  v_mov_b32 v59, 0
  v_mov_b32 v60, 0
  v_mov_b32 v61, 0
  v_mov_b32 v62, 0
  v_mov_b32 v63, 0
  v_mfma_f32_32x32x16_bf16 v[112:127], v[176:179], v[232:235], v[112:127]
  v_mov_b32 v64, 0
  v_mov_b32 v65, 0
  v_mov_b32 v66, 0
  v_mov_b32 v67, 0
  v_mov_b32 v68, 0
  v_mov_b32 v69, 0
  v_mov_b32 v70, 0
  v_mov_b32 v71, 0
  v_mfma_f32_32x32x16_bf16 v[112:127], v[180:183], v[236:239], v[112:127]
  v_mov_b32 v72, 0
  v_mov_b32 v73, 0
  v_mov_b32 v74, 0
  v_mov_b32 v75, 0
  v_mov_b32 v76, 0
  v_mov_b32 v77, 0
  v_mov_b32 v78, 0
  v_mov_b32 v79, 0
  s_waitcnt lgkmcnt(0)
  v_mfma_f32_32x32x16_bf16 v[112:127], v[184:187], v[240:243], v[112:127]
  v_mov_b32 v80, 0
  v_mov_b32 v81, 0
  v_mov_b32 v82, 0
  v_mov_b32 v83, 0
  v_mov_b32 v84, 0
  v_mov_b32 v85, 0
  v_mov_b32 v86, 0
  v_mov_b32 v87, 0
  v_mfma_f32_32x32x16_bf16 v[112:127], v[188:191], v[244:247], v[112:127]
  v_mov_b32 v88, 0
  v_mov_b32 v89, 0
  v_mov_b32 v90, 0
  v_mov_b32 v91, 0
  v_mov_b32 v92, 0
  v_mov_b32 v93, 0
  v_mov_b32 v94, 0
  v_mov_b32 v95, 0
  v_mfma_f32_32x32x16_bf16 v[112:127], v[192:195], v[248:251], v[112:127]
  v_mov_b32 v96, 0
  v_mov_b32 v97, 0
  v_mov_b32 v98, 0
  v_mov_b32 v99, 0
  v_mov_b32 v100, 0
  v_mov_b32 v101, 0
  v_mov_b32 v102, 0
  v_mov_b32 v103, 0
  v_mfma_f32_32x32x16_bf16 v[112:127], v[196:199], v[252:255], v[112:127]
  v_mov_b32 v104, 0
  v_mov_b32 v105, 0
  v_mov_b32 v106, 0
  v_mov_b32 v107, 0
  v_mov_b32 v108, 0
  v_mov_b32 v109, 0
  v_mov_b32 v110, 0
  v_mov_b32 v111, 0
  ds_read_b128 v[168:171], v24 offset:8192
  ds_read_b128 v[172:175], v25 offset:8192
  ds_read_b128 v[176:179], v26 offset:8192
  ds_read_b128 v[180:183], v27 offset:8192
  ds_read_b128 v[184:187], v28 offset:8192
  ds_read_b128 v[188:191], v29 offset:8192
  ds_read_b128 v[192:195], v30 offset:8192
  ds_read_b128 v[196:199], v31 offset:8192
  v_mov_b32 v7, 0
  s_mov_b32 s27, 0
  s_mov_b32 s39, 0x41f00000
  v_add_u32 v24, 147456, v24
  v_add_u32 v25, 147456, v25
  v_add_u32 v26, 147456, v26
  v_add_u32 v27, 147456, v27
  v_add_u32 v28, 147456, v28
  v_add_u32 v29, 147456, v29
  v_add_u32 v30, 147456, v30
  v_add_u32 v31, 147456, v31
  v_max3_f32 v8, v112, v113, v114
  v_max3_f32 v9, v115, v116, v117
  v_max3_f32 v8, v8, v118, v119
  v_max3_f32 v9, v9, v120, v121
  v_max3_f32 v8, v8, v122, v123
  v_max3_f32 v9, v9, v124, v125
  v_max3_f32 v8, v8, v126, v127
  v_max_f32 v8, v8, v9
  v_mov_b32 v9, v8
  s_nop 1
  v_permlane32_swap_b32 v8, v9
  v_max_f32 v8, v8, v9
  v_sub_f32 v112, v112, v8
  v_sub_f32 v144, 0, v8
  v_sub_f32 v113, v113, v8
  v_sub_f32 v145, 0, v8
  v_sub_f32 v114, v114, v8
  v_sub_f32 v146, 0, v8
  v_sub_f32 v115, v115, v8
  v_sub_f32 v147, 0, v8
  v_sub_f32 v116, v116, v8
  v_sub_f32 v148, 0, v8
  v_sub_f32 v117, v117, v8
  v_sub_f32 v149, 0, v8
  v_sub_f32 v118, v118, v8
  v_sub_f32 v150, 0, v8
  v_sub_f32 v119, v119, v8
  v_sub_f32 v151, 0, v8
  v_sub_f32 v120, v120, v8
  v_sub_f32 v152, 0, v8
  v_sub_f32 v121, v121, v8
  v_sub_f32 v153, 0, v8
  v_sub_f32 v122, v122, v8
  v_sub_f32 v154, 0, v8
  v_sub_f32 v123, v123, v8
  v_sub_f32 v155, 0, v8
  v_sub_f32 v124, v124, v8
  v_sub_f32 v156, 0, v8
  v_sub_f32 v125, v125, v8
  v_sub_f32 v157, 0, v8
  v_sub_f32 v126, v126, v8
  v_sub_f32 v158, 0, v8
  v_sub_f32 v127, v127, v8
  v_sub_f32 v159, 0, v8
  s_mov_b32 s40, 131072
  s_add_u32 s42, s35, 49152
  s_add_u32 s43, s35, 65536
  s_movk_i32 s46, 8192
  s_movk_i32 s47, 16384
  s_lshl_b32 s37, s2, 3
  s_add_u32 s37, s37, s24
  s_movk_i32 s38, 48
  s_cmp_ge_u32 s37, 683
  s_cselect_b32 s38, 56, s38
  s_cselect_b32 s44, 683, 0
  s_cmp_ge_u32 s37, 1366
  s_cselect_b32 s38, 64, s38
  s_cselect_b32 s44, 1366, s44
  s_sub_u32 s37, s37, s44
  s_mul_i32 s37, s37, 7808
  s_load_dwordx2 s[4:5], s[0:1], s38
  s_mov_b32 s6, 5308416
  v_lshlrev_b32 v216, 7, v1
  s_mul_i32 s38, s26, 18432
  s_add_u32 s38, s38, s36
  s_mul_i32 s44, s24, 2304
  s_add_u32 s38, s38, s44
  s_mov_b64 exec, 0x3ffff
  buffer_load_dword v217, v216, s[16:19], s38 offen
  s_mov_b64 exec, -1
  v_add_u32 v216, s37, v216
k2_att_loop:
  s_waitcnt lgkmcnt(4)
  v_mfma_f32_32x32x16_bf16 v[128:143], v[168:171], v[224:227], v[144:159]
  v_exp_f32 v112, v112
  v_exp_f32 v113, v113
  v_exp_f32 v114, v114
  v_mfma_f32_32x32x16_bf16 v[128:143], v[172:175], v[228:231], v[128:143]
  v_cvt_pk_bf16_f32 v160, v112, v113
  v_exp_f32 v115, v115
  v_exp_f32 v116, v116
  v_cvt_pk_bf16_f32 v161, v114, v115
  s_add_u32 s44, s40, 32768
  s_cmp_eq_u32 s44, 163840
  s_cselect_b32 s44, 32768, s44
  s_sub_u32 s45, s44, s40
  s_add_u32 s41, s40, s30
  s_mov_b32 s40, s44
  v_add_u32 v20, s45, v20
  v_add_u32 v21, s45, v21
  v_add_u32 v22, s45, v22
  v_add_u32 v23, s45, v23
  s_cmp_ge_u32 s27, 4
  s_cbranch_scc1 k2_att_sw
k2_att_swb:
  s_waitcnt vmcnt(9) lgkmcnt(0)
  s_barrier
  v_mfma_f32_32x32x16_bf16 v[128:143], v[176:179], v[232:235], v[128:143]
  v_exp_f32 v117, v117
  ds_read_b64_tr_b16 v[34:35], v20 offset:2048
  ds_read_b64_tr_b16 v[32:33], v20 offset:0
  v_add_u32 v24, s45, v24
  v_exp_f32 v118, v118
  v_cvt_pk_bf16_f32 v162, v116, v117
  v_mfma_f32_32x32x16_bf16 v[128:143], v[180:183], v[236:239], v[128:143]
  v_add_u32 v25, s45, v25
  ds_read_b64_tr_b16 v[38:39], v21 offset:2048
  ds_read_b64_tr_b16 v[36:37], v21 offset:0
  v_exp_f32 v119, v119
  v_exp_f32 v120, v120
  v_add_f32 v10, v112, v113
  v_mfma_f32_32x32x16_bf16 v[128:143], v[184:187], v[240:243], v[128:143]
  s_add_u32 m0, s41, 0
  s_nop 0
  buffer_load_dwordx4 v5, s[12:15], s42 offen lds
  ds_read_b64_tr_b16 v[42:43], v22 offset:2048
  ds_read_b64_tr_b16 v[40:41], v22 offset:0
  v_mfma_f32_32x32x16_bf16 v[128:143], v[188:191], v[244:247], v[128:143]
  v_cvt_pk_bf16_f32 v163, v118, v119
  ds_read_b64_tr_b16 v[46:47], v23 offset:2048
  ds_read_b64_tr_b16 v[44:45], v23 offset:0
  v_exp_f32 v121, v121
  v_add_u32 v26, s45, v26
  v_exp_f32 v122, v122
  v_mfma_f32_32x32x16_bf16 v[128:143], v[192:195], v[248:251], v[128:143]
  v_add_f32 v7, v7, v114
  ds_read_b64_tr_b16 v[202:203], v20 offset:6144
  ds_read_b64_tr_b16 v[200:201], v20 offset:4096
  v_add_u32 v27, s45, v27
  v_cvt_pk_bf16_f32 v164, v120, v121
  v_exp_f32 v123, v123
  v_exp_f32 v124, v124
  v_mfma_f32_32x32x16_bf16 v[128:143], v[196:199], v[252:255], v[128:143]
  v_add_u32 v28, s45, v28
  ds_read_b64_tr_b16 v[206:207], v21 offset:6144
  ds_read_b64_tr_b16 v[204:205], v21 offset:4096
  v_add_f32 v10, v10, v115
  v_cvt_pk_bf16_f32 v165, v122, v123
  v_add_u32 v29, s45, v29
  v_exp_f32 v125, v125
  s_waitcnt lgkmcnt(8)
  v_mfma_f32_32x32x16_bf16 v[48:63], v[32:35], v[160:163], v[48:63]
  v_exp_f32 v126, v126
  ds_read_b128 v[168:171], v24 offset:0
  ds_read_b64_tr_b16 v[210:211], v22 offset:6144
  ds_read_b64_tr_b16 v[208:209], v22 offset:4096
  s_add_u32 m0, s41, 8192
  s_add_u32 s38, s42, s46
  s_add_u32 s42, s42, s47
  buffer_load_dwordx4 v5, s[12:15], s38 offen lds
  v_mfma_f32_32x32x16_bf16 v[64:79], v[36:39], v[160:163], v[64:79]
  v_add_f32 v7, v7, v116
  ds_read_b128 v[172:175], v25 offset:0
  ds_read_b64_tr_b16 v[214:215], v23 offset:6144
  ds_read_b64_tr_b16 v[212:213], v23 offset:4096
  v_cvt_pk_bf16_f32 v166, v124, v125
  v_exp_f32 v127, v127
  s_waitcnt lgkmcnt(10)
  v_mfma_f32_32x32x16_bf16 v[80:95], v[40:43], v[160:163], v[80:95]
  v_add_u32 v30, s45, v30
  ds_read_b128 v[176:179], v26 offset:0
  v_add_f32 v10, v10, v117
  v_cvt_pk_bf16_f32 v167, v126, v127
  v_add_u32 v31, s45, v31
  v_add_f32 v7, v7, v118
  v_mfma_f32_32x32x16_bf16 v[96:111], v[44:47], v[160:163], v[96:111]
  v_add_f32 v10, v10, v119
  ds_read_b128 v[180:183], v27 offset:0
  v_add_f32 v7, v7, v120
  v_add_f32 v10, v10, v121
  v_add_f32 v7, v7, v122
  s_waitcnt lgkmcnt(8)
  v_mfma_f32_32x32x16_bf16 v[48:63], v[200:203], v[164:167], v[48:63]
  v_add_f32 v10, v10, v123
  ds_read_b128 v[184:187], v28 offset:0
  v_add_f32 v7, v7, v124
  v_add_f32 v10, v10, v125
  v_add_f32 v7, v7, v126
  v_mfma_f32_32x32x16_bf16 v[64:79], v[204:207], v[164:167], v[64:79]
  v_add_f32 v10, v10, v127
  ds_read_b128 v[188:191], v29 offset:0
  v_add_f32 v7, v7, v10
  v_max3_f32 v8, v128, v129, v130
  s_waitcnt lgkmcnt(4)
  v_mfma_f32_32x32x16_bf16 v[80:95], v[208:211], v[164:167], v[80:95]
  v_max3_f32 v9, v131, v132, v133
  ds_read_b128 v[192:195], v30 offset:0
  v_max3_f32 v8, v8, v134, v135
  v_max3_f32 v9, v9, v136, v137
  v_max3_f32 v8, v8, v138, v139
  v_mfma_f32_32x32x16_bf16 v[96:111], v[212:215], v[164:167], v[96:111]
  v_max3_f32 v9, v9, v140, v141
  ds_read_b128 v[196:199], v31 offset:0
  v_max3_f32 v8, v8, v142, v143
  v_max_f32 v8, v8, v9
  v_cmp_lt_f32 vcc, s39, v8
  s_cbranch_vccnz k2_rare_3
k2_back_4:
  s_waitcnt lgkmcnt(4)
  v_mfma_f32_32x32x16_bf16 v[112:127], v[168:171], v[224:227], v[144:159]
  v_exp_f32 v128, v128
  ds_read_b64_tr_b16 v[34:35], v20 offset:10240
  ds_read_b64_tr_b16 v[32:33], v20 offset:8192
  v_exp_f32 v129, v129
  v_exp_f32 v130, v130
  v_mfma_f32_32x32x16_bf16 v[112:127], v[172:175], v[228:231], v[112:127]
  v_cvt_pk_bf16_f32 v160, v128, v129
  ds_read_b64_tr_b16 v[38:39], v21 offset:10240
  ds_read_b64_tr_b16 v[36:37], v21 offset:8192
  v_exp_f32 v131, v131
  v_exp_f32 v132, v132
  v_cvt_pk_bf16_f32 v161, v130, v131
  v_mfma_f32_32x32x16_bf16 v[112:127], v[176:179], v[232:235], v[112:127]
  v_exp_f32 v133, v133
  ds_read_b64_tr_b16 v[40:41], v22 offset:8192
  v_exp_f32 v134, v134
  v_cvt_pk_bf16_f32 v162, v132, v133
  v_exp_f32 v135, v135
  v_mfma_f32_32x32x16_bf16 v[112:127], v[180:183], v[236:239], v[112:127]
  s_add_u32 m0, s41, 16384
  s_nop 0
  buffer_load_dwordx4 v4, s[8:11], s43 offen lds
  ds_read_b64_tr_b16 v[44:45], v23 offset:8192
  ds_read_b64_tr_b16 v[42:43], v22 offset:10240
  s_waitcnt lgkmcnt(7)
  v_mfma_f32_32x32x16_bf16 v[112:127], v[184:187], v[240:243], v[112:127]
  v_exp_f32 v136, v136
  ds_read_b64_tr_b16 v[46:47], v23 offset:10240
  v_add_f32 v10, v128, v129
  v_cvt_pk_bf16_f32 v163, v134, v135
  v_exp_f32 v137, v137
  v_mfma_f32_32x32x16_bf16 v[112:127], v[188:191], v[244:247], v[112:127]
  v_exp_f32 v138, v138
  ds_read_b64_tr_b16 v[202:203], v20 offset:14336
  ds_read_b64_tr_b16 v[200:201], v20 offset:12288
  v_add_f32 v7, v7, v130
  v_cvt_pk_bf16_f32 v164, v136, v137
  v_mfma_f32_32x32x16_bf16 v[112:127], v[192:195], v[248:251], v[112:127]
  v_exp_f32 v139, v139
  ds_read_b64_tr_b16 v[206:207], v21 offset:14336
  ds_read_b64_tr_b16 v[204:205], v21 offset:12288
  s_add_u32 m0, s41, 24576
  s_add_u32 s38, s43, s46
  s_add_u32 s43, s43, s47
  buffer_load_dwordx4 v4, s[8:11], s38 offen lds
  v_mfma_f32_32x32x16_bf16 v[112:127], v[196:199], v[252:255], v[112:127]
  v_exp_f32 v140, v140
  ds_read_b64_tr_b16 v[208:209], v22 offset:12288
  v_add_f32 v10, v10, v131
  v_cvt_pk_bf16_f32 v165, v138, v139
  s_waitcnt lgkmcnt(9)
  v_mfma_f32_32x32x16_bf16 v[48:63], v[32:35], v[160:163], v[48:63]
  v_exp_f32 v141, v141
  ds_read_b128 v[168:171], v24 offset:8192
  ds_read_b64_tr_b16 v[212:213], v23 offset:12288
  ds_read_b64_tr_b16 v[210:211], v22 offset:14336
  v_exp_f32 v142, v142
  v_add_f32 v7, v7, v132
  v_cvt_pk_bf16_f32 v166, v140, v141
  v_mfma_f32_32x32x16_bf16 v[64:79], v[36:39], v[160:163], v[64:79]
  s_mov_b64 exec, 0x1ff
  buffer_load_dword v217, v216, s[4:7], 0 offen
  s_mov_b64 exec, -1
  v_add_u32 v216, 0x480, v216
  ds_read_b128 v[172:175], v25 offset:8192
  ds_read_b64_tr_b16 v[214:215], v23 offset:14336
  s_waitcnt lgkmcnt(10)
  v_mfma_f32_32x32x16_bf16 v[80:95], v[40:43], v[160:163], v[80:95]
  v_exp_f32 v143, v143
  ds_read_b128 v[176:179], v26 offset:8192
  v_add_f32 v10, v10, v133
  v_cvt_pk_bf16_f32 v167, v142, v143
  v_add_f32 v7, v7, v134
  v_mfma_f32_32x32x16_bf16 v[96:111], v[44:47], v[160:163], v[96:111]
  v_add_f32 v10, v10, v135
  ds_read_b128 v[180:183], v27 offset:8192
  v_add_f32 v7, v7, v136
  v_add_f32 v10, v10, v137
  v_add_f32 v7, v7, v138
  s_waitcnt lgkmcnt(8)
  v_mfma_f32_32x32x16_bf16 v[48:63], v[200:203], v[164:167], v[48:63]
  v_add_f32 v10, v10, v139
  ds_read_b128 v[184:187], v28 offset:8192
  v_add_f32 v7, v7, v140
  v_add_f32 v10, v10, v141
  v_add_f32 v7, v7, v142
  v_mfma_f32_32x32x16_bf16 v[64:79], v[204:207], v[164:167], v[64:79]
  v_add_f32 v10, v10, v143
  ds_read_b128 v[188:191], v29 offset:8192
  v_add_f32 v7, v7, v10
  v_max3_f32 v8, v112, v113, v114
  s_waitcnt lgkmcnt(4)
  v_mfma_f32_32x32x16_bf16 v[80:95], v[208:211], v[164:167], v[80:95]
  v_max3_f32 v9, v115, v116, v117
  ds_read_b128 v[192:195], v30 offset:8192
  v_max3_f32 v8, v8, v118, v119
  v_max3_f32 v9, v9, v120, v121
  v_max3_f32 v8, v8, v122, v123
  v_mfma_f32_32x32x16_bf16 v[96:111], v[212:215], v[164:167], v[96:111]
  v_max3_f32 v9, v9, v124, v125
  ds_read_b128 v[196:199], v31 offset:8192
  v_max3_f32 v8, v8, v126, v127
  v_max_f32 v8, v8, v9
  v_cmp_lt_f32 vcc, s39, v8
  s_cbranch_vccnz k2_rare_5
k2_back_6:
  s_add_u32 s27, s27, 1
  s_cmp_lt_u32 s27, 7
  s_cbranch_scc1 k2_att_loop
  s_waitcnt lgkmcnt(4)
  v_mfma_f32_32x32x16_bf16 v[128:143], v[168:171], v[224:227], v[144:159]
  v_exp_f32 v112, v112
  v_exp_f32 v113, v113
  v_exp_f32 v114, v114
  v_mfma_f32_32x32x16_bf16 v[128:143], v[172:175], v[228:231], v[128:143]
  v_cvt_pk_bf16_f32 v160, v112, v113
  v_exp_f32 v115, v115
  v_exp_f32 v116, v116
  v_cvt_pk_bf16_f32 v161, v114, v115
  s_add_u32 s44, s40, 32768
  s_cmp_eq_u32 s44, 163840
  s_cselect_b32 s44, 32768, s44
  s_sub_u32 s45, s44, s40
  s_add_u32 s41, s40, s30
  s_mov_b32 s40, s44
  v_add_u32 v20, s45, v20
  v_add_u32 v21, s45, v21
  v_add_u32 v22, s45, v22
  v_add_u32 v23, s45, v23
  s_waitcnt vmcnt(9) lgkmcnt(0)
  s_barrier
  v_mfma_f32_32x32x16_bf16 v[128:143], v[176:179], v[232:235], v[128:143]
  v_exp_f32 v117, v117
  ds_read_b64_tr_b16 v[34:35], v20 offset:2048
  ds_read_b64_tr_b16 v[32:33], v20 offset:0
  v_add_u32 v24, s45, v24
  v_exp_f32 v118, v118
  v_cvt_pk_bf16_f32 v162, v116, v117
  v_mfma_f32_32x32x16_bf16 v[128:143], v[180:183], v[236:239], v[128:143]
  v_add_u32 v25, s45, v25
  ds_read_b64_tr_b16 v[38:39], v21 offset:2048
  ds_read_b64_tr_b16 v[36:37], v21 offset:0
  v_exp_f32 v119, v119
  v_exp_f32 v120, v120
  v_add_f32 v10, v112, v113
  v_mfma_f32_32x32x16_bf16 v[128:143], v[184:187], v[240:243], v[128:143]
  s_add_u32 m0, s41, 0
  s_nop 0
  buffer_load_dwordx4 v5, s[12:15], s42 offen lds
  ds_read_b64_tr_b16 v[42:43], v22 offset:2048
  ds_read_b64_tr_b16 v[40:41], v22 offset:0
  v_mfma_f32_32x32x16_bf16 v[128:143], v[188:191], v[244:247], v[128:143]
  v_cvt_pk_bf16_f32 v163, v118, v119
  ds_read_b64_tr_b16 v[46:47], v23 offset:2048
  ds_read_b64_tr_b16 v[44:45], v23 offset:0
  v_exp_f32 v121, v121
  v_add_u32 v26, s45, v26
  v_exp_f32 v122, v122
  v_mfma_f32_32x32x16_bf16 v[128:143], v[192:195], v[248:251], v[128:143]
  v_add_f32 v7, v7, v114
  ds_read_b64_tr_b16 v[202:203], v20 offset:6144
  ds_read_b64_tr_b16 v[200:201], v20 offset:4096
  v_add_u32 v27, s45, v27
  v_cvt_pk_bf16_f32 v164, v120, v121
  v_exp_f32 v123, v123
  v_exp_f32 v124, v124
  v_mfma_f32_32x32x16_bf16 v[128:143], v[196:199], v[252:255], v[128:143]
  v_add_u32 v28, s45, v28
  ds_read_b64_tr_b16 v[206:207], v21 offset:6144
  ds_read_b64_tr_b16 v[204:205], v21 offset:4096
  v_add_f32 v10, v10, v115
  v_cvt_pk_bf16_f32 v165, v122, v123
  v_add_u32 v29, s45, v29
  v_exp_f32 v125, v125
  s_waitcnt lgkmcnt(8)
  v_mfma_f32_32x32x16_bf16 v[48:63], v[32:35], v[160:163], v[48:63]
  v_exp_f32 v126, v126
  ds_read_b64_tr_b16 v[210:211], v22 offset:6144
  ds_read_b64_tr_b16 v[208:209], v22 offset:4096
  s_add_u32 m0, s41, 8192
  s_add_u32 s38, s42, s46
  s_add_u32 s42, s42, s47
  buffer_load_dwordx4 v5, s[12:15], s38 offen lds
  v_mfma_f32_32x32x16_bf16 v[64:79], v[36:39], v[160:163], v[64:79]
  v_add_f32 v7, v7, v116
  ds_read_b64_tr_b16 v[214:215], v23 offset:6144
  ds_read_b64_tr_b16 v[212:213], v23 offset:4096
  v_cvt_pk_bf16_f32 v166, v124, v125
  v_exp_f32 v127, v127
  s_waitcnt lgkmcnt(8)
  v_mfma_f32_32x32x16_bf16 v[80:95], v[40:43], v[160:163], v[80:95]
  v_add_u32 v30, s45, v30
  v_add_f32 v10, v10, v117
  v_cvt_pk_bf16_f32 v167, v126, v127
  v_add_u32 v31, s45, v31
  v_add_f32 v7, v7, v118
  v_mfma_f32_32x32x16_bf16 v[96:111], v[44:47], v[160:163], v[96:111]
  v_add_f32 v10, v10, v119
  v_add_f32 v7, v7, v120
  v_add_f32 v10, v10, v121
  v_add_f32 v7, v7, v122
  s_waitcnt lgkmcnt(4)
  v_mfma_f32_32x32x16_bf16 v[48:63], v[200:203], v[164:167], v[48:63]
  v_add_f32 v10, v10, v123
  v_add_f32 v7, v7, v124
  v_add_f32 v10, v10, v125
  v_add_f32 v7, v7, v126
  v_mfma_f32_32x32x16_bf16 v[64:79], v[204:207], v[164:167], v[64:79]
  v_add_f32 v10, v10, v127
  v_add_f32 v7, v7, v10
  v_max3_f32 v8, v128, v129, v130
  s_waitcnt lgkmcnt(0)
  v_mfma_f32_32x32x16_bf16 v[80:95], v[208:211], v[164:167], v[80:95]
  v_max3_f32 v9, v131, v132, v133
  v_max3_f32 v8, v8, v134, v135
  v_max3_f32 v9, v9, v136, v137
  v_max3_f32 v8, v8, v138, v139
  v_mfma_f32_32x32x16_bf16 v[96:111], v[212:215], v[164:167], v[96:111]
  v_max3_f32 v9, v9, v140, v141
  v_max3_f32 v8, v8, v142, v143
  v_max_f32 v8, v8, v9
  v_cmp_lt_f32 vcc, s39, v8
  s_cbranch_vccnz k2_rare_7
k2_back_8:
  v_exp_f32 v128, v128
  ds_read_b64_tr_b16 v[34:35], v20 offset:10240
  ds_read_b64_tr_b16 v[32:33], v20 offset:8192
  v_exp_f32 v129, v129
  v_exp_f32 v130, v130
  v_cvt_pk_bf16_f32 v160, v128, v129
  ds_read_b64_tr_b16 v[38:39], v21 offset:10240
  ds_read_b64_tr_b16 v[36:37], v21 offset:8192
  v_exp_f32 v131, v131
  v_exp_f32 v132, v132
  v_cvt_pk_bf16_f32 v161, v130, v131
  ds_read_b64_tr_b16 v[40:41], v22 offset:8192
  v_exp_f32 v133, v133
  v_exp_f32 v134, v134
  v_cvt_pk_bf16_f32 v162, v132, v133
  ds_read_b64_tr_b16 v[44:45], v23 offset:8192
  ds_read_b64_tr_b16 v[42:43], v22 offset:10240
  v_exp_f32 v135, v135
  v_exp_f32 v136, v136
  v_add_f32 v10, v128, v129
  s_add_u32 m0, s41, 16384
  s_nop 0
  buffer_load_dwordx4 v4, s[8:11], s43 offen lds
  ds_read_b64_tr_b16 v[46:47], v23 offset:10240
  v_cvt_pk_bf16_f32 v163, v134, v135
  ds_read_b64_tr_b16 v[202:203], v20 offset:14336
  ds_read_b64_tr_b16 v[200:201], v20 offset:12288
  v_exp_f32 v137, v137
  v_exp_f32 v138, v138
  v_add_f32 v7, v7, v130
  ds_read_b64_tr_b16 v[206:207], v21 offset:14336
  ds_read_b64_tr_b16 v[204:205], v21 offset:12288
  v_cvt_pk_bf16_f32 v164, v136, v137
  v_exp_f32 v139, v139
  v_exp_f32 v140, v140
  ds_read_b64_tr_b16 v[208:209], v22 offset:12288
  v_add_f32 v10, v10, v131
  v_cvt_pk_bf16_f32 v165, v138, v139
  v_exp_f32 v141, v141
  s_waitcnt lgkmcnt(9)
  v_mfma_f32_32x32x16_bf16 v[48:63], v[32:35], v[160:163], v[48:63]
  v_exp_f32 v142, v142
  ds_read_b64_tr_b16 v[212:213], v23 offset:12288
  ds_read_b64_tr_b16 v[210:211], v22 offset:14336
  s_add_u32 m0, s41, 24576
  s_add_u32 s38, s43, s46
  s_add_u32 s43, s43, s47
  buffer_load_dwordx4 v4, s[8:11], s38 offen lds
  v_mfma_f32_32x32x16_bf16 v[64:79], v[36:39], v[160:163], v[64:79]
  v_add_f32 v7, v7, v132
  ds_read_b64_tr_b16 v[214:215], v23 offset:14336
  v_cvt_pk_bf16_f32 v166, v140, v141
  s_waitcnt lgkmcnt(8)
  v_mfma_f32_32x32x16_bf16 v[80:95], v[40:43], v[160:163], v[80:95]
  v_exp_f32 v143, v143
  v_add_f32 v10, v10, v133
  v_cvt_pk_bf16_f32 v167, v142, v143
  v_add_f32 v7, v7, v134
  s_waitcnt lgkmcnt(0)
  s_barrier
  v_mfma_f32_32x32x16_bf16 v[96:111], v[44:47], v[160:163], v[96:111]
  v_add_f32 v10, v10, v135
  v_add_f32 v7, v7, v136
  v_mfma_f32_32x32x16_bf16 v[48:63], v[200:203], v[164:167], v[48:63]
  v_add_f32 v10, v10, v137
  v_add_f32 v7, v7, v138
  v_mfma_f32_32x32x16_bf16 v[64:79], v[204:207], v[164:167], v[64:79]
  v_add_f32 v10, v10, v139
  v_add_f32 v7, v7, v140
  v_mfma_f32_32x32x16_bf16 v[80:95], v[208:211], v[164:167], v[80:95]
  v_add_f32 v10, v10, v141
  v_add_f32 v7, v7, v142
  v_mfma_f32_32x32x16_bf16 v[96:111], v[212:215], v[164:167], v[96:111]
  v_add_f32 v10, v10, v143
  v_add_f32 v7, v7, v10
  v_mov_b32 v9, v7
  s_nop 1
  v_permlane32_swap_b32 v7, v9
  v_add_f32 v7, v7, v9
  v_rcp_f32 v7, v7
  s_lshl_b32 s38, s28, 13
  s_lshl_b32 s37, s29, 17
  s_add_u32 s38, s38, s37
  v_add_u32 v13, s38, v14
  s_xor_b32 s38, s38, 131072
  v_add_u32 v14, s38, v14
  s_lshl_b32 s38, s29, 14
  s_add_u32 s38, s38, 32768
  v_add_u32 v16, s38, v15
  v_xor_b32 v17, 0x4000, v16
  v_mul_f32 v48, v7, v48
  v_mul_f32 v49, v7, v49
  v_cvt_pk_bf16_f32 v112, v48, v49
  v_mul_f32 v50, v7, v50
  v_mul_f32 v51, v7, v51
  v_cvt_pk_bf16_f32 v113, v50, v51
  v_mul_f32 v52, v7, v52
  v_mul_f32 v53, v7, v53
  v_cvt_pk_bf16_f32 v114, v52, v53
  v_mul_f32 v54, v7, v54
  v_mul_f32 v55, v7, v55
  v_cvt_pk_bf16_f32 v115, v54, v55
  ds_write_b128 v13, v[112:115] offset:0
  v_mul_f32 v56, v7, v56
  v_mul_f32 v57, v7, v57
  v_cvt_pk_bf16_f32 v116, v56, v57
  v_mul_f32 v58, v7, v58
  v_mul_f32 v59, v7, v59
  v_cvt_pk_bf16_f32 v117, v58, v59
  v_mul_f32 v60, v7, v60
  v_mul_f32 v61, v7, v61
  v_cvt_pk_bf16_f32 v118, v60, v61
  v_mul_f32 v62, v7, v62
  v_mul_f32 v63, v7, v63
  v_cvt_pk_bf16_f32 v119, v62, v63
  ds_write_b128 v13, v[116:119] offset:1024
  v_mul_f32 v64, v7, v64
  v_mul_f32 v65, v7, v65
  v_cvt_pk_bf16_f32 v120, v64, v65
  v_mul_f32 v66, v7, v66
  v_mul_f32 v67, v7, v67
  v_cvt_pk_bf16_f32 v121, v66, v67
  v_mul_f32 v68, v7, v68
  v_mul_f32 v69, v7, v69
  v_cvt_pk_bf16_f32 v122, v68, v69
  v_mul_f32 v70, v7, v70
  v_mul_f32 v71, v7, v71
  v_cvt_pk_bf16_f32 v123, v70, v71
  ds_write_b128 v13, v[120:123] offset:2048
  v_mul_f32 v72, v7, v72
  v_mul_f32 v73, v7, v73
  v_cvt_pk_bf16_f32 v124, v72, v73
  v_mul_f32 v74, v7, v74
  v_mul_f32 v75, v7, v75
  v_cvt_pk_bf16_f32 v125, v74, v75
  v_mul_f32 v76, v7, v76
  v_mul_f32 v77, v7, v77
  v_cvt_pk_bf16_f32 v126, v76, v77
  v_mul_f32 v78, v7, v78
  v_mul_f32 v79, v7, v79
  v_cvt_pk_bf16_f32 v127, v78, v79
  ds_write_b128 v13, v[124:127] offset:3072
  v_mul_f32 v80, v7, v80
  v_mul_f32 v81, v7, v81
  v_cvt_pk_bf16_f32 v128, v80, v81
  v_mul_f32 v82, v7, v82
  v_mul_f32 v83, v7, v83
  v_cvt_pk_bf16_f32 v129, v82, v83
  v_mul_f32 v84, v7, v84
  v_mul_f32 v85, v7, v85
  v_cvt_pk_bf16_f32 v130, v84, v85
  v_mul_f32 v86, v7, v86
  v_mul_f32 v87, v7, v87
  v_cvt_pk_bf16_f32 v131, v86, v87
  ds_write_b128 v13, v[128:131] offset:4096
  v_mul_f32 v88, v7, v88
  v_mul_f32 v89, v7, v89
  v_cvt_pk_bf16_f32 v132, v88, v89
  v_mul_f32 v90, v7, v90
  v_mul_f32 v91, v7, v91
  v_cvt_pk_bf16_f32 v133, v90, v91
  v_mul_f32 v92, v7, v92
  v_mul_f32 v93, v7, v93
  v_cvt_pk_bf16_f32 v134, v92, v93
  v_mul_f32 v94, v7, v94
  v_mul_f32 v95, v7, v95
  v_cvt_pk_bf16_f32 v135, v94, v95
  ds_write_b128 v13, v[132:135] offset:5120
  v_mul_f32 v96, v7, v96
  v_mul_f32 v97, v7, v97
  v_cvt_pk_bf16_f32 v136, v96, v97
  v_mul_f32 v98, v7, v98
  v_mul_f32 v99, v7, v99
  v_cvt_pk_bf16_f32 v137, v98, v99
  v_mul_f32 v100, v7, v100
  v_mul_f32 v101, v7, v101
  v_cvt_pk_bf16_f32 v138, v100, v101
  v_mul_f32 v102, v7, v102
  v_mul_f32 v103, v7, v103
  v_cvt_pk_bf16_f32 v139, v102, v103
  ds_write_b128 v13, v[136:139] offset:6144
  v_mul_f32 v104, v7, v104
  v_mul_f32 v105, v7, v105
  v_cvt_pk_bf16_f32 v140, v104, v105
  v_mul_f32 v106, v7, v106
  v_mul_f32 v107, v7, v107
  v_cvt_pk_bf16_f32 v141, v106, v107
  v_mul_f32 v108, v7, v108
  v_mul_f32 v109, v7, v109
  v_cvt_pk_bf16_f32 v142, v108, v109
  v_mul_f32 v110, v7, v110
  v_mul_f32 v111, v7, v111
  v_cvt_pk_bf16_f32 v143, v110, v111
  ds_write_b128 v13, v[140:143] offset:7168
  s_waitcnt vmcnt(8)
  s_waitcnt lgkmcnt(0)
  s_barrier
  ds_read_b64_tr_b16 v[32:33], v16 offset:0
  ds_read_b64_tr_b16 v[34:35], v16 offset:1024
  ds_read_b64_tr_b16 v[36:37], v16 offset:2048
  ds_read_b64_tr_b16 v[38:39], v16 offset:3072
  ds_read_b64_tr_b16 v[40:41], v16 offset:4096
  ds_read_b64_tr_b16 v[42:43], v16 offset:5120
  ds_read_b64_tr_b16 v[44:45], v16 offset:6144
  ds_read_b64_tr_b16 v[46:47], v16 offset:7168
  s_waitcnt lgkmcnt(6)
  v_mfma_f32_32x32x16_bf16 v[176:191], v[32:35], v[112:115], 0
  ds_read_b64_tr_b16 v[48:49], v16 offset:8192
  ds_read_b64_tr_b16 v[50:51], v16 offset:9216
  ds_read_b128 v[144:147], v14 offset:0
  ds_read_b128 v[148:151], v14 offset:1024
  ds_read_b128 v[152:155], v14 offset:2048
  ds_read_b128 v[156:159], v14 offset:3072
  ds_read_b128 v[160:163], v14 offset:4096
  ds_read_b128 v[164:167], v14 offset:5120
  ds_read_b128 v[168:171], v14 offset:6144
  ds_read_b128 v[172:175], v14 offset:7168
  s_waitcnt lgkmcnt(14)
  v_mfma_f32_32x32x16_bf16 v[176:191], v[36:39], v[116:119], v[176:191]
  ds_read_b64_tr_b16 v[52:53], v16 offset:10240
  ds_read_b64_tr_b16 v[54:55], v16 offset:11264
  s_waitcnt lgkmcnt(14)
  v_mfma_f32_32x32x16_bf16 v[176:191], v[40:43], v[120:123], v[176:191]
  ds_read_b64_tr_b16 v[32:33], v16 offset:12288
  ds_read_b64_tr_b16 v[34:35], v16 offset:13312
  s_waitcnt lgkmcnt(14)
  v_mfma_f32_32x32x16_bf16 v[176:191], v[44:47], v[124:127], v[176:191]
  ds_read_b64_tr_b16 v[36:37], v16 offset:14336
  ds_read_b64_tr_b16 v[38:39], v16 offset:15360
  s_waitcnt lgkmcnt(14)
  v_mfma_f32_32x32x16_bf16 v[176:191], v[48:51], v[128:131], v[176:191]
  ds_read_b64_tr_b16 v[40:41], v17 offset:0
  ds_read_b64_tr_b16 v[42:43], v17 offset:1024
  s_waitcnt lgkmcnt(6)
  v_mfma_f32_32x32x16_bf16 v[176:191], v[52:55], v[132:135], v[176:191]
  ds_read_b64_tr_b16 v[44:45], v17 offset:2048
  ds_read_b64_tr_b16 v[46:47], v17 offset:3072
  s_waitcnt lgkmcnt(6)
  v_mfma_f32_32x32x16_bf16 v[176:191], v[32:35], v[136:139], v[176:191]
  ds_read_b64_tr_b16 v[48:49], v17 offset:4096
  ds_read_b64_tr_b16 v[50:51], v17 offset:5120
  s_waitcnt lgkmcnt(6)
  v_mfma_f32_32x32x16_bf16 v[176:191], v[36:39], v[140:143], v[176:191]
  ds_read_b64_tr_b16 v[52:53], v17 offset:6144
  ds_read_b64_tr_b16 v[54:55], v17 offset:7168
  s_waitcnt lgkmcnt(6)
  v_mfma_f32_32x32x16_bf16 v[176:191], v[40:43], v[144:147], v[176:191]
  ds_read_b64_tr_b16 v[32:33], v17 offset:8192
  ds_read_b64_tr_b16 v[34:35], v17 offset:9216
  s_waitcnt lgkmcnt(6)
  v_mfma_f32_32x32x16_bf16 v[176:191], v[44:47], v[148:151], v[176:191]
  ds_read_b64_tr_b16 v[36:37], v17 offset:10240
  ds_read_b64_tr_b16 v[38:39], v17 offset:11264
  s_waitcnt lgkmcnt(6)
  v_mfma_f32_32x32x16_bf16 v[176:191], v[48:51], v[152:155], v[176:191]
  ds_read_b64_tr_b16 v[40:41], v17 offset:12288
  ds_read_b64_tr_b16 v[42:43], v17 offset:13312
  s_waitcnt lgkmcnt(6)
  v_mfma_f32_32x32x16_bf16 v[176:191], v[52:55], v[156:159], v[176:191]
  ds_read_b64_tr_b16 v[44:45], v17 offset:14336
  ds_read_b64_tr_b16 v[46:47], v17 offset:15360
  s_waitcnt lgkmcnt(6)
  v_mfma_f32_32x32x16_bf16 v[176:191], v[32:35], v[160:163], v[176:191]
  s_waitcnt vmcnt(4)
  s_waitcnt lgkmcnt(0)
  s_barrier
  v_add_u32 v16, 32768, v16
  v_add_u32 v17, 32768, v17
  ds_read_b64_tr_b16 v[48:49], v16 offset:0
  ds_read_b64_tr_b16 v[50:51], v16 offset:1024
  s_add_u32 m0, s30, 131072
  s_add_u32 s38, s36, 384
  buffer_load_dwordx4 v6, s[16:19], s38 offen lds
  v_mfma_f32_32x32x16_bf16 v[176:191], v[36:39], v[164:167], v[176:191]
  ds_read_b64_tr_b16 v[52:53], v16 offset:2048
  ds_read_b64_tr_b16 v[54:55], v16 offset:3072
  v_mfma_f32_32x32x16_bf16 v[176:191], v[40:43], v[168:171], v[176:191]
  ds_read_b64_tr_b16 v[32:33], v16 offset:4096
  ds_read_b64_tr_b16 v[34:35], v16 offset:5120
  s_add_u32 m0, s30, 139264
  s_add_u32 s38, s36, 74112
  buffer_load_dwordx4 v6, s[16:19], s38 offen lds
  v_mfma_f32_32x32x16_bf16 v[176:191], v[44:47], v[172:175], v[176:191]
  ds_read_b64_tr_b16 v[36:37], v16 offset:6144
  ds_read_b64_tr_b16 v[38:39], v16 offset:7168
  s_waitcnt lgkmcnt(6)
  v_mfma_f32_32x32x16_bf16 v[192:207], v[48:51], v[112:115], 0
  ds_read_b64_tr_b16 v[40:41], v16 offset:8192
  ds_read_b64_tr_b16 v[42:43], v16 offset:9216
  s_add_u32 m0, s30, 147456
  s_add_u32 s38, s36, 147840
  buffer_load_dwordx4 v6, s[16:19], s38 offen lds
  s_waitcnt lgkmcnt(6)
  v_mfma_f32_32x32x16_bf16 v[192:207], v[52:55], v[116:119], v[192:207]
  ds_read_b64_tr_b16 v[44:45], v16 offset:10240
  ds_read_b64_tr_b16 v[46:47], v16 offset:11264
  s_waitcnt lgkmcnt(6)
  v_mfma_f32_32x32x16_bf16 v[192:207], v[32:35], v[120:123], v[192:207]
  ds_read_b64_tr_b16 v[48:49], v16 offset:12288
  ds_read_b64_tr_b16 v[50:51], v16 offset:13312
  s_add_u32 m0, s30, 155648
  s_add_u32 s38, s36, 221568
  buffer_load_dwordx4 v6, s[16:19], s38 offen lds
  s_waitcnt lgkmcnt(6)
  v_mfma_f32_32x32x16_bf16 v[192:207], v[36:39], v[124:127], v[192:207]
  ds_read_b64_tr_b16 v[52:53], v16 offset:14336
  ds_read_b64_tr_b16 v[54:55], v16 offset:15360
  v_cvt_pk_bf16_f32 v208, v176, v177
  v_cvt_pk_bf16_f32 v209, v178, v179
  s_waitcnt lgkmcnt(6)
  v_mfma_f32_32x32x16_bf16 v[192:207], v[40:43], v[128:131], v[192:207]
  ds_read_b64_tr_b16 v[32:33], v17 offset:0
  ds_read_b64_tr_b16 v[34:35], v17 offset:1024
  v_cvt_pk_bf16_f32 v210, v180, v181
  v_cvt_pk_bf16_f32 v211, v182, v183
  s_add_u32 m0, s30, 32768
  s_add_u32 s38, s36, 512
  buffer_load_dwordx4 v6, s[16:19], s38 offen lds
  s_waitcnt lgkmcnt(6)
  v_mfma_f32_32x32x16_bf16 v[192:207], v[44:47], v[132:135], v[192:207]
  ds_read_b64_tr_b16 v[36:37], v17 offset:2048
  ds_read_b64_tr_b16 v[38:39], v17 offset:3072
  s_add_u32 s46, s33, 0
  buffer_store_dwordx4 v[208:211], v2, s[20:23], s46 offen sc1
  v_cvt_pk_bf16_f32 v212, v184, v185
  s_waitcnt lgkmcnt(6)
  v_mfma_f32_32x32x16_bf16 v[192:207], v[48:51], v[136:139], v[192:207]
  ds_read_b64_tr_b16 v[40:41], v17 offset:4096
  ds_read_b64_tr_b16 v[42:43], v17 offset:5120
  v_cvt_pk_bf16_f32 v213, v186, v187
  v_cvt_pk_bf16_f32 v214, v188, v189
  s_add_u32 m0, s30, 40960
  s_add_u32 s38, s36, 74240
  buffer_load_dwordx4 v6, s[16:19], s38 offen lds
  s_waitcnt lgkmcnt(6)
  v_mfma_f32_32x32x16_bf16 v[192:207], v[52:55], v[140:143], v[192:207]
  ds_read_b64_tr_b16 v[44:45], v17 offset:6144
  ds_read_b64_tr_b16 v[46:47], v17 offset:7168
  v_cvt_pk_bf16_f32 v215, v190, v191
  buffer_store_dwordx4 v[212:215], v2, s[20:23], s46 offen offset:256 sc1
  s_waitcnt lgkmcnt(6)
  v_mfma_f32_32x32x16_bf16 v[192:207], v[32:35], v[144:147], v[192:207]
  ds_read_b64_tr_b16 v[48:49], v17 offset:8192
  ds_read_b64_tr_b16 v[50:51], v17 offset:9216
  s_add_u32 m0, s30, 49152
  s_add_u32 s38, s36, 147968
  buffer_load_dwordx4 v6, s[16:19], s38 offen lds
  s_waitcnt lgkmcnt(6)
  v_mfma_f32_32x32x16_bf16 v[192:207], v[36:39], v[148:151], v[192:207]
  ds_read_b64_tr_b16 v[52:53], v17 offset:10240
  ds_read_b64_tr_b16 v[54:55], v17 offset:11264
  s_waitcnt lgkmcnt(6)
  v_mfma_f32_32x32x16_bf16 v[192:207], v[40:43], v[152:155], v[192:207]
  ds_read_b64_tr_b16 v[32:33], v17 offset:12288
  ds_read_b64_tr_b16 v[34:35], v17 offset:13312
  s_add_u32 m0, s30, 57344
  s_add_u32 s38, s36, 221696
  buffer_load_dwordx4 v6, s[16:19], s38 offen lds
  s_waitcnt lgkmcnt(6)
  v_mfma_f32_32x32x16_bf16 v[192:207], v[44:47], v[156:159], v[192:207]
  ds_read_b64_tr_b16 v[36:37], v17 offset:14336
  ds_read_b64_tr_b16 v[38:39], v17 offset:15360
  s_waitcnt lgkmcnt(6)
  v_mfma_f32_32x32x16_bf16 v[192:207], v[48:51], v[160:163], v[192:207]
  s_waitcnt vmcnt(10)
  s_waitcnt lgkmcnt(0)
  s_barrier
  v_add_u32 v16, 32768, v16
  v_add_u32 v17, 32768, v17
  ds_read_b64_tr_b16 v[40:41], v16 offset:0
  ds_read_b64_tr_b16 v[42:43], v16 offset:1024
  s_add_u32 m0, s30, 65536
  s_add_u32 s38, s36, 640
  buffer_load_dwordx4 v6, s[16:19], s38 offen lds
  v_mfma_f32_32x32x16_bf16 v[192:207], v[52:55], v[164:167], v[192:207]
  ds_read_b64_tr_b16 v[44:45], v16 offset:2048
  ds_read_b64_tr_b16 v[46:47], v16 offset:3072
  v_mfma_f32_32x32x16_bf16 v[192:207], v[32:35], v[168:171], v[192:207]
  ds_read_b64_tr_b16 v[48:49], v16 offset:4096
  ds_read_b64_tr_b16 v[50:51], v16 offset:5120
  s_add_u32 m0, s30, 73728
  s_add_u32 s38, s36, 74368
  buffer_load_dwordx4 v6, s[16:19], s38 offen lds
  v_mfma_f32_32x32x16_bf16 v[192:207], v[36:39], v[172:175], v[192:207]
  ds_read_b64_tr_b16 v[52:53], v16 offset:6144
  ds_read_b64_tr_b16 v[54:55], v16 offset:7168
  s_waitcnt lgkmcnt(6)
  v_mfma_f32_32x32x16_bf16 v[176:191], v[40:43], v[112:115], 0
  ds_read_b64_tr_b16 v[32:33], v16 offset:8192
  ds_read_b64_tr_b16 v[34:35], v16 offset:9216
  s_add_u32 m0, s30, 81920
  s_add_u32 s38, s36, 148096
  buffer_load_dwordx4 v6, s[16:19], s38 offen lds
  s_waitcnt lgkmcnt(6)
  v_mfma_f32_32x32x16_bf16 v[176:191], v[44:47], v[116:119], v[176:191]
  ds_read_b64_tr_b16 v[36:37], v16 offset:10240
  ds_read_b64_tr_b16 v[38:39], v16 offset:11264
  s_waitcnt lgkmcnt(6)
  v_mfma_f32_32x32x16_bf16 v[176:191], v[48:51], v[120:123], v[176:191]
  ds_read_b64_tr_b16 v[40:41], v16 offset:12288
  ds_read_b64_tr_b16 v[42:43], v16 offset:13312
  s_add_u32 m0, s30, 90112
  s_add_u32 s38, s36, 221824
  buffer_load_dwordx4 v6, s[16:19], s38 offen lds
  s_waitcnt lgkmcnt(6)
  v_mfma_f32_32x32x16_bf16 v[176:191], v[52:55], v[124:127], v[176:191]
  ds_read_b64_tr_b16 v[44:45], v16 offset:14336
  ds_read_b64_tr_b16 v[46:47], v16 offset:15360
  v_cvt_pk_bf16_f32 v216, v192, v193
  v_cvt_pk_bf16_f32 v217, v194, v195
  s_waitcnt lgkmcnt(6)
  v_mfma_f32_32x32x16_bf16 v[176:191], v[32:35], v[128:131], v[176:191]
  ds_read_b64_tr_b16 v[48:49], v17 offset:0
  ds_read_b64_tr_b16 v[50:51], v17 offset:1024
  v_cvt_pk_bf16_f32 v218, v196, v197
  v_cvt_pk_bf16_f32 v219, v198, v199
  s_waitcnt lgkmcnt(6)
  v_mfma_f32_32x32x16_bf16 v[176:191], v[36:39], v[132:135], v[176:191]
  ds_read_b64_tr_b16 v[52:53], v17 offset:2048
  ds_read_b64_tr_b16 v[54:55], v17 offset:3072
  s_add_u32 s46, s33, 1024
  buffer_store_dwordx4 v[216:219], v2, s[20:23], s46 offen sc1
  v_cvt_pk_bf16_f32 v220, v200, v201
  s_waitcnt lgkmcnt(6)
  v_mfma_f32_32x32x16_bf16 v[176:191], v[40:43], v[136:139], v[176:191]
  ds_read_b64_tr_b16 v[32:33], v17 offset:4096
  ds_read_b64_tr_b16 v[34:35], v17 offset:5120
  v_cvt_pk_bf16_f32 v221, v202, v203
  v_cvt_pk_bf16_f32 v222, v204, v205
  s_waitcnt lgkmcnt(6)
  v_mfma_f32_32x32x16_bf16 v[176:191], v[44:47], v[140:143], v[176:191]
  ds_read_b64_tr_b16 v[36:37], v17 offset:6144
  ds_read_b64_tr_b16 v[38:39], v17 offset:7168
  v_cvt_pk_bf16_f32 v223, v206, v207
  buffer_store_dwordx4 v[220:223], v2, s[20:23], s46 offen offset:256 sc1
  s_waitcnt lgkmcnt(6)
  v_mfma_f32_32x32x16_bf16 v[176:191], v[48:51], v[144:147], v[176:191]
  ds_read_b64_tr_b16 v[40:41], v17 offset:8192
  ds_read_b64_tr_b16 v[42:43], v17 offset:9216
  s_waitcnt lgkmcnt(6)
  v_mfma_f32_32x32x16_bf16 v[176:191], v[52:55], v[148:151], v[176:191]
  ds_read_b64_tr_b16 v[44:45], v17 offset:10240
  ds_read_b64_tr_b16 v[46:47], v17 offset:11264
  s_waitcnt lgkmcnt(6)
  v_mfma_f32_32x32x16_bf16 v[176:191], v[32:35], v[152:155], v[176:191]
  ds_read_b64_tr_b16 v[48:49], v17 offset:12288
  ds_read_b64_tr_b16 v[50:51], v17 offset:13312
  s_waitcnt lgkmcnt(6)
  v_mfma_f32_32x32x16_bf16 v[176:191], v[36:39], v[156:159], v[176:191]
  ds_read_b64_tr_b16 v[52:53], v17 offset:14336
  ds_read_b64_tr_b16 v[54:55], v17 offset:15360
  s_waitcnt lgkmcnt(6)
  v_mfma_f32_32x32x16_bf16 v[176:191], v[40:43], v[160:163], v[176:191]
  s_waitcnt vmcnt(12)
  s_waitcnt lgkmcnt(0)
  s_barrier
  v_add_u32 v16, 32768, v16
  v_add_u32 v17, 32768, v17
  ds_read_b64_tr_b16 v[32:33], v16 offset:0
  ds_read_b64_tr_b16 v[34:35], v16 offset:1024
  s_add_u32 m0, s30, 98304
  s_add_u32 s38, s36, 768
  buffer_load_dwordx4 v6, s[16:19], s38 offen lds
  v_mfma_f32_32x32x16_bf16 v[176:191], v[44:47], v[164:167], v[176:191]
  ds_read_b64_tr_b16 v[36:37], v16 offset:2048
  ds_read_b64_tr_b16 v[38:39], v16 offset:3072
  v_mfma_f32_32x32x16_bf16 v[176:191], v[48:51], v[168:171], v[176:191]
  ds_read_b64_tr_b16 v[40:41], v16 offset:4096
  ds_read_b64_tr_b16 v[42:43], v16 offset:5120
  s_add_u32 m0, s30, 106496
  s_add_u32 s38, s36, 74496
  buffer_load_dwordx4 v6, s[16:19], s38 offen lds
  v_mfma_f32_32x32x16_bf16 v[176:191], v[52:55], v[172:175], v[176:191]
  ds_read_b64_tr_b16 v[44:45], v16 offset:6144
  ds_read_b64_tr_b16 v[46:47], v16 offset:7168
  s_waitcnt lgkmcnt(6)
  v_mfma_f32_32x32x16_bf16 v[192:207], v[32:35], v[112:115], 0
  ds_read_b64_tr_b16 v[48:49], v16 offset:8192
  ds_read_b64_tr_b16 v[50:51], v16 offset:9216
  s_add_u32 m0, s30, 114688
  s_add_u32 s38, s36, 148224
  buffer_load_dwordx4 v6, s[16:19], s38 offen lds
  s_waitcnt lgkmcnt(6)
  v_mfma_f32_32x32x16_bf16 v[192:207], v[36:39], v[116:119], v[192:207]
  ds_read_b64_tr_b16 v[52:53], v16 offset:10240
  ds_read_b64_tr_b16 v[54:55], v16 offset:11264
  s_waitcnt lgkmcnt(6)
  v_mfma_f32_32x32x16_bf16 v[192:207], v[40:43], v[120:123], v[192:207]
  ds_read_b64_tr_b16 v[32:33], v16 offset:12288
  ds_read_b64_tr_b16 v[34:35], v16 offset:13312
  s_add_u32 m0, s30, 122880
  s_add_u32 s38, s36, 221952
  buffer_load_dwordx4 v6, s[16:19], s38 offen lds
  s_waitcnt lgkmcnt(6)
  v_mfma_f32_32x32x16_bf16 v[192:207], v[44:47], v[124:127], v[192:207]
  ds_read_b64_tr_b16 v[36:37], v16 offset:14336
  ds_read_b64_tr_b16 v[38:39], v16 offset:15360
  v_cvt_pk_bf16_f32 v208, v176, v177
  v_cvt_pk_bf16_f32 v209, v178, v179
  s_waitcnt lgkmcnt(6)
  v_mfma_f32_32x32x16_bf16 v[192:207], v[48:51], v[128:131], v[192:207]
  ds_read_b64_tr_b16 v[40:41], v17 offset:0
  ds_read_b64_tr_b16 v[42:43], v17 offset:1024
  v_cvt_pk_bf16_f32 v210, v180, v181
  v_cvt_pk_bf16_f32 v211, v182, v183
  s_waitcnt lgkmcnt(6)
  v_mfma_f32_32x32x16_bf16 v[192:207], v[52:55], v[132:135], v[192:207]
  ds_read_b64_tr_b16 v[44:45], v17 offset:2048
  ds_read_b64_tr_b16 v[46:47], v17 offset:3072
  s_add_u32 s46, s33, 2048
  buffer_store_dwordx4 v[208:211], v2, s[20:23], s46 offen sc1
  v_cvt_pk_bf16_f32 v212, v184, v185
  s_waitcnt lgkmcnt(6)
  v_mfma_f32_32x32x16_bf16 v[192:207], v[32:35], v[136:139], v[192:207]
  ds_read_b64_tr_b16 v[48:49], v17 offset:4096
  ds_read_b64_tr_b16 v[50:51], v17 offset:5120
  v_cvt_pk_bf16_f32 v213, v186, v187
  v_cvt_pk_bf16_f32 v214, v188, v189
  s_waitcnt lgkmcnt(6)
  v_mfma_f32_32x32x16_bf16 v[192:207], v[36:39], v[140:143], v[192:207]
  ds_read_b64_tr_b16 v[52:53], v17 offset:6144
  ds_read_b64_tr_b16 v[54:55], v17 offset:7168
  v_cvt_pk_bf16_f32 v215, v190, v191
  buffer_store_dwordx4 v[212:215], v2, s[20:23], s46 offen offset:256 sc1
  s_waitcnt lgkmcnt(6)
  v_mfma_f32_32x32x16_bf16 v[192:207], v[40:43], v[144:147], v[192:207]
  ds_read_b64_tr_b16 v[32:33], v17 offset:8192
  ds_read_b64_tr_b16 v[34:35], v17 offset:9216
  s_waitcnt lgkmcnt(6)
  v_mfma_f32_32x32x16_bf16 v[192:207], v[44:47], v[148:151], v[192:207]
  ds_read_b64_tr_b16 v[36:37], v17 offset:10240
  ds_read_b64_tr_b16 v[38:39], v17 offset:11264
  s_waitcnt lgkmcnt(6)
  v_mfma_f32_32x32x16_bf16 v[192:207], v[48:51], v[152:155], v[192:207]
  ds_read_b64_tr_b16 v[40:41], v17 offset:12288
  ds_read_b64_tr_b16 v[42:43], v17 offset:13312
  s_waitcnt lgkmcnt(6)
  v_mfma_f32_32x32x16_bf16 v[192:207], v[52:55], v[156:159], v[192:207]
  ds_read_b64_tr_b16 v[44:45], v17 offset:14336
  ds_read_b64_tr_b16 v[46:47], v17 offset:15360
  s_waitcnt lgkmcnt(6)
  v_mfma_f32_32x32x16_bf16 v[192:207], v[32:35], v[160:163], v[192:207]
  s_waitcnt vmcnt(12)
  s_waitcnt lgkmcnt(0)
  s_barrier
  v_add_u32 v16, 4294868992, v16
  v_add_u32 v17, 4294868992, v17
  ds_read_b64_tr_b16 v[48:49], v16 offset:0
  ds_read_b64_tr_b16 v[50:51], v16 offset:1024
  s_add_u32 m0, s30, 131072
  s_add_u32 s38, s36, 896
  buffer_load_dwordx4 v6, s[16:19], s38 offen lds
  v_mfma_f32_32x32x16_bf16 v[192:207], v[36:39], v[164:167], v[192:207]
  ds_read_b64_tr_b16 v[52:53], v16 offset:2048
  ds_read_b64_tr_b16 v[54:55], v16 offset:3072
  v_mfma_f32_32x32x16_bf16 v[192:207], v[40:43], v[168:171], v[192:207]
  ds_read_b64_tr_b16 v[32:33], v16 offset:4096
  ds_read_b64_tr_b16 v[34:35], v16 offset:5120
  s_add_u32 m0, s30, 139264
  s_add_u32 s38, s36, 74624
  buffer_load_dwordx4 v6, s[16:19], s38 offen lds
  v_mfma_f32_32x32x16_bf16 v[192:207], v[44:47], v[172:175], v[192:207]
  ds_read_b64_tr_b16 v[36:37], v16 offset:6144
  ds_read_b64_tr_b16 v[38:39], v16 offset:7168
  s_waitcnt lgkmcnt(6)
  v_mfma_f32_32x32x16_bf16 v[176:191], v[48:51], v[112:115], 0
  ds_read_b64_tr_b16 v[40:41], v16 offset:8192
  ds_read_b64_tr_b16 v[42:43], v16 offset:9216
  s_add_u32 m0, s30, 147456
  s_add_u32 s38, s36, 148352
  buffer_load_dwordx4 v6, s[16:19], s38 offen lds
  s_waitcnt lgkmcnt(6)
  v_mfma_f32_32x32x16_bf16 v[176:191], v[52:55], v[116:119], v[176:191]
  ds_read_b64_tr_b16 v[44:45], v16 offset:10240
  ds_read_b64_tr_b16 v[46:47], v16 offset:11264
  s_waitcnt lgkmcnt(6)
  v_mfma_f32_32x32x16_bf16 v[176:191], v[32:35], v[120:123], v[176:191]
  ds_read_b64_tr_b16 v[48:49], v16 offset:12288
  ds_read_b64_tr_b16 v[50:51], v16 offset:13312
  s_add_u32 m0, s30, 155648
  s_add_u32 s38, s36, 222080
  buffer_load_dwordx4 v6, s[16:19], s38 offen lds
  s_waitcnt lgkmcnt(6)
  v_mfma_f32_32x32x16_bf16 v[176:191], v[36:39], v[124:127], v[176:191]
  ds_read_b64_tr_b16 v[52:53], v16 offset:14336
  ds_read_b64_tr_b16 v[54:55], v16 offset:15360
  v_cvt_pk_bf16_f32 v216, v192, v193
  v_cvt_pk_bf16_f32 v217, v194, v195
  s_waitcnt lgkmcnt(6)
  v_mfma_f32_32x32x16_bf16 v[176:191], v[40:43], v[128:131], v[176:191]
  ds_read_b64_tr_b16 v[32:33], v17 offset:0
  ds_read_b64_tr_b16 v[34:35], v17 offset:1024
  v_cvt_pk_bf16_f32 v218, v196, v197
  v_cvt_pk_bf16_f32 v219, v198, v199
  s_waitcnt lgkmcnt(6)
  v_mfma_f32_32x32x16_bf16 v[176:191], v[44:47], v[132:135], v[176:191]
  ds_read_b64_tr_b16 v[36:37], v17 offset:2048
  ds_read_b64_tr_b16 v[38:39], v17 offset:3072
  s_add_u32 s46, s33, 3072
  buffer_store_dwordx4 v[216:219], v2, s[20:23], s46 offen sc1
  v_cvt_pk_bf16_f32 v220, v200, v201
  s_waitcnt lgkmcnt(6)
  v_mfma_f32_32x32x16_bf16 v[176:191], v[48:51], v[136:139], v[176:191]
  ds_read_b64_tr_b16 v[40:41], v17 offset:4096
  ds_read_b64_tr_b16 v[42:43], v17 offset:5120
  v_cvt_pk_bf16_f32 v221, v202, v203
  v_cvt_pk_bf16_f32 v222, v204, v205
  s_waitcnt lgkmcnt(6)
  v_mfma_f32_32x32x16_bf16 v[176:191], v[52:55], v[140:143], v[176:191]
  ds_read_b64_tr_b16 v[44:45], v17 offset:6144
  ds_read_b64_tr_b16 v[46:47], v17 offset:7168
  v_cvt_pk_bf16_f32 v223, v206, v207
  buffer_store_dwordx4 v[220:223], v2, s[20:23], s46 offen offset:256 sc1
  s_waitcnt lgkmcnt(6)
  v_mfma_f32_32x32x16_bf16 v[176:191], v[32:35], v[144:147], v[176:191]
  ds_read_b64_tr_b16 v[48:49], v17 offset:8192
  ds_read_b64_tr_b16 v[50:51], v17 offset:9216
  s_waitcnt lgkmcnt(6)
  v_mfma_f32_32x32x16_bf16 v[176:191], v[36:39], v[148:151], v[176:191]
  ds_read_b64_tr_b16 v[52:53], v17 offset:10240
  ds_read_b64_tr_b16 v[54:55], v17 offset:11264
  s_waitcnt lgkmcnt(6)
  v_mfma_f32_32x32x16_bf16 v[176:191], v[40:43], v[152:155], v[176:191]
  ds_read_b64_tr_b16 v[32:33], v17 offset:12288
  ds_read_b64_tr_b16 v[34:35], v17 offset:13312
  s_waitcnt lgkmcnt(6)
  v_mfma_f32_32x32x16_bf16 v[176:191], v[44:47], v[156:159], v[176:191]
  ds_read_b64_tr_b16 v[36:37], v17 offset:14336
  ds_read_b64_tr_b16 v[38:39], v17 offset:15360
  s_waitcnt lgkmcnt(6)
  v_mfma_f32_32x32x16_bf16 v[176:191], v[48:51], v[160:163], v[176:191]
  s_waitcnt vmcnt(14)
  s_waitcnt lgkmcnt(0)
  s_barrier
  v_add_u32 v16, 32768, v16
  v_add_u32 v17, 32768, v17
  ds_read_b64_tr_b16 v[40:41], v16 offset:0
  ds_read_b64_tr_b16 v[42:43], v16 offset:1024
  s_add_u32 m0, s30, 32768
  s_add_u32 s38, s36, 1024
  buffer_load_dwordx4 v6, s[16:19], s38 offen lds
  v_mfma_f32_32x32x16_bf16 v[176:191], v[52:55], v[164:167], v[176:191]
  ds_read_b64_tr_b16 v[44:45], v16 offset:2048
  ds_read_b64_tr_b16 v[46:47], v16 offset:3072
  v_mfma_f32_32x32x16_bf16 v[176:191], v[32:35], v[168:171], v[176:191]
  ds_read_b64_tr_b16 v[48:49], v16 offset:4096
  ds_read_b64_tr_b16 v[50:51], v16 offset:5120
  s_add_u32 m0, s30, 40960
  s_add_u32 s38, s36, 74752
  buffer_load_dwordx4 v6, s[16:19], s38 offen lds
  v_mfma_f32_32x32x16_bf16 v[176:191], v[36:39], v[172:175], v[176:191]
  ds_read_b64_tr_b16 v[52:53], v16 offset:6144
  ds_read_b64_tr_b16 v[54:55], v16 offset:7168
  s_waitcnt lgkmcnt(6)
  v_mfma_f32_32x32x16_bf16 v[192:207], v[40:43], v[112:115], 0
  ds_read_b64_tr_b16 v[32:33], v16 offset:8192
  ds_read_b64_tr_b16 v[34:35], v16 offset:9216
  s_add_u32 m0, s30, 49152
  s_add_u32 s38, s36, 148480
  buffer_load_dwordx4 v6, s[16:19], s38 offen lds
  s_waitcnt lgkmcnt(6)
  v_mfma_f32_32x32x16_bf16 v[192:207], v[44:47], v[116:119], v[192:207]
  ds_read_b64_tr_b16 v[36:37], v16 offset:10240
  ds_read_b64_tr_b16 v[38:39], v16 offset:11264
  s_waitcnt lgkmcnt(6)
  v_mfma_f32_32x32x16_bf16 v[192:207], v[48:51], v[120:123], v[192:207]
  ds_read_b64_tr_b16 v[40:41], v16 offset:12288
  ds_read_b64_tr_b16 v[42:43], v16 offset:13312
  s_add_u32 m0, s30, 57344
  s_add_u32 s38, s36, 222208
  buffer_load_dwordx4 v6, s[16:19], s38 offen lds
  s_waitcnt lgkmcnt(6)
  v_mfma_f32_32x32x16_bf16 v[192:207], v[52:55], v[124:127], v[192:207]
  ds_read_b64_tr_b16 v[44:45], v16 offset:14336
  ds_read_b64_tr_b16 v[46:47], v16 offset:15360
  v_cvt_pk_bf16_f32 v208, v176, v177
  v_cvt_pk_bf16_f32 v209, v178, v179
  s_waitcnt lgkmcnt(6)
  v_mfma_f32_32x32x16_bf16 v[192:207], v[32:35], v[128:131], v[192:207]
  ds_read_b64_tr_b16 v[48:49], v17 offset:0
  ds_read_b64_tr_b16 v[50:51], v17 offset:1024
  v_cvt_pk_bf16_f32 v210, v180, v181
  v_cvt_pk_bf16_f32 v211, v182, v183
  s_waitcnt lgkmcnt(6)
  v_mfma_f32_32x32x16_bf16 v[192:207], v[36:39], v[132:135], v[192:207]
  ds_read_b64_tr_b16 v[52:53], v17 offset:2048
  ds_read_b64_tr_b16 v[54:55], v17 offset:3072
  s_add_u32 s46, s33, 4096
  buffer_store_dwordx4 v[208:211], v2, s[20:23], s46 offen sc1
  v_cvt_pk_bf16_f32 v212, v184, v185
  s_waitcnt lgkmcnt(6)
  v_mfma_f32_32x32x16_bf16 v[192:207], v[40:43], v[136:139], v[192:207]
  ds_read_b64_tr_b16 v[32:33], v17 offset:4096
  ds_read_b64_tr_b16 v[34:35], v17 offset:5120
  v_cvt_pk_bf16_f32 v213, v186, v187
  v_cvt_pk_bf16_f32 v214, v188, v189
  s_waitcnt lgkmcnt(6)
  v_mfma_f32_32x32x16_bf16 v[192:207], v[44:47], v[140:143], v[192:207]
  ds_read_b64_tr_b16 v[36:37], v17 offset:6144
  ds_read_b64_tr_b16 v[38:39], v17 offset:7168
  v_cvt_pk_bf16_f32 v215, v190, v191
  buffer_store_dwordx4 v[212:215], v2, s[20:23], s46 offen offset:256 sc1
  s_waitcnt lgkmcnt(6)
  v_mfma_f32_32x32x16_bf16 v[192:207], v[48:51], v[144:147], v[192:207]
  ds_read_b64_tr_b16 v[40:41], v17 offset:8192
  ds_read_b64_tr_b16 v[42:43], v17 offset:9216
  s_waitcnt lgkmcnt(6)
  v_mfma_f32_32x32x16_bf16 v[192:207], v[52:55], v[148:151], v[192:207]
  ds_read_b64_tr_b16 v[44:45], v17 offset:10240
  ds_read_b64_tr_b16 v[46:47], v17 offset:11264
  s_waitcnt lgkmcnt(6)
  v_mfma_f32_32x32x16_bf16 v[192:207], v[32:35], v[152:155], v[192:207]
  ds_read_b64_tr_b16 v[48:49], v17 offset:12288
  ds_read_b64_tr_b16 v[50:51], v17 offset:13312
  s_waitcnt lgkmcnt(6)
  v_mfma_f32_32x32x16_bf16 v[192:207], v[36:39], v[156:159], v[192:207]
  ds_read_b64_tr_b16 v[52:53], v17 offset:14336
  ds_read_b64_tr_b16 v[54:55], v17 offset:15360
  s_waitcnt lgkmcnt(6)
  v_mfma_f32_32x32x16_bf16 v[192:207], v[40:43], v[160:163], v[192:207]
  s_waitcnt vmcnt(14)
  s_waitcnt lgkmcnt(0)
  s_barrier
  v_add_u32 v16, 32768, v16
  v_add_u32 v17, 32768, v17
  ds_read_b64_tr_b16 v[32:33], v16 offset:0
  ds_read_b64_tr_b16 v[34:35], v16 offset:1024
  v_mfma_f32_32x32x16_bf16 v[192:207], v[44:47], v[164:167], v[192:207]
  ds_read_b64_tr_b16 v[36:37], v16 offset:2048
  ds_read_b64_tr_b16 v[38:39], v16 offset:3072
  v_mfma_f32_32x32x16_bf16 v[192:207], v[48:51], v[168:171], v[192:207]
  ds_read_b64_tr_b16 v[40:41], v16 offset:4096
  ds_read_b64_tr_b16 v[42:43], v16 offset:5120
  v_mfma_f32_32x32x16_bf16 v[192:207], v[52:55], v[172:175], v[192:207]
  ds_read_b64_tr_b16 v[44:45], v16 offset:6144
  ds_read_b64_tr_b16 v[46:47], v16 offset:7168
  s_waitcnt lgkmcnt(6)
  v_mfma_f32_32x32x16_bf16 v[176:191], v[32:35], v[112:115], 0
  ds_read_b64_tr_b16 v[48:49], v16 offset:8192
  ds_read_b64_tr_b16 v[50:51], v16 offset:9216
  s_waitcnt lgkmcnt(6)
  v_mfma_f32_32x32x16_bf16 v[176:191], v[36:39], v[116:119], v[176:191]
  ds_read_b64_tr_b16 v[52:53], v16 offset:10240
  ds_read_b64_tr_b16 v[54:55], v16 offset:11264
  s_waitcnt lgkmcnt(6)
  v_mfma_f32_32x32x16_bf16 v[176:191], v[40:43], v[120:123], v[176:191]
  ds_read_b64_tr_b16 v[32:33], v16 offset:12288
  ds_read_b64_tr_b16 v[34:35], v16 offset:13312
  s_waitcnt lgkmcnt(6)
  v_mfma_f32_32x32x16_bf16 v[176:191], v[44:47], v[124:127], v[176:191]
  ds_read_b64_tr_b16 v[36:37], v16 offset:14336
  ds_read_b64_tr_b16 v[38:39], v16 offset:15360
  v_cvt_pk_bf16_f32 v216, v192, v193
  v_cvt_pk_bf16_f32 v217, v194, v195
  s_waitcnt lgkmcnt(6)
  v_mfma_f32_32x32x16_bf16 v[176:191], v[48:51], v[128:131], v[176:191]
  ds_read_b64_tr_b16 v[40:41], v17 offset:0
  ds_read_b64_tr_b16 v[42:43], v17 offset:1024
  v_cvt_pk_bf16_f32 v218, v196, v197
  v_cvt_pk_bf16_f32 v219, v198, v199
  s_waitcnt lgkmcnt(6)
  v_mfma_f32_32x32x16_bf16 v[176:191], v[52:55], v[132:135], v[176:191]
  ds_read_b64_tr_b16 v[44:45], v17 offset:2048
  ds_read_b64_tr_b16 v[46:47], v17 offset:3072
  s_add_u32 s46, s33, 5120
  buffer_store_dwordx4 v[216:219], v2, s[20:23], s46 offen sc1
  v_cvt_pk_bf16_f32 v220, v200, v201
  s_waitcnt lgkmcnt(6)
  v_mfma_f32_32x32x16_bf16 v[176:191], v[32:35], v[136:139], v[176:191]
  ds_read_b64_tr_b16 v[48:49], v17 offset:4096
  ds_read_b64_tr_b16 v[50:51], v17 offset:5120
  v_cvt_pk_bf16_f32 v221, v202, v203
  v_cvt_pk_bf16_f32 v222, v204, v205
  s_waitcnt lgkmcnt(6)
  v_mfma_f32_32x32x16_bf16 v[176:191], v[36:39], v[140:143], v[176:191]
  ds_read_b64_tr_b16 v[52:53], v17 offset:6144
  ds_read_b64_tr_b16 v[54:55], v17 offset:7168
  v_cvt_pk_bf16_f32 v223, v206, v207
  buffer_store_dwordx4 v[220:223], v2, s[20:23], s46 offen offset:256 sc1
  s_waitcnt lgkmcnt(6)
  v_mfma_f32_32x32x16_bf16 v[176:191], v[40:43], v[144:147], v[176:191]
  ds_read_b64_tr_b16 v[32:33], v17 offset:8192
  ds_read_b64_tr_b16 v[34:35], v17 offset:9216
  s_waitcnt lgkmcnt(6)
  v_mfma_f32_32x32x16_bf16 v[176:191], v[44:47], v[148:151], v[176:191]
  ds_read_b64_tr_b16 v[36:37], v17 offset:10240
  ds_read_b64_tr_b16 v[38:39], v17 offset:11264
  s_waitcnt lgkmcnt(6)
  v_mfma_f32_32x32x16_bf16 v[176:191], v[48:51], v[152:155], v[176:191]
  ds_read_b64_tr_b16 v[40:41], v17 offset:12288
  ds_read_b64_tr_b16 v[42:43], v17 offset:13312
  s_waitcnt lgkmcnt(6)
  v_mfma_f32_32x32x16_bf16 v[176:191], v[52:55], v[156:159], v[176:191]
  ds_read_b64_tr_b16 v[44:45], v17 offset:14336
  ds_read_b64_tr_b16 v[46:47], v17 offset:15360
  s_waitcnt lgkmcnt(6)
  v_mfma_f32_32x32x16_bf16 v[176:191], v[32:35], v[160:163], v[176:191]
  s_waitcnt vmcnt(10)
  s_waitcnt lgkmcnt(0)
  s_barrier
  v_add_u32 v16, 32768, v16
  v_add_u32 v17, 32768, v17
  ds_read_b64_tr_b16 v[48:49], v16 offset:0
  ds_read_b64_tr_b16 v[50:51], v16 offset:1024
  v_mfma_f32_32x32x16_bf16 v[176:191], v[36:39], v[164:167], v[176:191]
  ds_read_b64_tr_b16 v[52:53], v16 offset:2048
  ds_read_b64_tr_b16 v[54:55], v16 offset:3072
  v_mfma_f32_32x32x16_bf16 v[176:191], v[40:43], v[168:171], v[176:191]
  ds_read_b64_tr_b16 v[32:33], v16 offset:4096
  ds_read_b64_tr_b16 v[34:35], v16 offset:5120
  v_mfma_f32_32x32x16_bf16 v[176:191], v[44:47], v[172:175], v[176:191]
  ds_read_b64_tr_b16 v[36:37], v16 offset:6144
  ds_read_b64_tr_b16 v[38:39], v16 offset:7168
  s_waitcnt lgkmcnt(6)
  v_mfma_f32_32x32x16_bf16 v[192:207], v[48:51], v[112:115], 0
  ds_read_b64_tr_b16 v[40:41], v16 offset:8192
  ds_read_b64_tr_b16 v[42:43], v16 offset:9216
  s_waitcnt lgkmcnt(6)
  v_mfma_f32_32x32x16_bf16 v[192:207], v[52:55], v[116:119], v[192:207]
  ds_read_b64_tr_b16 v[44:45], v16 offset:10240
  ds_read_b64_tr_b16 v[46:47], v16 offset:11264
  s_waitcnt lgkmcnt(6)
  v_mfma_f32_32x32x16_bf16 v[192:207], v[32:35], v[120:123], v[192:207]
  ds_read_b64_tr_b16 v[48:49], v16 offset:12288
  ds_read_b64_tr_b16 v[50:51], v16 offset:13312
  s_waitcnt lgkmcnt(6)
  v_mfma_f32_32x32x16_bf16 v[192:207], v[36:39], v[124:127], v[192:207]
  ds_read_b64_tr_b16 v[52:53], v16 offset:14336
  ds_read_b64_tr_b16 v[54:55], v16 offset:15360
  v_cvt_pk_bf16_f32 v208, v176, v177
  v_cvt_pk_bf16_f32 v209, v178, v179
  s_waitcnt lgkmcnt(6)
  v_mfma_f32_32x32x16_bf16 v[192:207], v[40:43], v[128:131], v[192:207]
  ds_read_b64_tr_b16 v[32:33], v17 offset:0
  ds_read_b64_tr_b16 v[34:35], v17 offset:1024
  v_cvt_pk_bf16_f32 v210, v180, v181
  v_cvt_pk_bf16_f32 v211, v182, v183
  s_waitcnt lgkmcnt(6)
  v_mfma_f32_32x32x16_bf16 v[192:207], v[44:47], v[132:135], v[192:207]
  ds_read_b64_tr_b16 v[36:37], v17 offset:2048
  ds_read_b64_tr_b16 v[38:39], v17 offset:3072
  s_add_u32 s46, s33, 6144
  buffer_store_dwordx4 v[208:211], v2, s[20:23], s46 offen sc1
  v_cvt_pk_bf16_f32 v212, v184, v185
  s_waitcnt lgkmcnt(6)
  v_mfma_f32_32x32x16_bf16 v[192:207], v[48:51], v[136:139], v[192:207]
  ds_read_b64_tr_b16 v[40:41], v17 offset:4096
  ds_read_b64_tr_b16 v[42:43], v17 offset:5120
  v_cvt_pk_bf16_f32 v213, v186, v187
  v_cvt_pk_bf16_f32 v214, v188, v189
  s_waitcnt lgkmcnt(6)
  v_mfma_f32_32x32x16_bf16 v[192:207], v[52:55], v[140:143], v[192:207]
  ds_read_b64_tr_b16 v[44:45], v17 offset:6144
  ds_read_b64_tr_b16 v[46:47], v17 offset:7168
  v_cvt_pk_bf16_f32 v215, v190, v191
  buffer_store_dwordx4 v[212:215], v2, s[20:23], s46 offen offset:256 sc1
  s_waitcnt lgkmcnt(6)
  v_mfma_f32_32x32x16_bf16 v[192:207], v[32:35], v[144:147], v[192:207]
  ds_read_b64_tr_b16 v[48:49], v17 offset:8192
  ds_read_b64_tr_b16 v[50:51], v17 offset:9216
  s_waitcnt lgkmcnt(6)
  v_mfma_f32_32x32x16_bf16 v[192:207], v[36:39], v[148:151], v[192:207]
  ds_read_b64_tr_b16 v[52:53], v17 offset:10240
  ds_read_b64_tr_b16 v[54:55], v17 offset:11264
  s_waitcnt lgkmcnt(6)
  v_mfma_f32_32x32x16_bf16 v[192:207], v[40:43], v[152:155], v[192:207]
  ds_read_b64_tr_b16 v[32:33], v17 offset:12288
  ds_read_b64_tr_b16 v[34:35], v17 offset:13312
  s_waitcnt lgkmcnt(6)
  v_mfma_f32_32x32x16_bf16 v[192:207], v[44:47], v[156:159], v[192:207]
  ds_read_b64_tr_b16 v[36:37], v17 offset:14336
  ds_read_b64_tr_b16 v[38:39], v17 offset:15360
  s_waitcnt lgkmcnt(6)
  v_mfma_f32_32x32x16_bf16 v[192:207], v[48:51], v[160:163], v[192:207]
  s_waitcnt vmcnt(6)
  s_waitcnt lgkmcnt(0)
  s_barrier
  v_add_u32 v16, 4294868992, v16
  v_add_u32 v17, 4294868992, v17
  ds_read_b64_tr_b16 v[40:41], v16 offset:0
  ds_read_b64_tr_b16 v[42:43], v16 offset:1024
  v_mfma_f32_32x32x16_bf16 v[192:207], v[52:55], v[164:167], v[192:207]
  ds_read_b64_tr_b16 v[44:45], v16 offset:2048
  ds_read_b64_tr_b16 v[46:47], v16 offset:3072
  v_mfma_f32_32x32x16_bf16 v[192:207], v[32:35], v[168:171], v[192:207]
  ds_read_b64_tr_b16 v[48:49], v16 offset:4096
  ds_read_b64_tr_b16 v[50:51], v16 offset:5120
  v_mfma_f32_32x32x16_bf16 v[192:207], v[36:39], v[172:175], v[192:207]
  ds_read_b64_tr_b16 v[52:53], v16 offset:6144
  ds_read_b64_tr_b16 v[54:55], v16 offset:7168
  s_waitcnt lgkmcnt(6)
  v_mfma_f32_32x32x16_bf16 v[176:191], v[40:43], v[112:115], 0
  ds_read_b64_tr_b16 v[32:33], v16 offset:8192
  ds_read_b64_tr_b16 v[34:35], v16 offset:9216
  s_waitcnt lgkmcnt(6)
  v_mfma_f32_32x32x16_bf16 v[176:191], v[44:47], v[116:119], v[176:191]
  ds_read_b64_tr_b16 v[36:37], v16 offset:10240
  ds_read_b64_tr_b16 v[38:39], v16 offset:11264
  s_waitcnt lgkmcnt(6)
  v_mfma_f32_32x32x16_bf16 v[176:191], v[48:51], v[120:123], v[176:191]
  ds_read_b64_tr_b16 v[40:41], v16 offset:12288
  ds_read_b64_tr_b16 v[42:43], v16 offset:13312
  s_waitcnt lgkmcnt(6)
  v_mfma_f32_32x32x16_bf16 v[176:191], v[52:55], v[124:127], v[176:191]
  ds_read_b64_tr_b16 v[44:45], v16 offset:14336
  ds_read_b64_tr_b16 v[46:47], v16 offset:15360
  v_cvt_pk_bf16_f32 v216, v192, v193
  v_cvt_pk_bf16_f32 v217, v194, v195
  s_waitcnt lgkmcnt(6)
  v_mfma_f32_32x32x16_bf16 v[176:191], v[32:35], v[128:131], v[176:191]
  ds_read_b64_tr_b16 v[48:49], v17 offset:0
  ds_read_b64_tr_b16 v[50:51], v17 offset:1024
  v_cvt_pk_bf16_f32 v218, v196, v197
  v_cvt_pk_bf16_f32 v219, v198, v199
  s_waitcnt lgkmcnt(6)
  v_mfma_f32_32x32x16_bf16 v[176:191], v[36:39], v[132:135], v[176:191]
  ds_read_b64_tr_b16 v[52:53], v17 offset:2048
  ds_read_b64_tr_b16 v[54:55], v17 offset:3072
  s_add_u32 s46, s33, 7168
  buffer_store_dwordx4 v[216:219], v2, s[20:23], s46 offen sc1
  v_cvt_pk_bf16_f32 v220, v200, v201
  s_waitcnt lgkmcnt(6)
  v_mfma_f32_32x32x16_bf16 v[176:191], v[40:43], v[136:139], v[176:191]
  ds_read_b64_tr_b16 v[32:33], v17 offset:4096
  ds_read_b64_tr_b16 v[34:35], v17 offset:5120
  v_cvt_pk_bf16_f32 v221, v202, v203
  v_cvt_pk_bf16_f32 v222, v204, v205
  s_waitcnt lgkmcnt(6)
  v_mfma_f32_32x32x16_bf16 v[176:191], v[44:47], v[140:143], v[176:191]
  ds_read_b64_tr_b16 v[36:37], v17 offset:6144
  ds_read_b64_tr_b16 v[38:39], v17 offset:7168
  v_cvt_pk_bf16_f32 v223, v206, v207
  buffer_store_dwordx4 v[220:223], v2, s[20:23], s46 offen offset:256 sc1
  s_waitcnt lgkmcnt(6)
  v_mfma_f32_32x32x16_bf16 v[176:191], v[48:51], v[144:147], v[176:191]
  ds_read_b64_tr_b16 v[40:41], v17 offset:8192
  ds_read_b64_tr_b16 v[42:43], v17 offset:9216
  s_waitcnt lgkmcnt(6)
  v_mfma_f32_32x32x16_bf16 v[176:191], v[52:55], v[148:151], v[176:191]
  ds_read_b64_tr_b16 v[44:45], v17 offset:10240
  ds_read_b64_tr_b16 v[46:47], v17 offset:11264
  s_waitcnt lgkmcnt(6)
  v_mfma_f32_32x32x16_bf16 v[176:191], v[32:35], v[152:155], v[176:191]
  ds_read_b64_tr_b16 v[48:49], v17 offset:12288
  ds_read_b64_tr_b16 v[50:51], v17 offset:13312
  s_waitcnt lgkmcnt(6)
  v_mfma_f32_32x32x16_bf16 v[176:191], v[36:39], v[156:159], v[176:191]
  ds_read_b64_tr_b16 v[52:53], v17 offset:14336
  ds_read_b64_tr_b16 v[54:55], v17 offset:15360
  s_waitcnt lgkmcnt(6)
  v_mfma_f32_32x32x16_bf16 v[176:191], v[40:43], v[160:163], v[176:191]
  s_waitcnt lgkmcnt(4)
  v_mfma_f32_32x32x16_bf16 v[176:191], v[44:47], v[164:167], v[176:191]
  s_waitcnt lgkmcnt(2)
  v_mfma_f32_32x32x16_bf16 v[176:191], v[48:51], v[168:171], v[176:191]
  s_waitcnt lgkmcnt(0)
  v_mfma_f32_32x32x16_bf16 v[176:191], v[52:55], v[172:175], v[176:191]
  s_nop 11
  v_cvt_pk_bf16_f32 v208, v176, v177
  v_cvt_pk_bf16_f32 v209, v178, v179
  v_cvt_pk_bf16_f32 v210, v180, v181
  v_cvt_pk_bf16_f32 v211, v182, v183
  s_add_u32 s46, s33, 8192
  buffer_store_dwordx4 v[208:211], v2, s[20:23], s46 offen sc1
  v_cvt_pk_bf16_f32 v212, v184, v185
  v_cvt_pk_bf16_f32 v213, v186, v187
  v_cvt_pk_bf16_f32 v214, v188, v189
  v_cvt_pk_bf16_f32 v215, v190, v191
  buffer_store_dwordx4 v[212:215], v2, s[20:23], s46 offen offset:256 sc1
  s_load_dwordx2 s[4:5], s[0:1], 0
  s_mov_b32 s6, 2359296
  s_mov_b32 s7, 0x00020000
  s_load_dwordx2 s[8:9], s[0:1], 88
  s_mov_b32 s10, 2359296
  s_mov_b32 s11, 0x00020000
  v_mbcnt_lo_u32_b32 v0, -1, 0
  v_mbcnt_hi_u32_b32 v0, -1, v0
  s_lshl_b32 s16, s24, 6
  v_add_u32 v0, s16, v0
  v_lshlrev_b32 v1, 4, v0
  v_and_b32 v2, 7, v0
  v_lshrrev_b32 v5, 3, v0
  v_mul_u32_u24 v4, 1152, v2
  v_lshl_add_u32 v158, v5, 2, v4
  v_add_u32 v158, 1024, v158
  v_lshl_add_u32 v4, v5, 4, v4
  v_lshlrev_b32 v159, 3, v5
  v_add_u32 v159, 2048, v159
  v_and_b32 v157, 3, v5
  v_lshlrev_b32 v157, 2, v157
  v_lshl_add_u32 v157, v2, 4, v157
  v_lshrrev_b32 v3, 5, v0
  v_lshl_add_u32 v157, v3, 7, v157
  v_add_u32 v157, 8192, v157
  v_lshlrev_b32 v5, 5, v5
  v_lshlrev_b32 v2, 6, v2
  s_lshl_b32 s17, s24, 2
  v_add_u32 v3, s17, v2
  s_lshl_b32 s16, s26, 4
  s_add_u32 s16, s16, s25
  s_mul_i32 s16, s16, 9216
  s_cmp_lt_u32 s24, 4
  s_cselect_b32 s44, 1.0, 0
  s_cselect_b64 s[40:41], -1, 0
  v_mov_b32 v12, 0
  v_mov_b32 v140, 0
  v_mov_b32 v141, 0
  v_mov_b32 v142, 0
  v_mov_b32 v143, 0
  v_mov_b32 v144, 0
  v_mov_b32 v145, 0
  v_mov_b32 v146, 0
  v_mov_b32 v147, 0
  v_mov_b32 v148, 0
  v_mov_b32 v149, 0
  v_mov_b32 v150, 0
  v_mov_b32 v151, 0
  v_mov_b32 v152, 0
  v_mov_b32 v153, 0
  v_mov_b32 v154, 0
  v_mov_b32 v155, 0
  v_mov_b32 v40, 0
  v_mov_b32 v41, 0
  v_mov_b32 v42, 0
  v_mov_b32 v43, 0
  v_mov_b32 v44, 0
  v_mov_b32 v45, 0
  v_mov_b32 v7, 1024
  v_mov_b32 v6, 0
  ds_write_b32 v7, v6
  s_mov_b32 s45, 0
  s_mov_b32 s46, 0
  s_add_u32 s47, s16, 16777216
  s_waitcnt vmcnt(0) lgkmcnt(0)
  s_barrier
  s_cmp_eq_u32 s24, 0
  s_cbranch_scc0 k2_pg3_d
  s_lshl_b32 s17, s26, 8
  s_add_u32 s17, s17, 32768
  s_lshl_b32 s19, s25, 2
  s_add_u32 s19, s19, s17
  s_mov_b32 s18, 0x40000
  v_mov_b32 v6, 1
  v_lshlrev_b32 v156, 2, v0
  s_mov_b64 exec, 1
  buffer_store_dword v6, v156, s[20:23], s19 offen sc1
  s_mov_b64 exec, 0xffff
k2_pg3_p:
  buffer_load_dword v6, v156, s[20:23], s17 offen sc1
  s_waitcnt vmcnt(0)
  v_cmp_eq_u32 vcc, 1, v6
  s_sub_u32 s18, s18, 1
  s_cselect_b32 s45, 0xffff, vcc_lo
  v_mov_b32 v6, s45
  ds_write_b32 v7, v6
  s_cmp_eq_u32 s45, 0xffff
  s_cbranch_scc1 k2_pg3_x
  s_sleep 2
  s_branch k2_pg3_p
k2_pg3_x:
  s_mov_b64 exec, -1
k2_pg3_d:
  s_waitcnt lgkmcnt(0)
  s_add_u32 s17, s16, 3145728
  s_mov_b64 exec, s[40:41]
  buffer_load_dword v12, v158, s[4:7], s16 offen
  s_movk_i32 s18, 4608
  buffer_load_dwordx2 v[40:41], v159, s[20:23], s18 offen
  s_movk_i32 s18, 6912
  buffer_load_dwordx2 v[42:43], v159, s[20:23], s18 offen
  s_movk_i32 s18, 9216
  buffer_load_dwordx2 v[44:45], v159, s[20:23], s18 offen
  s_mov_b64 exec, -1
  buffer_load_dwordx4 v[8:11], v4, s[4:7], s16 offen
  s_movk_i32 s18, 4608
  buffer_load_dwordx4 v[16:19], v5, s[20:23], s18 offen
  buffer_load_dwordx4 v[20:23], v5, s[20:23], s18 offen offset:16
  s_movk_i32 s18, 6912
  buffer_load_dwordx4 v[24:27], v5, s[20:23], s18 offen
  buffer_load_dwordx4 v[28:31], v5, s[20:23], s18 offen offset:16
  s_movk_i32 s18, 9216
  buffer_load_dwordx4 v[32:35], v5, s[20:23], s18 offen
  buffer_load_dwordx4 v[36:39], v5, s[20:23], s18 offen offset:16
k2_pg3_l0:
  s_andn2_b32 s18, s45, s46
  s_cbranch_scc1 k2_pg3_g0
  s_sleep 1
  ds_read_b32 v6, v7
  s_waitcnt lgkmcnt(0)
  v_readfirstlane_b32 s45, v6
  s_branch k2_pg3_l0
k2_pg3_g0:
  s_ff1_i32_b32 s18, s18
  s_bitset1_b32 s46, s18
  s_mul_i32 s17, s18, 2359296
  s_add_u32 s17, s17, s47
  s_mov_b64 exec, s[40:41]
  buffer_load_dword v140, v157, s[20:23], s17 offen sc1
  s_mov_b64 exec, -1
  buffer_load_dwordx4 v[48:51], v1, s[20:23], s17 offen sc1
k2_pg3_l1:
  s_andn2_b32 s18, s45, s46
  s_cbranch_scc1 k2_pg3_g1
  s_sleep 1
  ds_read_b32 v6, v7
  s_waitcnt lgkmcnt(0)
  v_readfirstlane_b32 s45, v6
  s_branch k2_pg3_l1
k2_pg3_g1:
  s_ff1_i32_b32 s18, s18
  s_bitset1_b32 s46, s18
  s_mul_i32 s17, s18, 2359296
  s_add_u32 s17, s17, s47
  s_mov_b64 exec, s[40:41]
  buffer_load_dword v141, v157, s[20:23], s17 offen sc1
  s_mov_b64 exec, -1
  buffer_load_dwordx4 v[52:55], v1, s[20:23], s17 offen sc1
k2_pg3_l2:
  s_andn2_b32 s18, s45, s46
  s_cbranch_scc1 k2_pg3_g2
  s_sleep 1
  ds_read_b32 v6, v7
  s_waitcnt lgkmcnt(0)
  v_readfirstlane_b32 s45, v6
  s_branch k2_pg3_l2
k2_pg3_g2:
  s_ff1_i32_b32 s18, s18
  s_bitset1_b32 s46, s18
  s_mul_i32 s17, s18, 2359296
  s_add_u32 s17, s17, s47
  s_mov_b64 exec, s[40:41]
  buffer_load_dword v142, v157, s[20:23], s17 offen sc1
  s_mov_b64 exec, -1
  buffer_load_dwordx4 v[56:59], v1, s[20:23], s17 offen sc1
k2_pg3_l3:
  s_andn2_b32 s18, s45, s46
  s_cbranch_scc1 k2_pg3_g3
  s_sleep 1
  ds_read_b32 v6, v7
  s_waitcnt lgkmcnt(0)
  v_readfirstlane_b32 s45, v6
  s_branch k2_pg3_l3
k2_pg3_g3:
  s_ff1_i32_b32 s18, s18
  s_bitset1_b32 s46, s18
  s_mul_i32 s17, s18, 2359296
  s_add_u32 s17, s17, s47
  s_mov_b64 exec, s[40:41]
  buffer_load_dword v143, v157, s[20:23], s17 offen sc1
  s_mov_b64 exec, -1
  buffer_load_dwordx4 v[60:63], v1, s[20:23], s17 offen sc1
k2_pg3_l4:
  s_andn2_b32 s18, s45, s46
  s_cbranch_scc1 k2_pg3_g4
  s_sleep 1
  ds_read_b32 v6, v7
  s_waitcnt lgkmcnt(0)
  v_readfirstlane_b32 s45, v6
  s_branch k2_pg3_l4
k2_pg3_g4:
  s_ff1_i32_b32 s18, s18
  s_bitset1_b32 s46, s18
  s_mul_i32 s17, s18, 2359296
  s_add_u32 s17, s17, s47
  s_mov_b64 exec, s[40:41]
  buffer_load_dword v144, v157, s[20:23], s17 offen sc1
  s_mov_b64 exec, -1
  buffer_load_dwordx4 v[64:67], v1, s[20:23], s17 offen sc1
k2_pg3_l5:
  s_andn2_b32 s18, s45, s46
  s_cbranch_scc1 k2_pg3_g5
  s_sleep 1
  ds_read_b32 v6, v7
  s_waitcnt lgkmcnt(0)
  v_readfirstlane_b32 s45, v6
  s_branch k2_pg3_l5
k2_pg3_g5:
  s_ff1_i32_b32 s18, s18
  s_bitset1_b32 s46, s18
  s_mul_i32 s17, s18, 2359296
  s_add_u32 s17, s17, s47
  s_mov_b64 exec, s[40:41]
  buffer_load_dword v145, v157, s[20:23], s17 offen sc1
  s_mov_b64 exec, -1
  buffer_load_dwordx4 v[68:71], v1, s[20:23], s17 offen sc1
k2_pg3_l6:
  s_andn2_b32 s18, s45, s46
  s_cbranch_scc1 k2_pg3_g6
  s_sleep 1
  ds_read_b32 v6, v7
  s_waitcnt lgkmcnt(0)
  v_readfirstlane_b32 s45, v6
  s_branch k2_pg3_l6
k2_pg3_g6:
  s_ff1_i32_b32 s18, s18
  s_bitset1_b32 s46, s18
  s_mul_i32 s17, s18, 2359296
  s_add_u32 s17, s17, s47
  s_mov_b64 exec, s[40:41]
  buffer_load_dword v146, v157, s[20:23], s17 offen sc1
  s_mov_b64 exec, -1
  buffer_load_dwordx4 v[72:75], v1, s[20:23], s17 offen sc1
k2_pg3_l7:
  s_andn2_b32 s18, s45, s46
  s_cbranch_scc1 k2_pg3_g7
  s_sleep 1
  ds_read_b32 v6, v7
  s_waitcnt lgkmcnt(0)
  v_readfirstlane_b32 s45, v6
  s_branch k2_pg3_l7
k2_pg3_g7:
  s_ff1_i32_b32 s18, s18
  s_bitset1_b32 s46, s18
  s_mul_i32 s17, s18, 2359296
  s_add_u32 s17, s17, s47
  s_mov_b64 exec, s[40:41]
  buffer_load_dword v147, v157, s[20:23], s17 offen sc1
  s_mov_b64 exec, -1
  buffer_load_dwordx4 v[76:79], v1, s[20:23], s17 offen sc1
k2_pg3_l8:
  s_andn2_b32 s18, s45, s46
  s_cbranch_scc1 k2_pg3_g8
  s_sleep 1
  ds_read_b32 v6, v7
  s_waitcnt lgkmcnt(0)
  v_readfirstlane_b32 s45, v6
  s_branch k2_pg3_l8
k2_pg3_g8:
  s_ff1_i32_b32 s18, s18
  s_bitset1_b32 s46, s18
  s_mul_i32 s17, s18, 2359296
  s_add_u32 s17, s17, s47
  s_mov_b64 exec, s[40:41]
  buffer_load_dword v148, v157, s[20:23], s17 offen sc1
  s_mov_b64 exec, -1
  buffer_load_dwordx4 v[80:83], v1, s[20:23], s17 offen sc1
k2_pg3_l9:
  s_andn2_b32 s18, s45, s46
  s_cbranch_scc1 k2_pg3_g9
  s_sleep 1
  ds_read_b32 v6, v7
  s_waitcnt lgkmcnt(0)
  v_readfirstlane_b32 s45, v6
  s_branch k2_pg3_l9
k2_pg3_g9:
  s_ff1_i32_b32 s18, s18
  s_bitset1_b32 s46, s18
  s_mul_i32 s17, s18, 2359296
  s_add_u32 s17, s17, s47
  s_mov_b64 exec, s[40:41]
  buffer_load_dword v149, v157, s[20:23], s17 offen sc1
  s_mov_b64 exec, -1
  buffer_load_dwordx4 v[84:87], v1, s[20:23], s17 offen sc1
k2_pg3_l10:
  s_andn2_b32 s18, s45, s46
  s_cbranch_scc1 k2_pg3_g10
  s_sleep 1
  ds_read_b32 v6, v7
  s_waitcnt lgkmcnt(0)
  v_readfirstlane_b32 s45, v6
  s_branch k2_pg3_l10
k2_pg3_g10:
  s_ff1_i32_b32 s18, s18
  s_bitset1_b32 s46, s18
  s_mul_i32 s17, s18, 2359296
  s_add_u32 s17, s17, s47
  s_mov_b64 exec, s[40:41]
  buffer_load_dword v150, v157, s[20:23], s17 offen sc1
  s_mov_b64 exec, -1
  buffer_load_dwordx4 v[88:91], v1, s[20:23], s17 offen sc1
k2_pg3_l11:
  s_andn2_b32 s18, s45, s46
  s_cbranch_scc1 k2_pg3_g11
  s_sleep 1
  ds_read_b32 v6, v7
  s_waitcnt lgkmcnt(0)
  v_readfirstlane_b32 s45, v6
  s_branch k2_pg3_l11
k2_pg3_g11:
  s_ff1_i32_b32 s18, s18
  s_bitset1_b32 s46, s18
  s_mul_i32 s17, s18, 2359296
  s_add_u32 s17, s17, s47
  s_mov_b64 exec, s[40:41]
  buffer_load_dword v151, v157, s[20:23], s17 offen sc1
  s_mov_b64 exec, -1
  buffer_load_dwordx4 v[92:95], v1, s[20:23], s17 offen sc1
k2_pg3_l12:
  s_andn2_b32 s18, s45, s46
  s_cbranch_scc1 k2_pg3_g12
  s_sleep 1
  ds_read_b32 v6, v7
  s_waitcnt lgkmcnt(0)
  v_readfirstlane_b32 s45, v6
  s_branch k2_pg3_l12
k2_pg3_g12:
  s_ff1_i32_b32 s18, s18
  s_bitset1_b32 s46, s18
  s_mul_i32 s17, s18, 2359296
  s_add_u32 s17, s17, s47
  s_mov_b64 exec, s[40:41]
  buffer_load_dword v152, v157, s[20:23], s17 offen sc1
  s_mov_b64 exec, -1
  buffer_load_dwordx4 v[96:99], v1, s[20:23], s17 offen sc1
k2_pg3_l13:
  s_andn2_b32 s18, s45, s46
  s_cbranch_scc1 k2_pg3_g13
  s_sleep 1
  ds_read_b32 v6, v7
  s_waitcnt lgkmcnt(0)
  v_readfirstlane_b32 s45, v6
  s_branch k2_pg3_l13
k2_pg3_g13:
  s_ff1_i32_b32 s18, s18
  s_bitset1_b32 s46, s18
  s_mul_i32 s17, s18, 2359296
  s_add_u32 s17, s17, s47
  s_mov_b64 exec, s[40:41]
  buffer_load_dword v153, v157, s[20:23], s17 offen sc1
  s_mov_b64 exec, -1
  buffer_load_dwordx4 v[100:103], v1, s[20:23], s17 offen sc1
k2_pg3_l14:
  s_andn2_b32 s18, s45, s46
  s_cbranch_scc1 k2_pg3_g14
  s_sleep 1
  ds_read_b32 v6, v7
  s_waitcnt lgkmcnt(0)
  v_readfirstlane_b32 s45, v6
  s_branch k2_pg3_l14
k2_pg3_g14:
  s_ff1_i32_b32 s18, s18
  s_bitset1_b32 s46, s18
  s_mul_i32 s17, s18, 2359296
  s_add_u32 s17, s17, s47
  s_mov_b64 exec, s[40:41]
  buffer_load_dword v154, v157, s[20:23], s17 offen sc1
  s_mov_b64 exec, -1
  buffer_load_dwordx4 v[104:107], v1, s[20:23], s17 offen sc1
k2_pg3_l15:
  s_andn2_b32 s18, s45, s46
  s_cbranch_scc1 k2_pg3_g15
  s_sleep 1
  ds_read_b32 v6, v7
  s_waitcnt lgkmcnt(0)
  v_readfirstlane_b32 s45, v6
  s_branch k2_pg3_l15
k2_pg3_g15:
  s_ff1_i32_b32 s18, s18
  s_bitset1_b32 s46, s18
  s_mul_i32 s17, s18, 2359296
  s_add_u32 s17, s17, s47
  s_mov_b64 exec, s[40:41]
  buffer_load_dword v155, v157, s[20:23], s17 offen sc1
  s_mov_b64 exec, -1
  buffer_load_dwordx4 v[108:111], v1, s[20:23], s17 offen sc1
  s_waitcnt vmcnt(15)
  v_lshlrev_b32 v112, 16, v48
  v_and_b32 v113, 0xffff0000, v48
  v_lshlrev_b32 v114, 16, v49
  v_and_b32 v115, 0xffff0000, v49
  v_lshlrev_b32 v116, 16, v50
  v_and_b32 v117, 0xffff0000, v50
  v_lshlrev_b32 v118, 16, v51
  v_and_b32 v119, 0xffff0000, v51
  v_lshlrev_b32 v120, 16, v140
  v_and_b32 v121, 0xffff0000, v140
  s_waitcnt vmcnt(14)
  v_lshlrev_b32 v124, 16, v52
  v_and_b32 v125, 0xffff0000, v52
  v_lshlrev_b32 v126, 16, v53
  v_and_b32 v127, 0xffff0000, v53
  v_lshlrev_b32 v128, 16, v54
  v_and_b32 v129, 0xffff0000, v54
  v_lshlrev_b32 v130, 16, v55
  v_and_b32 v131, 0xffff0000, v55
  v_lshlrev_b32 v132, 16, v141
  v_and_b32 v133, 0xffff0000, v141
  v_add_f32 v112, v112, v124
  v_add_f32 v113, v113, v125
  v_add_f32 v114, v114, v126
  v_add_f32 v115, v115, v127
  v_add_f32 v116, v116, v128
  v_add_f32 v117, v117, v129
  v_add_f32 v118, v118, v130
  v_add_f32 v119, v119, v131
  v_add_f32 v120, v120, v132
  v_add_f32 v121, v121, v133
  s_waitcnt vmcnt(13)
  v_lshlrev_b32 v124, 16, v56
  v_and_b32 v125, 0xffff0000, v56
  v_lshlrev_b32 v126, 16, v57
  v_and_b32 v127, 0xffff0000, v57
  v_lshlrev_b32 v128, 16, v58
  v_and_b32 v129, 0xffff0000, v58
  v_lshlrev_b32 v130, 16, v59
  v_and_b32 v131, 0xffff0000, v59
  v_lshlrev_b32 v132, 16, v142
  v_and_b32 v133, 0xffff0000, v142
  v_add_f32 v112, v112, v124
  v_add_f32 v113, v113, v125
  v_add_f32 v114, v114, v126
  v_add_f32 v115, v115, v127
  v_add_f32 v116, v116, v128
  v_add_f32 v117, v117, v129
  v_add_f32 v118, v118, v130
  v_add_f32 v119, v119, v131
  v_add_f32 v120, v120, v132
  v_add_f32 v121, v121, v133
  s_waitcnt vmcnt(12)
  v_lshlrev_b32 v124, 16, v60
  v_and_b32 v125, 0xffff0000, v60
  v_lshlrev_b32 v126, 16, v61
  v_and_b32 v127, 0xffff0000, v61
  v_lshlrev_b32 v128, 16, v62
  v_and_b32 v129, 0xffff0000, v62
  v_lshlrev_b32 v130, 16, v63
  v_and_b32 v131, 0xffff0000, v63
  v_lshlrev_b32 v132, 16, v143
  v_and_b32 v133, 0xffff0000, v143
  v_add_f32 v112, v112, v124
  v_add_f32 v113, v113, v125
  v_add_f32 v114, v114, v126
  v_add_f32 v115, v115, v127
  v_add_f32 v116, v116, v128
  v_add_f32 v117, v117, v129
  v_add_f32 v118, v118, v130
  v_add_f32 v119, v119, v131
  v_add_f32 v120, v120, v132
  v_add_f32 v121, v121, v133
  s_waitcnt vmcnt(11)
  v_lshlrev_b32 v124, 16, v64
  v_and_b32 v125, 0xffff0000, v64
  v_lshlrev_b32 v126, 16, v65
  v_and_b32 v127, 0xffff0000, v65
  v_lshlrev_b32 v128, 16, v66
  v_and_b32 v129, 0xffff0000, v66
  v_lshlrev_b32 v130, 16, v67
  v_and_b32 v131, 0xffff0000, v67
  v_lshlrev_b32 v132, 16, v144
  v_and_b32 v133, 0xffff0000, v144
  v_add_f32 v112, v112, v124
  v_add_f32 v113, v113, v125
  v_add_f32 v114, v114, v126
  v_add_f32 v115, v115, v127
  v_add_f32 v116, v116, v128
  v_add_f32 v117, v117, v129
  v_add_f32 v118, v118, v130
  v_add_f32 v119, v119, v131
  v_add_f32 v120, v120, v132
  v_add_f32 v121, v121, v133
  s_waitcnt vmcnt(10)
  v_lshlrev_b32 v124, 16, v68
  v_and_b32 v125, 0xffff0000, v68
  v_lshlrev_b32 v126, 16, v69
  v_and_b32 v127, 0xffff0000, v69
  v_lshlrev_b32 v128, 16, v70
  v_and_b32 v129, 0xffff0000, v70
  v_lshlrev_b32 v130, 16, v71
  v_and_b32 v131, 0xffff0000, v71
  v_lshlrev_b32 v132, 16, v145
  v_and_b32 v133, 0xffff0000, v145
  v_add_f32 v112, v112, v124
  v_add_f32 v113, v113, v125
  v_add_f32 v114, v114, v126
  v_add_f32 v115, v115, v127
  v_add_f32 v116, v116, v128
  v_add_f32 v117, v117, v129
  v_add_f32 v118, v118, v130
  v_add_f32 v119, v119, v131
  v_add_f32 v120, v120, v132
  v_add_f32 v121, v121, v133
  s_waitcnt vmcnt(9)
  v_lshlrev_b32 v124, 16, v72
  v_and_b32 v125, 0xffff0000, v72
  v_lshlrev_b32 v126, 16, v73
  v_and_b32 v127, 0xffff0000, v73
  v_lshlrev_b32 v128, 16, v74
  v_and_b32 v129, 0xffff0000, v74
  v_lshlrev_b32 v130, 16, v75
  v_and_b32 v131, 0xffff0000, v75
  v_lshlrev_b32 v132, 16, v146
  v_and_b32 v133, 0xffff0000, v146
  v_add_f32 v112, v112, v124
  v_add_f32 v113, v113, v125
  v_add_f32 v114, v114, v126
  v_add_f32 v115, v115, v127
  v_add_f32 v116, v116, v128
  v_add_f32 v117, v117, v129
  v_add_f32 v118, v118, v130
  v_add_f32 v119, v119, v131
  v_add_f32 v120, v120, v132
  v_add_f32 v121, v121, v133
  s_waitcnt vmcnt(8)
  v_lshlrev_b32 v124, 16, v76
  v_and_b32 v125, 0xffff0000, v76
  v_lshlrev_b32 v126, 16, v77
  v_and_b32 v127, 0xffff0000, v77
  v_lshlrev_b32 v128, 16, v78
  v_and_b32 v129, 0xffff0000, v78
  v_lshlrev_b32 v130, 16, v79
  v_and_b32 v131, 0xffff0000, v79
  v_lshlrev_b32 v132, 16, v147
  v_and_b32 v133, 0xffff0000, v147
  v_add_f32 v112, v112, v124
  v_add_f32 v113, v113, v125
  v_add_f32 v114, v114, v126
  v_add_f32 v115, v115, v127
  v_add_f32 v116, v116, v128
  v_add_f32 v117, v117, v129
  v_add_f32 v118, v118, v130
  v_add_f32 v119, v119, v131
  v_add_f32 v120, v120, v132
  v_add_f32 v121, v121, v133
  s_waitcnt vmcnt(7)
  v_lshlrev_b32 v124, 16, v80
  v_and_b32 v125, 0xffff0000, v80
  v_lshlrev_b32 v126, 16, v81
  v_and_b32 v127, 0xffff0000, v81
  v_lshlrev_b32 v128, 16, v82
  v_and_b32 v129, 0xffff0000, v82
  v_lshlrev_b32 v130, 16, v83
  v_and_b32 v131, 0xffff0000, v83
  v_lshlrev_b32 v132, 16, v148
  v_and_b32 v133, 0xffff0000, v148
  v_add_f32 v112, v112, v124
  v_add_f32 v113, v113, v125
  v_add_f32 v114, v114, v126
  v_add_f32 v115, v115, v127
  v_add_f32 v116, v116, v128
  v_add_f32 v117, v117, v129
  v_add_f32 v118, v118, v130
  v_add_f32 v119, v119, v131
  v_add_f32 v120, v120, v132
  v_add_f32 v121, v121, v133
  s_waitcnt vmcnt(6)
  v_lshlrev_b32 v124, 16, v84
  v_and_b32 v125, 0xffff0000, v84
  v_lshlrev_b32 v126, 16, v85
  v_and_b32 v127, 0xffff0000, v85
  v_lshlrev_b32 v128, 16, v86
  v_and_b32 v129, 0xffff0000, v86
  v_lshlrev_b32 v130, 16, v87
  v_and_b32 v131, 0xffff0000, v87
  v_lshlrev_b32 v132, 16, v149
  v_and_b32 v133, 0xffff0000, v149
  v_add_f32 v112, v112, v124
  v_add_f32 v113, v113, v125
  v_add_f32 v114, v114, v126
  v_add_f32 v115, v115, v127
  v_add_f32 v116, v116, v128
  v_add_f32 v117, v117, v129
  v_add_f32 v118, v118, v130
  v_add_f32 v119, v119, v131
  v_add_f32 v120, v120, v132
  v_add_f32 v121, v121, v133
  s_waitcnt vmcnt(5)
  v_lshlrev_b32 v124, 16, v88
  v_and_b32 v125, 0xffff0000, v88
  v_lshlrev_b32 v126, 16, v89
  v_and_b32 v127, 0xffff0000, v89
  v_lshlrev_b32 v128, 16, v90
  v_and_b32 v129, 0xffff0000, v90
  v_lshlrev_b32 v130, 16, v91
  v_and_b32 v131, 0xffff0000, v91
  v_lshlrev_b32 v132, 16, v150
  v_and_b32 v133, 0xffff0000, v150
  v_add_f32 v112, v112, v124
  v_add_f32 v113, v113, v125
  v_add_f32 v114, v114, v126
  v_add_f32 v115, v115, v127
  v_add_f32 v116, v116, v128
  v_add_f32 v117, v117, v129
  v_add_f32 v118, v118, v130
  v_add_f32 v119, v119, v131
  v_add_f32 v120, v120, v132
  v_add_f32 v121, v121, v133
  s_waitcnt vmcnt(4)
  v_lshlrev_b32 v124, 16, v92
  v_and_b32 v125, 0xffff0000, v92
  v_lshlrev_b32 v126, 16, v93
  v_and_b32 v127, 0xffff0000, v93
  v_lshlrev_b32 v128, 16, v94
  v_and_b32 v129, 0xffff0000, v94
  v_lshlrev_b32 v130, 16, v95
  v_and_b32 v131, 0xffff0000, v95
  v_lshlrev_b32 v132, 16, v151
  v_and_b32 v133, 0xffff0000, v151
  v_add_f32 v112, v112, v124
  v_add_f32 v113, v113, v125
  v_add_f32 v114, v114, v126
  v_add_f32 v115, v115, v127
  v_add_f32 v116, v116, v128
  v_add_f32 v117, v117, v129
  v_add_f32 v118, v118, v130
  v_add_f32 v119, v119, v131
  v_add_f32 v120, v120, v132
  v_add_f32 v121, v121, v133
  s_waitcnt vmcnt(3)
  v_lshlrev_b32 v124, 16, v96
  v_and_b32 v125, 0xffff0000, v96
  v_lshlrev_b32 v126, 16, v97
  v_and_b32 v127, 0xffff0000, v97
  v_lshlrev_b32 v128, 16, v98
  v_and_b32 v129, 0xffff0000, v98
  v_lshlrev_b32 v130, 16, v99
  v_and_b32 v131, 0xffff0000, v99
  v_lshlrev_b32 v132, 16, v152
  v_and_b32 v133, 0xffff0000, v152
  v_add_f32 v112, v112, v124
  v_add_f32 v113, v113, v125
  v_add_f32 v114, v114, v126
  v_add_f32 v115, v115, v127
  v_add_f32 v116, v116, v128
  v_add_f32 v117, v117, v129
  v_add_f32 v118, v118, v130
  v_add_f32 v119, v119, v131
  v_add_f32 v120, v120, v132
  v_add_f32 v121, v121, v133
  s_waitcnt vmcnt(2)
  v_lshlrev_b32 v124, 16, v100
  v_and_b32 v125, 0xffff0000, v100
  v_lshlrev_b32 v126, 16, v101
  v_and_b32 v127, 0xffff0000, v101
  v_lshlrev_b32 v128, 16, v102
  v_and_b32 v129, 0xffff0000, v102
  v_lshlrev_b32 v130, 16, v103
  v_and_b32 v131, 0xffff0000, v103
  v_lshlrev_b32 v132, 16, v153
  v_and_b32 v133, 0xffff0000, v153
  v_add_f32 v112, v112, v124
  v_add_f32 v113, v113, v125
  v_add_f32 v114, v114, v126
  v_add_f32 v115, v115, v127
  v_add_f32 v116, v116, v128
  v_add_f32 v117, v117, v129
  v_add_f32 v118, v118, v130
  v_add_f32 v119, v119, v131
  v_add_f32 v120, v120, v132
  v_add_f32 v121, v121, v133
  s_waitcnt vmcnt(1)
  v_lshlrev_b32 v124, 16, v104
  v_and_b32 v125, 0xffff0000, v104
  v_lshlrev_b32 v126, 16, v105
  v_and_b32 v127, 0xffff0000, v105
  v_lshlrev_b32 v128, 16, v106
  v_and_b32 v129, 0xffff0000, v106
  v_lshlrev_b32 v130, 16, v107
  v_and_b32 v131, 0xffff0000, v107
  v_lshlrev_b32 v132, 16, v154
  v_and_b32 v133, 0xffff0000, v154
  v_add_f32 v112, v112, v124
  v_add_f32 v113, v113, v125
  v_add_f32 v114, v114, v126
  v_add_f32 v115, v115, v127
  v_add_f32 v116, v116, v128
  v_add_f32 v117, v117, v129
  v_add_f32 v118, v118, v130
  v_add_f32 v119, v119, v131
  v_add_f32 v120, v120, v132
  v_add_f32 v121, v121, v133
  s_waitcnt vmcnt(0)
  v_lshlrev_b32 v124, 16, v108
  v_and_b32 v125, 0xffff0000, v108
  v_lshlrev_b32 v126, 16, v109
  v_and_b32 v127, 0xffff0000, v109
  v_lshlrev_b32 v128, 16, v110
  v_and_b32 v129, 0xffff0000, v110
  v_lshlrev_b32 v130, 16, v111
  v_and_b32 v131, 0xffff0000, v111
  v_lshlrev_b32 v132, 16, v155
  v_and_b32 v133, 0xffff0000, v155
  v_add_f32 v112, v112, v124
  v_add_f32 v113, v113, v125
  v_add_f32 v114, v114, v126
  v_add_f32 v115, v115, v127
  v_add_f32 v116, v116, v128
  v_add_f32 v117, v117, v129
  v_add_f32 v118, v118, v130
  v_add_f32 v119, v119, v131
  v_add_f32 v120, v120, v132
  v_add_f32 v121, v121, v133
  v_lshlrev_b32 v124, 16, v8
  v_and_b32 v125, 0xffff0000, v8
  v_lshlrev_b32 v126, 16, v9
  v_and_b32 v127, 0xffff0000, v9
  v_lshlrev_b32 v128, 16, v10
  v_and_b32 v129, 0xffff0000, v10
  v_lshlrev_b32 v130, 16, v11
  v_and_b32 v131, 0xffff0000, v11
  v_lshlrev_b32 v132, 16, v12
  v_and_b32 v133, 0xffff0000, v12
  v_fma_f32 v112, v112, v16, v124
  v_fma_f32 v113, v113, v17, v125
  v_fma_f32 v114, v114, v18, v126
  v_fma_f32 v115, v115, v19, v127
  v_fma_f32 v116, v116, v20, v128
  v_fma_f32 v117, v117, v21, v129
  v_fma_f32 v118, v118, v22, v130
  v_fma_f32 v119, v119, v23, v131
  v_fma_f32 v120, v120, v40, v132
  v_fma_f32 v121, v121, v41, v133
  v_cvt_pk_bf16_f32 v8, v112, v113
  v_cvt_pk_bf16_f32 v9, v114, v115
  v_cvt_pk_bf16_f32 v10, v116, v117
  v_cvt_pk_bf16_f32 v11, v118, v119
  v_cvt_pk_bf16_f32 v12, v120, v121
  s_add_u32 s17, s16, 3145728
  buffer_store_dwordx4 v[8:11], v1, s[20:23], s17 offen sc1
  s_mov_b64 exec, s[40:41]
  buffer_store_dword v12, v157, s[20:23], s17 offen sc1
  s_mov_b64 exec, -1
  v_lshlrev_b32 v112, 16, v8
  v_and_b32 v113, 0xffff0000, v8
  v_lshlrev_b32 v114, 16, v9
  v_and_b32 v115, 0xffff0000, v9
  v_lshlrev_b32 v116, 16, v10
  v_and_b32 v117, 0xffff0000, v10
  v_lshlrev_b32 v118, 16, v11
  v_and_b32 v119, 0xffff0000, v11
  v_lshlrev_b32 v120, 16, v12
  v_and_b32 v121, 0xffff0000, v12
  v_add_f32 v6, v112, v113
  v_add_f32 v6, v6, v114
  v_add_f32 v6, v6, v115
  v_add_f32 v6, v6, v116
  v_add_f32 v6, v6, v117
  v_add_f32 v6, v6, v118
  v_add_f32 v6, v6, v119
  v_add_f32 v6, v6, v120
  v_add_f32 v6, v6, v121
  s_nop 1
  v_add_f32_dpp v6, v6, v6 row_ror:8 row_mask:0xf bank_mask:0xf
  ds_swizzle_b32 v124, v6 offset:0x401F
  s_waitcnt lgkmcnt(0)
  v_add_f32 v6, v6, v124
  v_mov_b32 v124, v6
  s_nop 1
  v_permlane32_swap_b32 v6, v124
  v_add_f32 v6, v6, v124
  ds_write_b32 v3, v6 offset:0
  s_waitcnt lgkmcnt(0)
  s_barrier
  ds_read_b128 v[124:127], v2 offset:0
  ds_read_b128 v[128:131], v2 offset:16
  s_waitcnt lgkmcnt(0)
  v_add_f32 v124, v124, v125
  v_add_f32 v126, v126, v127
  v_add_f32 v128, v128, v129
  v_add_f32 v130, v130, v131
  v_add_f32 v124, v124, v126
  v_add_f32 v128, v128, v130
  v_add_f32 v6, v124, v128
  v_mul_f32 v6, 0x3ae38e39, v6
  v_sub_f32 v112, v112, v6
  v_sub_f32 v113, v113, v6
  v_sub_f32 v114, v114, v6
  v_sub_f32 v115, v115, v6
  v_sub_f32 v116, v116, v6
  v_sub_f32 v117, v117, v6
  v_sub_f32 v118, v118, v6
  v_sub_f32 v119, v119, v6
  v_sub_f32 v120, v120, v6
  v_sub_f32 v121, v121, v6
  v_mul_f32 v120, s44, v120
  v_mul_f32 v121, s44, v121
  v_mul_f32 v6, v112, v112
  v_fmac_f32 v6, v113, v113
  v_fmac_f32 v6, v114, v114
  v_fmac_f32 v6, v115, v115
  v_fmac_f32 v6, v116, v116
  v_fmac_f32 v6, v117, v117
  v_fmac_f32 v6, v118, v118
  v_fmac_f32 v6, v119, v119
  v_fmac_f32 v6, v120, v120
  v_fmac_f32 v6, v121, v121
  s_nop 1
  v_add_f32_dpp v6, v6, v6 row_ror:8 row_mask:0xf bank_mask:0xf
  ds_swizzle_b32 v124, v6 offset:0x401F
  s_waitcnt lgkmcnt(0)
  v_add_f32 v6, v6, v124
  v_mov_b32 v124, v6
  s_nop 1
  v_permlane32_swap_b32 v6, v124
  v_add_f32 v6, v6, v124
  ds_write_b32 v3, v6 offset:512
  s_waitcnt lgkmcnt(0)
  s_barrier
  ds_read_b128 v[124:127], v2 offset:512
  ds_read_b128 v[128:131], v2 offset:528
  s_waitcnt lgkmcnt(0)
  v_add_f32 v124, v124, v125
  v_add_f32 v126, v126, v127
  v_add_f32 v128, v128, v129
  v_add_f32 v130, v130, v131
  v_add_f32 v124, v124, v126
  v_add_f32 v128, v128, v130
  v_add_f32 v6, v124, v128
  v_mov_b32 v7, 0x3727c5ac
  v_fmac_f32 v7, 0x3ae38e39, v6
  v_rsq_f32 v7, v7
  s_nop 0
  v_mul_f32 v112, v112, v7
  v_fma_f32 v112, v112, v32, v24
  v_mul_f32 v113, v113, v7
  v_fma_f32 v113, v113, v33, v25
  v_mul_f32 v114, v114, v7
  v_fma_f32 v114, v114, v34, v26
  v_mul_f32 v115, v115, v7
  v_fma_f32 v115, v115, v35, v27
  v_mul_f32 v116, v116, v7
  v_fma_f32 v116, v116, v36, v28
  v_mul_f32 v117, v117, v7
  v_fma_f32 v117, v117, v37, v29
  v_mul_f32 v118, v118, v7
  v_fma_f32 v118, v118, v38, v30
  v_mul_f32 v119, v119, v7
  v_fma_f32 v119, v119, v39, v31
  v_mul_f32 v120, v120, v7
  v_fma_f32 v120, v120, v44, v42
  v_mul_f32 v121, v121, v7
  v_fma_f32 v121, v121, v45, v43
  v_cvt_pk_bf16_f32 v48, v112, v113
  v_cvt_pk_bf16_f32 v49, v114, v115
  v_cvt_pk_bf16_f32 v50, v116, v117
  v_cvt_pk_bf16_f32 v51, v118, v119
  v_cvt_pk_bf16_f32 v52, v120, v121
  s_add_u32 s17, s16, 6291456
  buffer_store_dwordx4 v[48:51], v1, s[20:23], s17 offen sc1
  s_mov_b64 exec, s[40:41]
  buffer_store_dword v52, v157, s[20:23], s17 offen sc1
  s_mov_b64 exec, -1
  s_waitcnt vmcnt(0) lgkmcnt(0)
  s_barrier
  s_lshl_b32 s45, s26, 8
  s_add_u32 s45, s45, 0x8040
  s_cmp_eq_u32 s24, 0
  s_cbranch_scc0 k2_gs_d
  v_mov_b32 v250, 1
  v_mov_b32 v251, 0
  s_mov_b64 exec, 1
  buffer_atomic_add v250, v251, s[20:23], s45 offen sc1
  s_mov_b64 exec, -1
k2_gs_d:
  s_load_dwordx2 s[4:5], s[0:1], 48
  s_mov_b32 s6, 5308416
  s_mov_b32 s7, 0x00020000
  s_load_dwordx2 s[12:13], s[0:1], 48
  s_mov_b32 s14, 5308416
  s_mov_b32 s15, 0x00020000
  s_load_dwordx2 s[8:9], s[0:1], 56
  s_mov_b32 s10, 5308416
  s_mov_b32 s11, 0x00020000
  s_load_dwordx2 s[16:17], s[0:1], 64
  s_mov_b32 s18, 5308416
  s_mov_b32 s19, 0x00020000
  v_and_b32 v1, 63, v0
  v_lshrrev_b32 v8, 6, v0
  s_nop 0
  v_readfirstlane_b32 s24, v8
  v_lshrrev_b32 v8, 5, v1
  v_bfe_u32 v9, v1, 2, 2
  v_bfe_u32 v10, v1, 4, 1
  v_and_b32 v11, 3, v1
  v_lshlrev_b32 v12, 1, v11
  v_lshrrev_b32 v13, 1, v11
  v_or_b32 v12, v12, v13
  v_and_b32 v12, 3, v12
  v_bfe_u32 v13, v1, 3, 2
  v_mul_u32_u24 v2, 9216, v13
  v_lshl_add_u32 v2, v8, 7, v2
  v_and_b32 v13, 7, v1
  v_lshl_add_u32 v2, v13, 4, v2
  s_cmp_lt_u32 s24, 4
  s_cbranch_scc1 k2_prio_9
  s_setprio 1
k2_prio_9:
  s_and_b32 s25, s2, 7
  s_bfe_u32 s26, s2, 0x10003
  s_lshl_b32 s26, s26, 3
  s_add_u32 s25, s25, s26
  s_lshr_b32 s26, s2, 4
  s_and_b32 s28, s24, 3
  s_lshr_b32 s29, s24, 2
  s_mul_i32 s30, s24, 4608
  s_lshl_b32 s31, s26, 2
  s_add_u32 s31, s31, s28
  s_mul_i32 s31, s31, 36864
  s_add_u32 s32, s31, 6291456
  s_mul_i32 s33, s25, 2359296
  s_add_u32 s33, s33, s31
  s_lshl_b32 s34, s29, 9
  s_add_u32 s33, s33, s34
  s_add_u32 s33, s33, 67108864
  s_mul_i32 s34, s25, 576
  s_mul_i32 s35, s28, 73728
  s_add_u32 s34, s34, s35
  s_mul_i32 s36, s25, 331776
  s_mul_i32 s35, s24, 41472
  s_add_u32 s36, s36, s35
  s_lshl_b32 s37, s29, 1
  v_add_u32 v13, 0, v1
  v_mul_u32_u24 v14, 1821, v13
  v_lshrrev_b32 v14, 16, v14
  v_mul_u32_u24 v15, 36, v14
  v_sub_u32 v13, v13, v15
  v_xor_b32 v13, s37, v13
  v_mul_u32_u24 v3, 9216, v14
  v_lshl_add_u32 v3, v13, 4, v3
  v_add_u32 v13, 64, v1
  v_mul_u32_u24 v14, 1821, v13
  v_lshrrev_b32 v14, 16, v14
  v_mul_u32_u24 v15, 36, v14
  v_sub_u32 v13, v13, v15
  v_xor_b32 v13, s37, v13
  v_mul_u32_u24 v4, 9216, v14
  v_lshl_add_u32 v4, v13, 4, v4
  v_subrev_u32 v4, 1024, v4
  v_add_u32 v13, 128, v1
  v_mul_u32_u24 v14, 1821, v13
  v_lshrrev_b32 v14, 16, v14
  v_mul_u32_u24 v15, 36, v14
  v_sub_u32 v13, v13, v15
  v_xor_b32 v13, s37, v13
  v_mul_u32_u24 v5, 9216, v14
  v_lshl_add_u32 v5, v13, 4, v5
  v_subrev_u32 v5, 2048, v5
  v_add_u32 v13, 192, v1
  v_mul_u32_u24 v14, 1821, v13
  v_lshrrev_b32 v14, 16, v14
  v_mul_u32_u24 v15, 36, v14
  v_sub_u32 v13, v13, v15
  v_xor_b32 v13, s37, v13
  v_mul_u32_u24 v6, 9216, v14
  v_lshl_add_u32 v6, v13, 4, v6
  v_subrev_u32 v6, 3072, v6
  v_add_u32 v13, 256, v1
  v_mul_u32_u24 v14, 1821, v13
  v_lshrrev_b32 v14, 16, v14
  v_mul_u32_u24 v15, 36, v14
  v_sub_u32 v13, v13, v15
  v_xor_b32 v13, s37, v13
  v_mul_u32_u24 v7, 9216, v14
  v_lshl_add_u32 v7, v13, 4, v7
  v_lshrrev_b32 v13, 3, v1
  v_mul_u32_u24 v19, 1152, v13
  v_bfe_u32 v13, v1, 2, 1
  v_xor_b32 v13, v13, v10
  v_lshl_add_u32 v19, v13, 6, v19
  v_lshl_add_u32 v19, v11, 4, v19
  v_lshl_add_u32 v13, v8, 3, v9
  v_mul_u32_u24 v16, 576, v13
  v_lshl_add_u32 v16, v11, 3, v16
  v_mul_u32_u24 v13, 18432, v10
  v_add_u32 v16, v16, v13
  v_xor_b32 v13, s29, v10
  v_lshl_add_u32 v16, v13, 5, v16
  v_lshl_add_u32 v13, v8, 2, v9
  v_lshlrev_b32 v17, 7, v13
  v_lshrrev_b32 v13, 1, v9
  v_xor_b32 v13, s29, v13
  v_lshl_add_u32 v17, v13, 6, v17
  v_lshl_add_u32 v17, v10, 5, v17
  v_lshl_add_u32 v17, v12, 3, v17
  s_lshl_b32 s38, s29, 11
  v_add_u32 v17, s38, v17
  v_xor_b32 v18, 0x800, v17
  v_add_u32 v17, 73728, v17
  v_add_u32 v18, 73728, v18
  v_lshlrev_b32 v13, 4, v1
  s_mul_i32 s38, s24, 9216
  v_add_u32 v20, s38, v13
  s_xor_b32 s38, s24, 4
  s_mul_i32 s38, s38, 9216
  v_add_u32 v21, s38, v13
  v_mov_b32 v22, 0xc0135761
  s_mov_b32 s42, 0xbdd2d3e8
  s_mov_b32 s43, s42
  v_mov_b32 v23, v22
  s_waitcnt lgkmcnt(0)
  s_cmp_eq_u32 s29, 0
  s_cselect_b32 s4, s4, s8
  s_cselect_b32 s5, s5, s9
  s_add_u32 m0, s30, 0
  s_add_u32 s38, s34, 0
  buffer_load_dwordx4 v3, s[4:7], s38 offen lds
  buffer_load_dwordx4 v4, s[4:7], s38 offen offset:1024 lds
  buffer_load_dwordx4 v5, s[4:7], s38 offen offset:2048 lds
  buffer_load_dwordx4 v6, s[4:7], s38 offen offset:3072 lds
  s_add_u32 m0, m0, 4096
  s_mov_b32 exec_hi, 0
  buffer_load_dwordx4 v7, s[4:7], s38 offen lds
  s_mov_b32 exec_hi, -1
  s_add_u32 m0, s30, 36864
  s_add_u32 s38, s34, 294912
  buffer_load_dwordx4 v3, s[4:7], s38 offen lds
  buffer_load_dwordx4 v4, s[4:7], s38 offen offset:1024 lds
  buffer_load_dwordx4 v5, s[4:7], s38 offen offset:2048 lds
  buffer_load_dwordx4 v6, s[4:7], s38 offen offset:3072 lds
  s_add_u32 m0, m0, 4096
  s_mov_b32 exec_hi, 0
  buffer_load_dwordx4 v7, s[4:7], s38 offen lds
  s_mov_b32 exec_hi, -1
  s_add_u32 m0, s30, 73728
  s_add_u32 s38, s34, 589824
  buffer_load_dwordx4 v3, s[4:7], s38 offen lds
  buffer_load_dwordx4 v4, s[4:7], s38 offen offset:1024 lds
  buffer_load_dwordx4 v5, s[4:7], s38 offen offset:2048 lds
  buffer_load_dwordx4 v6, s[4:7], s38 offen offset:3072 lds
  s_add_u32 m0, m0, 4096
  s_mov_b32 exec_hi, 0
  buffer_load_dwordx4 v7, s[4:7], s38 offen lds
  s_mov_b32 exec_hi, -1
  s_cmp_eq_u32 s24, 0
  s_cbranch_scc0 k2_gw_d
  s_mov_b32 s44, 0x40000
  s_mov_b64 exec, 1
k2_gw_p:
  buffer_load_dword v250, v251, s[20:23], s45 offen sc1
  s_waitcnt vmcnt(0)
  v_readfirstlane_b32 s47, v250
  s_sub_u32 s44, s44, 1
  s_cbranch_scc1 k2_gw_x
  s_cmp_ge_u32 s47, 16
  s_cbranch_scc1 k2_gw_x
  s_sleep 2
  s_branch k2_gw_p
k2_gw_x:
  s_mov_b64 exec, -1
k2_gw_d:
  s_barrier
  s_add_u32 s40, s32, 0
  buffer_load_dwordx4 v[64:67], v2, s[20:23], s40 offen sc1
  buffer_load_dwordx4 v[68:71], v2, s[20:23], s40 offen offset:256 sc1
  s_add_u32 s40, s32, 512
  buffer_load_dwordx4 v[72:75], v2, s[20:23], s40 offen sc1
  buffer_load_dwordx4 v[76:79], v2, s[20:23], s40 offen offset:256 sc1
  s_add_u32 s40, s32, 1024
  buffer_load_dwordx4 v[80:83], v2, s[20:23], s40 offen sc1
  buffer_load_dwordx4 v[84:87], v2, s[20:23], s40 offen offset:256 sc1
  s_waitcnt vmcnt(4)
  s_waitcnt lgkmcnt(0)
  s_barrier
  ds_read_b64_tr_b16 v[32:33], v16 offset:0
  ds_read_b64_tr_b16 v[34:35], v16 offset:2304
  ds_read_b64_tr_b16 v[36:37], v16 offset:64
  ds_read_b64_tr_b16 v[38:39], v16 offset:2368
  ds_read_b64_tr_b16 v[40:41], v16 offset:128
  ds_read_b64_tr_b16 v[42:43], v16 offset:2432
  ds_read_b64_tr_b16 v[44:45], v16 offset:192
  ds_read_b64_tr_b16 v[46:47], v16 offset:2496
  s_waitcnt lgkmcnt(6)
  v_mfma_f32_32x32x16_bf16 v[112:127], v[32:35], v[64:67], 0
  ds_read_b64_tr_b16 v[48:49], v16 offset:256
  ds_read_b64_tr_b16 v[50:51], v16 offset:2560
  s_waitcnt lgkmcnt(6)
  v_mfma_f32_32x32x16_bf16 v[128:143], v[36:39], v[64:67], 0
  ds_read_b64_tr_b16 v[52:53], v16 offset:320
  ds_read_b64_tr_b16 v[54:55], v16 offset:2624
  s_waitcnt lgkmcnt(6)
  v_mfma_f32_32x32x16_bf16 v[144:159], v[40:43], v[64:67], 0
  ds_read_b64_tr_b16 v[32:33], v16 offset:384
  ds_read_b64_tr_b16 v[34:35], v16 offset:2688
  s_add_u32 m0, s30, 110592
  s_add_u32 s38, s34, 884736
  buffer_load_dwordx4 v3, s[4:7], s38 offen lds
  s_waitcnt lgkmcnt(6)
  v_mfma_f32_32x32x16_bf16 v[160:175], v[44:47], v[64:67], 0
  ds_read_b64_tr_b16 v[36:37], v16 offset:448
  ds_read_b64_tr_b16 v[38:39], v16 offset:2752
  s_waitcnt lgkmcnt(6)
  v_mfma_f32_32x32x16_bf16 v[176:191], v[48:51], v[64:67], 0
  ds_read_b64_tr_b16 v[40:41], v16 offset:512
  ds_read_b64_tr_b16 v[42:43], v16 offset:2816
  s_waitcnt lgkmcnt(6)
  v_mfma_f32_32x32x16_bf16 v[192:207], v[52:55], v[64:67], 0
  ds_read_b64_tr_b16 v[44:45], v16 offset:9216
  ds_read_b64_tr_b16 v[46:47], v16 offset:11520
  buffer_load_dwordx4 v4, s[4:7], s38 offen offset:1024 lds
  s_waitcnt lgkmcnt(6)
  v_mfma_f32_32x32x16_bf16 v[208:223], v[32:35], v[64:67], 0
  ds_read_b64_tr_b16 v[48:49], v16 offset:9280
  ds_read_b64_tr_b16 v[50:51], v16 offset:11584
  s_waitcnt lgkmcnt(6)
  v_mfma_f32_32x32x16_bf16 v[224:239], v[36:39], v[64:67], 0
  ds_read_b64_tr_b16 v[52:53], v16 offset:9344
  ds_read_b64_tr_b16 v[54:55], v16 offset:11648
  buffer_load_dwordx4 v5, s[4:7], s38 offen offset:2048 lds
  s_waitcnt lgkmcnt(6)
  v_mfma_f32_32x32x16_bf16 v[240:255], v[40:43], v[64:67], 0
  ds_read_b64_tr_b16 v[32:33], v16 offset:9408
  ds_read_b64_tr_b16 v[34:35], v16 offset:11712
  s_waitcnt lgkmcnt(6)
  v_mfma_f32_32x32x16_bf16 v[112:127], v[44:47], v[68:71], v[112:127]
  ds_read_b64_tr_b16 v[36:37], v16 offset:9472
  ds_read_b64_tr_b16 v[38:39], v16 offset:11776
  s_waitcnt lgkmcnt(6)
  v_mfma_f32_32x32x16_bf16 v[128:143], v[48:51], v[68:71], v[128:143]
  ds_read_b64_tr_b16 v[40:41], v16 offset:9536
  ds_read_b64_tr_b16 v[42:43], v16 offset:11840
  buffer_load_dwordx4 v6, s[4:7], s38 offen offset:3072 lds
  s_waitcnt lgkmcnt(6)
  v_mfma_f32_32x32x16_bf16 v[144:159], v[52:55], v[68:71], v[144:159]
  ds_read_b64_tr_b16 v[44:45], v16 offset:9600
  ds_read_b64_tr_b16 v[46:47], v16 offset:11904
  s_waitcnt lgkmcnt(6)
  v_mfma_f32_32x32x16_bf16 v[160:175], v[32:35], v[68:71], v[160:175]
  ds_read_b64_tr_b16 v[48:49], v16 offset:9664
  ds_read_b64_tr_b16 v[50:51], v16 offset:11968
  s_add_u32 m0, m0, 4096
  s_mov_b32 exec_hi, 0
  buffer_load_dwordx4 v7, s[4:7], s38 offen lds
  s_mov_b32 exec_hi, -1
  s_waitcnt lgkmcnt(6)
  v_mfma_f32_32x32x16_bf16 v[176:191], v[36:39], v[68:71], v[176:191]
  ds_read_b64_tr_b16 v[52:53], v16 offset:9728
  ds_read_b64_tr_b16 v[54:55], v16 offset:12032
  s_waitcnt lgkmcnt(6)
  v_mfma_f32_32x32x16_bf16 v[192:207], v[40:43], v[68:71], v[192:207]
  s_waitcnt vmcnt(7)
  s_waitcnt lgkmcnt(0)
  s_barrier
  v_add_u32 v16, 36864, v16
  ds_read_b64_tr_b16 v[32:33], v16 offset:0
  ds_read_b64_tr_b16 v[34:35], v16 offset:2304
  v_mfma_f32_32x32x16_bf16 v[208:223], v[44:47], v[68:71], v[208:223]
  ds_read_b64_tr_b16 v[36:37], v16 offset:64
  ds_read_b64_tr_b16 v[38:39], v16 offset:2368
  s_add_u32 s40, s32, 1536
  buffer_load_dwordx4 v[88:91], v2, s[20:23], s40 offen sc1
  v_mfma_f32_32x32x16_bf16 v[224:239], v[48:51], v[68:71], v[224:239]
  ds_read_b64_tr_b16 v[40:41], v16 offset:128
  ds_read_b64_tr_b16 v[42:43], v16 offset:2432
  v_mfma_f32_32x32x16_bf16 v[240:255], v[52:55], v[68:71], v[240:255]
  ds_read_b64_tr_b16 v[44:45], v16 offset:192
  ds_read_b64_tr_b16 v[46:47], v16 offset:2496
  buffer_load_dwordx4 v[92:95], v2, s[20:23], s40 offen offset:256 sc1
  s_waitcnt lgkmcnt(6)
  v_mfma_f32_32x32x16_bf16 v[112:127], v[32:35], v[72:75], v[112:127]
  ds_read_b64_tr_b16 v[48:49], v16 offset:256
  ds_read_b64_tr_b16 v[50:51], v16 offset:2560
  s_waitcnt lgkmcnt(6)
  v_mfma_f32_32x32x16_bf16 v[128:143], v[36:39], v[72:75], v[128:143]
  ds_read_b64_tr_b16 v[52:53], v16 offset:320
  ds_read_b64_tr_b16 v[54:55], v16 offset:2624
  s_waitcnt lgkmcnt(6)
  v_mfma_f32_32x32x16_bf16 v[144:159], v[40:43], v[72:75], v[144:159]
  ds_read_b64_tr_b16 v[32:33], v16 offset:384
  ds_read_b64_tr_b16 v[34:35], v16 offset:2688
  s_add_u32 m0, s30, 0
  s_add_u32 s38, s34, 1179648
  buffer_load_dwordx4 v3, s[4:7], s38 offen lds
  s_waitcnt lgkmcnt(6)
  v_mfma_f32_32x32x16_bf16 v[160:175], v[44:47], v[72:75], v[160:175]
  ds_read_b64_tr_b16 v[36:37], v16 offset:448
  ds_read_b64_tr_b16 v[38:39], v16 offset:2752
  s_waitcnt lgkmcnt(6)
  v_mfma_f32_32x32x16_bf16 v[176:191], v[48:51], v[72:75], v[176:191]
  ds_read_b64_tr_b16 v[40:41], v16 offset:512
  ds_read_b64_tr_b16 v[42:43], v16 offset:2816
  s_waitcnt lgkmcnt(6)
  v_mfma_f32_32x32x16_bf16 v[192:207], v[52:55], v[72:75], v[192:207]
  ds_read_b64_tr_b16 v[44:45], v16 offset:9216
  ds_read_b64_tr_b16 v[46:47], v16 offset:11520
  buffer_load_dwordx4 v4, s[4:7], s38 offen offset:1024 lds
  s_waitcnt lgkmcnt(6)
  v_mfma_f32_32x32x16_bf16 v[208:223], v[32:35], v[72:75], v[208:223]
  ds_read_b64_tr_b16 v[48:49], v16 offset:9280
  ds_read_b64_tr_b16 v[50:51], v16 offset:11584
  s_waitcnt lgkmcnt(6)
  v_mfma_f32_32x32x16_bf16 v[224:239], v[36:39], v[72:75], v[224:239]
  ds_read_b64_tr_b16 v[52:53], v16 offset:9344
  ds_read_b64_tr_b16 v[54:55], v16 offset:11648
  buffer_load_dwordx4 v5, s[4:7], s38 offen offset:2048 lds
  s_waitcnt lgkmcnt(6)
  v_mfma_f32_32x32x16_bf16 v[240:255], v[40:43], v[72:75], v[240:255]
  ds_read_b64_tr_b16 v[32:33], v16 offset:9408
  ds_read_b64_tr_b16 v[34:35], v16 offset:11712
  s_waitcnt lgkmcnt(6)
  v_mfma_f32_32x32x16_bf16 v[112:127], v[44:47], v[76:79], v[112:127]
  ds_read_b64_tr_b16 v[36:37], v16 offset:9472
  ds_read_b64_tr_b16 v[38:39], v16 offset:11776
  s_waitcnt lgkmcnt(6)
  v_mfma_f32_32x32x16_bf16 v[128:143], v[48:51], v[76:79], v[128:143]
  ds_read_b64_tr_b16 v[40:41], v16 offset:9536
  ds_read_b64_tr_b16 v[42:43], v16 offset:11840
  buffer_load_dwordx4 v6, s[4:7], s38 offen offset:3072 lds
  s_waitcnt lgkmcnt(6)
  v_mfma_f32_32x32x16_bf16 v[144:159], v[52:55], v[76:79], v[144:159]
  ds_read_b64_tr_b16 v[44:45], v16 offset:9600
  ds_read_b64_tr_b16 v[46:47], v16 offset:11904
  s_waitcnt lgkmcnt(6)
  v_mfma_f32_32x32x16_bf16 v[160:175], v[32:35], v[76:79], v[160:175]
  ds_read_b64_tr_b16 v[48:49], v16 offset:9664
  ds_read_b64_tr_b16 v[50:51], v16 offset:11968
  s_add_u32 m0, m0, 4096
  s_mov_b32 exec_hi, 0
  buffer_load_dwordx4 v7, s[4:7], s38 offen lds
  s_mov_b32 exec_hi, -1
  s_waitcnt lgkmcnt(6)
  v_mfma_f32_32x32x16_bf16 v[176:191], v[36:39], v[76:79], v[176:191]
  ds_read_b64_tr_b16 v[52:53], v16 offset:9728
  ds_read_b64_tr_b16 v[54:55], v16 offset:12032
  s_waitcnt lgkmcnt(6)
  v_mfma_f32_32x32x16_bf16 v[192:207], v[40:43], v[76:79], v[192:207]
  s_waitcnt vmcnt(12)
  s_waitcnt lgkmcnt(0)
  s_barrier
  v_add_u32 v16, 36864, v16
  ds_read_b64_tr_b16 v[32:33], v16 offset:0
  ds_read_b64_tr_b16 v[34:35], v16 offset:2304
  v_mfma_f32_32x32x16_bf16 v[208:223], v[44:47], v[76:79], v[208:223]
  ds_read_b64_tr_b16 v[36:37], v16 offset:64
  ds_read_b64_tr_b16 v[38:39], v16 offset:2368
  s_add_u32 s40, s32, 2048
  buffer_load_dwordx4 v[64:67], v2, s[20:23], s40 offen sc1
  v_mfma_f32_32x32x16_bf16 v[224:239], v[48:51], v[76:79], v[224:239]
  ds_read_b64_tr_b16 v[40:41], v16 offset:128
  ds_read_b64_tr_b16 v[42:43], v16 offset:2432
  v_mfma_f32_32x32x16_bf16 v[240:255], v[52:55], v[76:79], v[240:255]
  ds_read_b64_tr_b16 v[44:45], v16 offset:192
  ds_read_b64_tr_b16 v[46:47], v16 offset:2496
  buffer_load_dwordx4 v[68:71], v2, s[20:23], s40 offen offset:256 sc1
  s_waitcnt lgkmcnt(6)
  v_mfma_f32_32x32x16_bf16 v[112:127], v[32:35], v[80:83], v[112:127]
  ds_read_b64_tr_b16 v[48:49], v16 offset:256
  ds_read_b64_tr_b16 v[50:51], v16 offset:2560
  s_waitcnt lgkmcnt(6)
  v_mfma_f32_32x32x16_bf16 v[128:143], v[36:39], v[80:83], v[128:143]
  ds_read_b64_tr_b16 v[52:53], v16 offset:320
  ds_read_b64_tr_b16 v[54:55], v16 offset:2624
  s_waitcnt lgkmcnt(6)
  v_mfma_f32_32x32x16_bf16 v[144:159], v[40:43], v[80:83], v[144:159]
  ds_read_b64_tr_b16 v[32:33], v16 offset:384
  ds_read_b64_tr_b16 v[34:35], v16 offset:2688
  s_add_u32 m0, s30, 36864
  s_add_u32 s38, s34, 1474560
  buffer_load_dwordx4 v3, s[4:7], s38 offen lds
  s_waitcnt lgkmcnt(6)
  v_mfma_f32_32x32x16_bf16 v[160:175], v[44:47], v[80:83], v[160:175]
  ds_read_b64_tr_b16 v[36:37], v16 offset:448
  ds_read_b64_tr_b16 v[38:39], v16 offset:2752
  s_waitcnt lgkmcnt(6)
  v_mfma_f32_32x32x16_bf16 v[176:191], v[48:51], v[80:83], v[176:191]
  ds_read_b64_tr_b16 v[40:41], v16 offset:512
  ds_read_b64_tr_b16 v[42:43], v16 offset:2816
  s_waitcnt lgkmcnt(6)
  v_mfma_f32_32x32x16_bf16 v[192:207], v[52:55], v[80:83], v[192:207]
  ds_read_b64_tr_b16 v[44:45], v16 offset:9216
  ds_read_b64_tr_b16 v[46:47], v16 offset:11520
  buffer_load_dwordx4 v4, s[4:7], s38 offen offset:1024 lds
  s_waitcnt lgkmcnt(6)
  v_mfma_f32_32x32x16_bf16 v[208:223], v[32:35], v[80:83], v[208:223]
  ds_read_b64_tr_b16 v[48:49], v16 offset:9280
  ds_read_b64_tr_b16 v[50:51], v16 offset:11584
  s_waitcnt lgkmcnt(6)
  v_mfma_f32_32x32x16_bf16 v[224:239], v[36:39], v[80:83], v[224:239]
  ds_read_b64_tr_b16 v[52:53], v16 offset:9344
  ds_read_b64_tr_b16 v[54:55], v16 offset:11648
  buffer_load_dwordx4 v5, s[4:7], s38 offen offset:2048 lds
  s_waitcnt lgkmcnt(6)
  v_mfma_f32_32x32x16_bf16 v[240:255], v[40:43], v[80:83], v[240:255]
  ds_read_b64_tr_b16 v[32:33], v16 offset:9408
  ds_read_b64_tr_b16 v[34:35], v16 offset:11712
  s_waitcnt lgkmcnt(6)
  v_mfma_f32_32x32x16_bf16 v[112:127], v[44:47], v[84:87], v[112:127]
  ds_read_b64_tr_b16 v[36:37], v16 offset:9472
  ds_read_b64_tr_b16 v[38:39], v16 offset:11776
  s_waitcnt lgkmcnt(6)
  v_mfma_f32_32x32x16_bf16 v[128:143], v[48:51], v[84:87], v[128:143]
  ds_read_b64_tr_b16 v[40:41], v16 offset:9536
  ds_read_b64_tr_b16 v[42:43], v16 offset:11840
  buffer_load_dwordx4 v6, s[4:7], s38 offen offset:3072 lds
  s_waitcnt lgkmcnt(6)
  v_mfma_f32_32x32x16_bf16 v[144:159], v[52:55], v[84:87], v[144:159]
  ds_read_b64_tr_b16 v[44:45], v16 offset:9600
  ds_read_b64_tr_b16 v[46:47], v16 offset:11904
  s_waitcnt lgkmcnt(6)
  v_mfma_f32_32x32x16_bf16 v[160:175], v[32:35], v[84:87], v[160:175]
  ds_read_b64_tr_b16 v[48:49], v16 offset:9664
  ds_read_b64_tr_b16 v[50:51], v16 offset:11968
  s_add_u32 m0, m0, 4096
  s_mov_b32 exec_hi, 0
  buffer_load_dwordx4 v7, s[4:7], s38 offen lds
  s_mov_b32 exec_hi, -1
  s_waitcnt lgkmcnt(6)
  v_mfma_f32_32x32x16_bf16 v[176:191], v[36:39], v[84:87], v[176:191]
  ds_read_b64_tr_b16 v[52:53], v16 offset:9728
  ds_read_b64_tr_b16 v[54:55], v16 offset:12032
  s_waitcnt lgkmcnt(6)
  v_mfma_f32_32x32x16_bf16 v[192:207], v[40:43], v[84:87], v[192:207]
  s_waitcnt vmcnt(12)
  s_waitcnt lgkmcnt(0)
  s_barrier
  v_add_u32 v16, 36864, v16
  ds_read_b64_tr_b16 v[32:33], v16 offset:0
  ds_read_b64_tr_b16 v[34:35], v16 offset:2304
  v_mfma_f32_32x32x16_bf16 v[208:223], v[44:47], v[84:87], v[208:223]
  ds_read_b64_tr_b16 v[36:37], v16 offset:64
  ds_read_b64_tr_b16 v[38:39], v16 offset:2368
  s_add_u32 s40, s32, 2560
  buffer_load_dwordx4 v[72:75], v2, s[20:23], s40 offen sc1
  v_mfma_f32_32x32x16_bf16 v[224:239], v[48:51], v[84:87], v[224:239]
  ds_read_b64_tr_b16 v[40:41], v16 offset:128
  ds_read_b64_tr_b16 v[42:43], v16 offset:2432
  v_mfma_f32_32x32x16_bf16 v[240:255], v[52:55], v[84:87], v[240:255]
  ds_read_b64_tr_b16 v[44:45], v16 offset:192
  ds_read_b64_tr_b16 v[46:47], v16 offset:2496
  buffer_load_dwordx4 v[76:79], v2, s[20:23], s40 offen offset:256 sc1
  s_waitcnt lgkmcnt(6)
  v_mfma_f32_32x32x16_bf16 v[112:127], v[32:35], v[88:91], v[112:127]
  ds_read_b64_tr_b16 v[48:49], v16 offset:256
  ds_read_b64_tr_b16 v[50:51], v16 offset:2560
  s_waitcnt lgkmcnt(6)
  v_mfma_f32_32x32x16_bf16 v[128:143], v[36:39], v[88:91], v[128:143]
  ds_read_b64_tr_b16 v[52:53], v16 offset:320
  ds_read_b64_tr_b16 v[54:55], v16 offset:2624
  s_waitcnt lgkmcnt(6)
  v_mfma_f32_32x32x16_bf16 v[144:159], v[40:43], v[88:91], v[144:159]
  ds_read_b64_tr_b16 v[32:33], v16 offset:384
  ds_read_b64_tr_b16 v[34:35], v16 offset:2688
  s_add_u32 m0, s30, 73728
  s_add_u32 s38, s34, 1769472
  buffer_load_dwordx4 v3, s[4:7], s38 offen lds
  s_waitcnt lgkmcnt(6)
  v_mfma_f32_32x32x16_bf16 v[160:175], v[44:47], v[88:91], v[160:175]
  ds_read_b64_tr_b16 v[36:37], v16 offset:448
  ds_read_b64_tr_b16 v[38:39], v16 offset:2752
  s_waitcnt lgkmcnt(6)
  v_mfma_f32_32x32x16_bf16 v[176:191], v[48:51], v[88:91], v[176:191]
  ds_read_b64_tr_b16 v[40:41], v16 offset:512
  ds_read_b64_tr_b16 v[42:43], v16 offset:2816
  s_waitcnt lgkmcnt(6)
  v_mfma_f32_32x32x16_bf16 v[192:207], v[52:55], v[88:91], v[192:207]
  ds_read_b64_tr_b16 v[44:45], v16 offset:9216
  ds_read_b64_tr_b16 v[46:47], v16 offset:11520
  buffer_load_dwordx4 v4, s[4:7], s38 offen offset:1024 lds
  s_waitcnt lgkmcnt(6)
  v_mfma_f32_32x32x16_bf16 v[208:223], v[32:35], v[88:91], v[208:223]
  ds_read_b64_tr_b16 v[48:49], v16 offset:9280
  ds_read_b64_tr_b16 v[50:51], v16 offset:11584
  s_waitcnt lgkmcnt(6)
  v_mfma_f32_32x32x16_bf16 v[224:239], v[36:39], v[88:91], v[224:239]
  ds_read_b64_tr_b16 v[52:53], v16 offset:9344
  ds_read_b64_tr_b16 v[54:55], v16 offset:11648
  buffer_load_dwordx4 v5, s[4:7], s38 offen offset:2048 lds
  s_waitcnt lgkmcnt(6)
  v_mfma_f32_32x32x16_bf16 v[240:255], v[40:43], v[88:91], v[240:255]
  ds_read_b64_tr_b16 v[32:33], v16 offset:9408
  ds_read_b64_tr_b16 v[34:35], v16 offset:11712
  s_waitcnt lgkmcnt(6)
  v_mfma_f32_32x32x16_bf16 v[112:127], v[44:47], v[92:95], v[112:127]
  ds_read_b64_tr_b16 v[36:37], v16 offset:9472
  ds_read_b64_tr_b16 v[38:39], v16 offset:11776
  s_waitcnt lgkmcnt(6)
  v_mfma_f32_32x32x16_bf16 v[128:143], v[48:51], v[92:95], v[128:143]
  ds_read_b64_tr_b16 v[40:41], v16 offset:9536
  ds_read_b64_tr_b16 v[42:43], v16 offset:11840
  buffer_load_dwordx4 v6, s[4:7], s38 offen offset:3072 lds
  s_waitcnt lgkmcnt(6)
  v_mfma_f32_32x32x16_bf16 v[144:159], v[52:55], v[92:95], v[144:159]
  ds_read_b64_tr_b16 v[44:45], v16 offset:9600
  ds_read_b64_tr_b16 v[46:47], v16 offset:11904
  s_waitcnt lgkmcnt(6)
  v_mfma_f32_32x32x16_bf16 v[160:175], v[32:35], v[92:95], v[160:175]
  ds_read_b64_tr_b16 v[48:49], v16 offset:9664
  ds_read_b64_tr_b16 v[50:51], v16 offset:11968
  s_add_u32 m0, m0, 4096
  s_mov_b32 exec_hi, 0
  buffer_load_dwordx4 v7, s[4:7], s38 offen lds
  s_mov_b32 exec_hi, -1
  s_waitcnt lgkmcnt(6)
  v_mfma_f32_32x32x16_bf16 v[176:191], v[36:39], v[92:95], v[176:191]
  ds_read_b64_tr_b16 v[52:53], v16 offset:9728
  ds_read_b64_tr_b16 v[54:55], v16 offset:12032
  s_waitcnt lgkmcnt(6)
  v_mfma_f32_32x32x16_bf16 v[192:207], v[40:43], v[92:95], v[192:207]
  s_waitcnt vmcnt(12)
  s_waitcnt lgkmcnt(0)
  s_barrier
  v_add_u32 v16, 4294856704, v16
  ds_read_b64_tr_b16 v[32:33], v16 offset:0
  ds_read_b64_tr_b16 v[34:35], v16 offset:2304
  v_mfma_f32_32x32x16_bf16 v[208:223], v[44:47], v[92:95], v[208:223]
  ds_read_b64_tr_b16 v[36:37], v16 offset:64
  ds_read_b64_tr_b16 v[38:39], v16 offset:2368
  s_add_u32 s40, s32, 3072
  buffer_load_dwordx4 v[80:83], v2, s[20:23], s40 offen sc1
  v_mfma_f32_32x32x16_bf16 v[224:239], v[48:51], v[92:95], v[224:239]
  ds_read_b64_tr_b16 v[40:41], v16 offset:128
  ds_read_b64_tr_b16 v[42:43], v16 offset:2432
  v_mfma_f32_32x32x16_bf16 v[240:255], v[52:55], v[92:95], v[240:255]
  ds_read_b64_tr_b16 v[44:45], v16 offset:192
  ds_read_b64_tr_b16 v[46:47], v16 offset:2496
  buffer_load_dwordx4 v[84:87], v2, s[20:23], s40 offen offset:256 sc1
  s_waitcnt lgkmcnt(6)
  v_mfma_f32_32x32x16_bf16 v[112:127], v[32:35], v[64:67], v[112:127]
  ds_read_b64_tr_b16 v[48:49], v16 offset:256
  ds_read_b64_tr_b16 v[50:51], v16 offset:2560
  s_waitcnt lgkmcnt(6)
  v_mfma_f32_32x32x16_bf16 v[128:143], v[36:39], v[64:67], v[128:143]
  ds_read_b64_tr_b16 v[52:53], v16 offset:320
  ds_read_b64_tr_b16 v[54:55], v16 offset:2624
  s_waitcnt lgkmcnt(6)
  v_mfma_f32_32x32x16_bf16 v[144:159], v[40:43], v[64:67], v[144:159]
  ds_read_b64_tr_b16 v[32:33], v16 offset:384
  ds_read_b64_tr_b16 v[34:35], v16 offset:2688
  s_add_u32 m0, s30, 110592
  s_add_u32 s38, s34, 2064384
  buffer_load_dwordx4 v3, s[4:7], s38 offen lds
  s_waitcnt lgkmcnt(6)
  v_mfma_f32_32x32x16_bf16 v[160:175], v[44:47], v[64:67], v[160:175]
  ds_read_b64_tr_b16 v[36:37], v16 offset:448
  ds_read_b64_tr_b16 v[38:39], v16 offset:2752
  s_waitcnt lgkmcnt(6)
  v_mfma_f32_32x32x16_bf16 v[176:191], v[48:51], v[64:67], v[176:191]
  ds_read_b64_tr_b16 v[40:41], v16 offset:512
  ds_read_b64_tr_b16 v[42:43], v16 offset:2816
  s_waitcnt lgkmcnt(6)
  v_mfma_f32_32x32x16_bf16 v[192:207], v[52:55], v[64:67], v[192:207]
  ds_read_b64_tr_b16 v[44:45], v16 offset:9216
  ds_read_b64_tr_b16 v[46:47], v16 offset:11520
  buffer_load_dwordx4 v4, s[4:7], s38 offen offset:1024 lds
  s_waitcnt lgkmcnt(6)
  v_mfma_f32_32x32x16_bf16 v[208:223], v[32:35], v[64:67], v[208:223]
  ds_read_b64_tr_b16 v[48:49], v16 offset:9280
  ds_read_b64_tr_b16 v[50:51], v16 offset:11584
  s_waitcnt lgkmcnt(6)
  v_mfma_f32_32x32x16_bf16 v[224:239], v[36:39], v[64:67], v[224:239]
  ds_read_b64_tr_b16 v[52:53], v16 offset:9344
  ds_read_b64_tr_b16 v[54:55], v16 offset:11648
  buffer_load_dwordx4 v5, s[4:7], s38 offen offset:2048 lds
  s_waitcnt lgkmcnt(6)
  v_mfma_f32_32x32x16_bf16 v[240:255], v[40:43], v[64:67], v[240:255]
  ds_read_b64_tr_b16 v[32:33], v16 offset:9408
  ds_read_b64_tr_b16 v[34:35], v16 offset:11712
  s_waitcnt lgkmcnt(6)
  v_mfma_f32_32x32x16_bf16 v[112:127], v[44:47], v[68:71], v[112:127]
  ds_read_b64_tr_b16 v[36:37], v16 offset:9472
  ds_read_b64_tr_b16 v[38:39], v16 offset:11776
  s_waitcnt lgkmcnt(6)
  v_mfma_f32_32x32x16_bf16 v[128:143], v[48:51], v[68:71], v[128:143]
  ds_read_b64_tr_b16 v[40:41], v16 offset:9536
  ds_read_b64_tr_b16 v[42:43], v16 offset:11840
  buffer_load_dwordx4 v6, s[4:7], s38 offen offset:3072 lds
  s_waitcnt lgkmcnt(6)
  v_mfma_f32_32x32x16_bf16 v[144:159], v[52:55], v[68:71], v[144:159]
  ds_read_b64_tr_b16 v[44:45], v16 offset:9600
  ds_read_b64_tr_b16 v[46:47], v16 offset:11904
  s_waitcnt lgkmcnt(6)
  v_mfma_f32_32x32x16_bf16 v[160:175], v[32:35], v[68:71], v[160:175]
  ds_read_b64_tr_b16 v[48:49], v16 offset:9664
  ds_read_b64_tr_b16 v[50:51], v16 offset:11968
  s_add_u32 m0, m0, 4096
  s_mov_b32 exec_hi, 0
  buffer_load_dwordx4 v7, s[4:7], s38 offen lds
  s_mov_b32 exec_hi, -1
  s_waitcnt lgkmcnt(6)
  v_mfma_f32_32x32x16_bf16 v[176:191], v[36:39], v[68:71], v[176:191]
  ds_read_b64_tr_b16 v[52:53], v16 offset:9728
  ds_read_b64_tr_b16 v[54:55], v16 offset:12032
  s_waitcnt lgkmcnt(6)
  v_mfma_f32_32x32x16_bf16 v[192:207], v[40:43], v[68:71], v[192:207]
  s_waitcnt vmcnt(12)
  s_waitcnt lgkmcnt(0)
  s_barrier
  v_add_u32 v16, 36864, v16
  ds_read_b64_tr_b16 v[32:33], v16 offset:0
  ds_read_b64_tr_b16 v[34:35], v16 offset:2304
  v_mfma_f32_32x32x16_bf16 v[208:223], v[44:47], v[68:71], v[208:223]
  ds_read_b64_tr_b16 v[36:37], v16 offset:64
  ds_read_b64_tr_b16 v[38:39], v16 offset:2368
  s_add_u32 s40, s32, 3584
  buffer_load_dwordx4 v[88:91], v2, s[20:23], s40 offen sc1
  v_mfma_f32_32x32x16_bf16 v[224:239], v[48:51], v[68:71], v[224:239]
  ds_read_b64_tr_b16 v[40:41], v16 offset:128
  ds_read_b64_tr_b16 v[42:43], v16 offset:2432
  v_mfma_f32_32x32x16_bf16 v[240:255], v[52:55], v[68:71], v[240:255]
  ds_read_b64_tr_b16 v[44:45], v16 offset:192
  ds_read_b64_tr_b16 v[46:47], v16 offset:2496
  buffer_load_dwordx4 v[92:95], v2, s[20:23], s40 offen offset:256 sc1
  s_waitcnt lgkmcnt(6)
  v_mfma_f32_32x32x16_bf16 v[112:127], v[32:35], v[72:75], v[112:127]
  ds_read_b64_tr_b16 v[48:49], v16 offset:256
  ds_read_b64_tr_b16 v[50:51], v16 offset:2560
  s_waitcnt lgkmcnt(6)
  v_mfma_f32_32x32x16_bf16 v[128:143], v[36:39], v[72:75], v[128:143]
  ds_read_b64_tr_b16 v[52:53], v16 offset:320
  ds_read_b64_tr_b16 v[54:55], v16 offset:2624
  s_waitcnt lgkmcnt(6)
  v_mfma_f32_32x32x16_bf16 v[144:159], v[40:43], v[72:75], v[144:159]
  ds_read_b64_tr_b16 v[32:33], v16 offset:384
  ds_read_b64_tr_b16 v[34:35], v16 offset:2688
  s_add_u32 m0, s30, 0
  s_add_u32 s38, s34, 2359296
  buffer_load_dwordx4 v3, s[4:7], s38 offen lds
  s_waitcnt lgkmcnt(6)
  v_mfma_f32_32x32x16_bf16 v[160:175], v[44:47], v[72:75], v[160:175]
  ds_read_b64_tr_b16 v[36:37], v16 offset:448
  ds_read_b64_tr_b16 v[38:39], v16 offset:2752
  s_waitcnt lgkmcnt(6)
  v_mfma_f32_32x32x16_bf16 v[176:191], v[48:51], v[72:75], v[176:191]
  ds_read_b64_tr_b16 v[40:41], v16 offset:512
  ds_read_b64_tr_b16 v[42:43], v16 offset:2816
  s_waitcnt lgkmcnt(6)
  v_mfma_f32_32x32x16_bf16 v[192:207], v[52:55], v[72:75], v[192:207]
  ds_read_b64_tr_b16 v[44:45], v16 offset:9216
  ds_read_b64_tr_b16 v[46:47], v16 offset:11520
  buffer_load_dwordx4 v4, s[4:7], s38 offen offset:1024 lds
  s_waitcnt lgkmcnt(6)
  v_mfma_f32_32x32x16_bf16 v[208:223], v[32:35], v[72:75], v[208:223]
  ds_read_b64_tr_b16 v[48:49], v16 offset:9280
  ds_read_b64_tr_b16 v[50:51], v16 offset:11584
  s_waitcnt lgkmcnt(6)
  v_mfma_f32_32x32x16_bf16 v[224:239], v[36:39], v[72:75], v[224:239]
  ds_read_b64_tr_b16 v[52:53], v16 offset:9344
  ds_read_b64_tr_b16 v[54:55], v16 offset:11648
  buffer_load_dwordx4 v5, s[4:7], s38 offen offset:2048 lds
  s_waitcnt lgkmcnt(6)
  v_mfma_f32_32x32x16_bf16 v[240:255], v[40:43], v[72:75], v[240:255]
  ds_read_b64_tr_b16 v[32:33], v16 offset:9408
  ds_read_b64_tr_b16 v[34:35], v16 offset:11712
  s_waitcnt lgkmcnt(6)
  v_mfma_f32_32x32x16_bf16 v[112:127], v[44:47], v[76:79], v[112:127]
  ds_read_b64_tr_b16 v[36:37], v16 offset:9472
  ds_read_b64_tr_b16 v[38:39], v16 offset:11776
  s_waitcnt lgkmcnt(6)
  v_mfma_f32_32x32x16_bf16 v[128:143], v[48:51], v[76:79], v[128:143]
  ds_read_b64_tr_b16 v[40:41], v16 offset:9536
  ds_read_b64_tr_b16 v[42:43], v16 offset:11840
  buffer_load_dwordx4 v6, s[4:7], s38 offen offset:3072 lds
  s_waitcnt lgkmcnt(6)
  v_mfma_f32_32x32x16_bf16 v[144:159], v[52:55], v[76:79], v[144:159]
  ds_read_b64_tr_b16 v[44:45], v16 offset:9600
  ds_read_b64_tr_b16 v[46:47], v16 offset:11904
  s_waitcnt lgkmcnt(6)
  v_mfma_f32_32x32x16_bf16 v[160:175], v[32:35], v[76:79], v[160:175]
  ds_read_b64_tr_b16 v[48:49], v16 offset:9664
  ds_read_b64_tr_b16 v[50:51], v16 offset:11968
  s_add_u32 m0, m0, 4096
  s_mov_b32 exec_hi, 0
  buffer_load_dwordx4 v7, s[4:7], s38 offen lds
  s_mov_b32 exec_hi, -1
  s_waitcnt lgkmcnt(6)
  v_mfma_f32_32x32x16_bf16 v[176:191], v[36:39], v[76:79], v[176:191]
  ds_read_b64_tr_b16 v[52:53], v16 offset:9728
  ds_read_b64_tr_b16 v[54:55], v16 offset:12032
  s_waitcnt lgkmcnt(6)
  v_mfma_f32_32x32x16_bf16 v[192:207], v[40:43], v[76:79], v[192:207]
  s_waitcnt vmcnt(12)
  s_waitcnt lgkmcnt(0)
  s_barrier
  v_add_u32 v16, 36864, v16
  ds_read_b64_tr_b16 v[32:33], v16 offset:0
  ds_read_b64_tr_b16 v[34:35], v16 offset:2304
  v_mfma_f32_32x32x16_bf16 v[208:223], v[44:47], v[76:79], v[208:223]
  ds_read_b64_tr_b16 v[36:37], v16 offset:64
  ds_read_b64_tr_b16 v[38:39], v16 offset:2368
  s_add_u32 s40, s32, 4096
  buffer_load_dwordx4 v[64:67], v2, s[20:23], s40 offen sc1
  v_mfma_f32_32x32x16_bf16 v[224:239], v[48:51], v[76:79], v[224:239]
  ds_read_b64_tr_b16 v[40:41], v16 offset:128
  ds_read_b64_tr_b16 v[42:43], v16 offset:2432
  v_mfma_f32_32x32x16_bf16 v[240:255], v[52:55], v[76:79], v[240:255]
  ds_read_b64_tr_b16 v[44:45], v16 offset:192
  ds_read_b64_tr_b16 v[46:47], v16 offset:2496
  buffer_load_dwordx4 v[68:71], v2, s[20:23], s40 offen offset:256 sc1
  s_waitcnt lgkmcnt(6)
  v_mfma_f32_32x32x16_bf16 v[112:127], v[32:35], v[80:83], v[112:127]
  ds_read_b64_tr_b16 v[48:49], v16 offset:256
  ds_read_b64_tr_b16 v[50:51], v16 offset:2560
  s_waitcnt lgkmcnt(6)
  v_mfma_f32_32x32x16_bf16 v[128:143], v[36:39], v[80:83], v[128:143]
  ds_read_b64_tr_b16 v[52:53], v16 offset:320
  ds_read_b64_tr_b16 v[54:55], v16 offset:2624
  s_waitcnt lgkmcnt(6)
  v_mfma_f32_32x32x16_bf16 v[144:159], v[40:43], v[80:83], v[144:159]
  ds_read_b64_tr_b16 v[32:33], v16 offset:384
  ds_read_b64_tr_b16 v[34:35], v16 offset:2688
  s_add_u32 m0, s30, 36864
  s_add_u32 s38, s34, 2654208
  buffer_load_dwordx4 v3, s[4:7], s38 offen lds
  s_waitcnt lgkmcnt(6)
  v_mfma_f32_32x32x16_bf16 v[160:175], v[44:47], v[80:83], v[160:175]
  ds_read_b64_tr_b16 v[36:37], v16 offset:448
  ds_read_b64_tr_b16 v[38:39], v16 offset:2752
  s_waitcnt lgkmcnt(6)
  v_mfma_f32_32x32x16_bf16 v[176:191], v[48:51], v[80:83], v[176:191]
  ds_read_b64_tr_b16 v[40:41], v16 offset:512
  ds_read_b64_tr_b16 v[42:43], v16 offset:2816
  s_waitcnt lgkmcnt(6)
  v_mfma_f32_32x32x16_bf16 v[192:207], v[52:55], v[80:83], v[192:207]
  ds_read_b64_tr_b16 v[44:45], v16 offset:9216
  ds_read_b64_tr_b16 v[46:47], v16 offset:11520
  buffer_load_dwordx4 v4, s[4:7], s38 offen offset:1024 lds
  s_waitcnt lgkmcnt(6)
  v_mfma_f32_32x32x16_bf16 v[208:223], v[32:35], v[80:83], v[208:223]
  ds_read_b64_tr_b16 v[48:49], v16 offset:9280
  ds_read_b64_tr_b16 v[50:51], v16 offset:11584
  s_waitcnt lgkmcnt(6)
  v_mfma_f32_32x32x16_bf16 v[224:239], v[36:39], v[80:83], v[224:239]
  ds_read_b64_tr_b16 v[52:53], v16 offset:9344
  ds_read_b64_tr_b16 v[54:55], v16 offset:11648
  buffer_load_dwordx4 v5, s[4:7], s38 offen offset:2048 lds
  s_waitcnt lgkmcnt(6)
  v_mfma_f32_32x32x16_bf16 v[240:255], v[40:43], v[80:83], v[240:255]
  ds_read_b64_tr_b16 v[32:33], v16 offset:9408
  ds_read_b64_tr_b16 v[34:35], v16 offset:11712
  s_waitcnt lgkmcnt(6)
  v_mfma_f32_32x32x16_bf16 v[112:127], v[44:47], v[84:87], v[112:127]
  ds_read_b64_tr_b16 v[36:37], v16 offset:9472
  ds_read_b64_tr_b16 v[38:39], v16 offset:11776
  s_waitcnt lgkmcnt(6)
  v_mfma_f32_32x32x16_bf16 v[128:143], v[48:51], v[84:87], v[128:143]
  ds_read_b64_tr_b16 v[40:41], v16 offset:9536
  ds_read_b64_tr_b16 v[42:43], v16 offset:11840
  buffer_load_dwordx4 v6, s[4:7], s38 offen offset:3072 lds
  s_waitcnt lgkmcnt(6)
  v_mfma_f32_32x32x16_bf16 v[144:159], v[52:55], v[84:87], v[144:159]
  ds_read_b64_tr_b16 v[44:45], v16 offset:9600
  ds_read_b64_tr_b16 v[46:47], v16 offset:11904
  s_waitcnt lgkmcnt(6)
  v_mfma_f32_32x32x16_bf16 v[160:175], v[32:35], v[84:87], v[160:175]
  ds_read_b64_tr_b16 v[48:49], v16 offset:9664
  ds_read_b64_tr_b16 v[50:51], v16 offset:11968
  s_add_u32 m0, m0, 4096
  s_mov_b32 exec_hi, 0
  buffer_load_dwordx4 v7, s[4:7], s38 offen lds
  s_mov_b32 exec_hi, -1
  s_waitcnt lgkmcnt(6)
  v_mfma_f32_32x32x16_bf16 v[176:191], v[36:39], v[84:87], v[176:191]
  ds_read_b64_tr_b16 v[52:53], v16 offset:9728
  ds_read_b64_tr_b16 v[54:55], v16 offset:12032
  s_waitcnt lgkmcnt(6)
  v_mfma_f32_32x32x16_bf16 v[192:207], v[40:43], v[84:87], v[192:207]
  s_waitcnt vmcnt(12)
  s_waitcnt lgkmcnt(0)
  s_barrier
  v_add_u32 v16, 36864, v16
  ds_read_b64_tr_b16 v[32:33], v16 offset:0
  ds_read_b64_tr_b16 v[34:35], v16 offset:2304
  v_mfma_f32_32x32x16_bf16 v[208:223], v[44:47], v[84:87], v[208:223]
  ds_read_b64_tr_b16 v[36:37], v16 offset:64
  ds_read_b64_tr_b16 v[38:39], v16 offset:2368
  s_add_u32 s40, s32, 4608
  buffer_load_dwordx4 v[72:75], v2, s[20:23], s40 offen sc1
  v_mfma_f32_32x32x16_bf16 v[224:239], v[48:51], v[84:87], v[224:239]
  ds_read_b64_tr_b16 v[40:41], v16 offset:128
  ds_read_b64_tr_b16 v[42:43], v16 offset:2432
  v_mfma_f32_32x32x16_bf16 v[240:255], v[52:55], v[84:87], v[240:255]
  ds_read_b64_tr_b16 v[44:45], v16 offset:192
  ds_read_b64_tr_b16 v[46:47], v16 offset:2496
  buffer_load_dwordx4 v[76:79], v2, s[20:23], s40 offen offset:256 sc1
  s_waitcnt lgkmcnt(6)
  v_mfma_f32_32x32x16_bf16 v[112:127], v[32:35], v[88:91], v[112:127]
  ds_read_b64_tr_b16 v[48:49], v16 offset:256
  ds_read_b64_tr_b16 v[50:51], v16 offset:2560
  s_waitcnt lgkmcnt(6)
  v_mfma_f32_32x32x16_bf16 v[128:143], v[36:39], v[88:91], v[128:143]
  ds_read_b64_tr_b16 v[52:53], v16 offset:320
  ds_read_b64_tr_b16 v[54:55], v16 offset:2624
  s_waitcnt lgkmcnt(6)
  v_mfma_f32_32x32x16_bf16 v[144:159], v[40:43], v[88:91], v[144:159]
  ds_read_b64_tr_b16 v[32:33], v16 offset:384
  ds_read_b64_tr_b16 v[34:35], v16 offset:2688
  s_add_u32 m0, s30, 73728
  s_add_u32 s38, s34, 2949120
  buffer_load_dwordx4 v3, s[4:7], s38 offen lds
  s_waitcnt lgkmcnt(6)
  v_mfma_f32_32x32x16_bf16 v[160:175], v[44:47], v[88:91], v[160:175]
  ds_read_b64_tr_b16 v[36:37], v16 offset:448
  ds_read_b64_tr_b16 v[38:39], v16 offset:2752
  s_waitcnt lgkmcnt(6)
  v_mfma_f32_32x32x16_bf16 v[176:191], v[48:51], v[88:91], v[176:191]
  ds_read_b64_tr_b16 v[40:41], v16 offset:512
  ds_read_b64_tr_b16 v[42:43], v16 offset:2816
  s_waitcnt lgkmcnt(6)
  v_mfma_f32_32x32x16_bf16 v[192:207], v[52:55], v[88:91], v[192:207]
  ds_read_b64_tr_b16 v[44:45], v16 offset:9216
  ds_read_b64_tr_b16 v[46:47], v16 offset:11520
  buffer_load_dwordx4 v4, s[4:7], s38 offen offset:1024 lds
  s_waitcnt lgkmcnt(6)
  v_mfma_f32_32x32x16_bf16 v[208:223], v[32:35], v[88:91], v[208:223]
  ds_read_b64_tr_b16 v[48:49], v16 offset:9280
  ds_read_b64_tr_b16 v[50:51], v16 offset:11584
  s_waitcnt lgkmcnt(6)
  v_mfma_f32_32x32x16_bf16 v[224:239], v[36:39], v[88:91], v[224:239]
  ds_read_b64_tr_b16 v[52:53], v16 offset:9344
  ds_read_b64_tr_b16 v[54:55], v16 offset:11648
  buffer_load_dwordx4 v5, s[4:7], s38 offen offset:2048 lds
  s_waitcnt lgkmcnt(6)
  v_mfma_f32_32x32x16_bf16 v[240:255], v[40:43], v[88:91], v[240:255]
  ds_read_b64_tr_b16 v[32:33], v16 offset:9408
  ds_read_b64_tr_b16 v[34:35], v16 offset:11712
  s_waitcnt lgkmcnt(6)
  v_mfma_f32_32x32x16_bf16 v[112:127], v[44:47], v[92:95], v[112:127]
  ds_read_b64_tr_b16 v[36:37], v16 offset:9472
  ds_read_b64_tr_b16 v[38:39], v16 offset:11776
  s_waitcnt lgkmcnt(6)
  v_mfma_f32_32x32x16_bf16 v[128:143], v[48:51], v[92:95], v[128:143]
  ds_read_b64_tr_b16 v[40:41], v16 offset:9536
  ds_read_b64_tr_b16 v[42:43], v16 offset:11840
  buffer_load_dwordx4 v6, s[4:7], s38 offen offset:3072 lds
  s_waitcnt lgkmcnt(6)
  v_mfma_f32_32x32x16_bf16 v[144:159], v[52:55], v[92:95], v[144:159]
  ds_read_b64_tr_b16 v[44:45], v16 offset:9600
  ds_read_b64_tr_b16 v[46:47], v16 offset:11904
  s_waitcnt lgkmcnt(6)
  v_mfma_f32_32x32x16_bf16 v[160:175], v[32:35], v[92:95], v[160:175]
  ds_read_b64_tr_b16 v[48:49], v16 offset:9664
  ds_read_b64_tr_b16 v[50:51], v16 offset:11968
  s_add_u32 m0, m0, 4096
  s_mov_b32 exec_hi, 0
  buffer_load_dwordx4 v7, s[4:7], s38 offen lds
  s_mov_b32 exec_hi, -1
  s_waitcnt lgkmcnt(6)
  v_mfma_f32_32x32x16_bf16 v[176:191], v[36:39], v[92:95], v[176:191]
  ds_read_b64_tr_b16 v[52:53], v16 offset:9728
  ds_read_b64_tr_b16 v[54:55], v16 offset:12032
  s_waitcnt lgkmcnt(6)
  v_mfma_f32_32x32x16_bf16 v[192:207], v[40:43], v[92:95], v[192:207]
  s_waitcnt vmcnt(12)
  s_waitcnt lgkmcnt(0)
  s_barrier
  v_add_u32 v16, 4294856704, v16
  ds_read_b64_tr_b16 v[32:33], v16 offset:0
  ds_read_b64_tr_b16 v[34:35], v16 offset:2304
  v_mfma_f32_32x32x16_bf16 v[208:223], v[44:47], v[92:95], v[208:223]
  ds_read_b64_tr_b16 v[36:37], v16 offset:64
  ds_read_b64_tr_b16 v[38:39], v16 offset:2368
  s_add_u32 s40, s32, 5120
  buffer_load_dwordx4 v[80:83], v2, s[20:23], s40 offen sc1
  v_mfma_f32_32x32x16_bf16 v[224:239], v[48:51], v[92:95], v[224:239]
  ds_read_b64_tr_b16 v[40:41], v16 offset:128
  ds_read_b64_tr_b16 v[42:43], v16 offset:2432
  v_mfma_f32_32x32x16_bf16 v[240:255], v[52:55], v[92:95], v[240:255]
  ds_read_b64_tr_b16 v[44:45], v16 offset:192
  ds_read_b64_tr_b16 v[46:47], v16 offset:2496
  buffer_load_dwordx4 v[84:87], v2, s[20:23], s40 offen offset:256 sc1
  s_waitcnt lgkmcnt(6)
  v_mfma_f32_32x32x16_bf16 v[112:127], v[32:35], v[64:67], v[112:127]
  ds_read_b64_tr_b16 v[48:49], v16 offset:256
  ds_read_b64_tr_b16 v[50:51], v16 offset:2560
  s_waitcnt lgkmcnt(6)
  v_mfma_f32_32x32x16_bf16 v[128:143], v[36:39], v[64:67], v[128:143]
  ds_read_b64_tr_b16 v[52:53], v16 offset:320
  ds_read_b64_tr_b16 v[54:55], v16 offset:2624
  s_waitcnt lgkmcnt(6)
  v_mfma_f32_32x32x16_bf16 v[144:159], v[40:43], v[64:67], v[144:159]
  ds_read_b64_tr_b16 v[32:33], v16 offset:384
  ds_read_b64_tr_b16 v[34:35], v16 offset:2688
  s_add_u32 m0, s30, 110592
  s_add_u32 s38, s34, 3244032
  buffer_load_dwordx4 v3, s[4:7], s38 offen lds
  s_waitcnt lgkmcnt(6)
  v_mfma_f32_32x32x16_bf16 v[160:175], v[44:47], v[64:67], v[160:175]
  ds_read_b64_tr_b16 v[36:37], v16 offset:448
  ds_read_b64_tr_b16 v[38:39], v16 offset:2752
  s_waitcnt lgkmcnt(6)
  v_mfma_f32_32x32x16_bf16 v[176:191], v[48:51], v[64:67], v[176:191]
  ds_read_b64_tr_b16 v[40:41], v16 offset:512
  ds_read_b64_tr_b16 v[42:43], v16 offset:2816
  s_waitcnt lgkmcnt(6)
  v_mfma_f32_32x32x16_bf16 v[192:207], v[52:55], v[64:67], v[192:207]
  ds_read_b64_tr_b16 v[44:45], v16 offset:9216
  ds_read_b64_tr_b16 v[46:47], v16 offset:11520
  buffer_load_dwordx4 v4, s[4:7], s38 offen offset:1024 lds
  s_waitcnt lgkmcnt(6)
  v_mfma_f32_32x32x16_bf16 v[208:223], v[32:35], v[64:67], v[208:223]
  ds_read_b64_tr_b16 v[48:49], v16 offset:9280
  ds_read_b64_tr_b16 v[50:51], v16 offset:11584
  s_waitcnt lgkmcnt(6)
  v_mfma_f32_32x32x16_bf16 v[224:239], v[36:39], v[64:67], v[224:239]
  ds_read_b64_tr_b16 v[52:53], v16 offset:9344
  ds_read_b64_tr_b16 v[54:55], v16 offset:11648
  buffer_load_dwordx4 v5, s[4:7], s38 offen offset:2048 lds
  s_waitcnt lgkmcnt(6)
  v_mfma_f32_32x32x16_bf16 v[240:255], v[40:43], v[64:67], v[240:255]
  ds_read_b64_tr_b16 v[32:33], v16 offset:9408
  ds_read_b64_tr_b16 v[34:35], v16 offset:11712
  s_waitcnt lgkmcnt(6)
  v_mfma_f32_32x32x16_bf16 v[112:127], v[44:47], v[68:71], v[112:127]
  ds_read_b64_tr_b16 v[36:37], v16 offset:9472
  ds_read_b64_tr_b16 v[38:39], v16 offset:11776
  s_waitcnt lgkmcnt(6)
  v_mfma_f32_32x32x16_bf16 v[128:143], v[48:51], v[68:71], v[128:143]
  ds_read_b64_tr_b16 v[40:41], v16 offset:9536
  ds_read_b64_tr_b16 v[42:43], v16 offset:11840
  buffer_load_dwordx4 v6, s[4:7], s38 offen offset:3072 lds
  s_waitcnt lgkmcnt(6)
  v_mfma_f32_32x32x16_bf16 v[144:159], v[52:55], v[68:71], v[144:159]
  ds_read_b64_tr_b16 v[44:45], v16 offset:9600
  ds_read_b64_tr_b16 v[46:47], v16 offset:11904
  s_waitcnt lgkmcnt(6)
  v_mfma_f32_32x32x16_bf16 v[160:175], v[32:35], v[68:71], v[160:175]
  ds_read_b64_tr_b16 v[48:49], v16 offset:9664
  ds_read_b64_tr_b16 v[50:51], v16 offset:11968
  s_add_u32 m0, m0, 4096
  s_mov_b32 exec_hi, 0
  buffer_load_dwordx4 v7, s[4:7], s38 offen lds
  s_mov_b32 exec_hi, -1
  s_waitcnt lgkmcnt(6)
  v_mfma_f32_32x32x16_bf16 v[176:191], v[36:39], v[68:71], v[176:191]
  ds_read_b64_tr_b16 v[52:53], v16 offset:9728
  ds_read_b64_tr_b16 v[54:55], v16 offset:12032
  s_waitcnt lgkmcnt(6)
  v_mfma_f32_32x32x16_bf16 v[192:207], v[40:43], v[68:71], v[192:207]
  s_waitcnt vmcnt(12)
  s_waitcnt lgkmcnt(0)
  s_barrier
  v_add_u32 v16, 36864, v16
  ds_read_b64_tr_b16 v[32:33], v16 offset:0
  ds_read_b64_tr_b16 v[34:35], v16 offset:2304
  v_mfma_f32_32x32x16_bf16 v[208:223], v[44:47], v[68:71], v[208:223]
  ds_read_b64_tr_b16 v[36:37], v16 offset:64
  ds_read_b64_tr_b16 v[38:39], v16 offset:2368
  s_add_u32 s40, s32, 5632
  buffer_load_dwordx4 v[88:91], v2, s[20:23], s40 offen sc1
  v_mfma_f32_32x32x16_bf16 v[224:239], v[48:51], v[68:71], v[224:239]
  ds_read_b64_tr_b16 v[40:41], v16 offset:128
  ds_read_b64_tr_b16 v[42:43], v16 offset:2432
  v_mfma_f32_32x32x16_bf16 v[240:255], v[52:55], v[68:71], v[240:255]
  ds_read_b64_tr_b16 v[44:45], v16 offset:192
  ds_read_b64_tr_b16 v[46:47], v16 offset:2496
  buffer_load_dwordx4 v[92:95], v2, s[20:23], s40 offen offset:256 sc1
  s_waitcnt lgkmcnt(6)
  v_mfma_f32_32x32x16_bf16 v[112:127], v[32:35], v[72:75], v[112:127]
  ds_read_b64_tr_b16 v[48:49], v16 offset:256
  ds_read_b64_tr_b16 v[50:51], v16 offset:2560
  s_waitcnt lgkmcnt(6)
  v_mfma_f32_32x32x16_bf16 v[128:143], v[36:39], v[72:75], v[128:143]
  ds_read_b64_tr_b16 v[52:53], v16 offset:320
  ds_read_b64_tr_b16 v[54:55], v16 offset:2624
  s_waitcnt lgkmcnt(6)
  v_mfma_f32_32x32x16_bf16 v[144:159], v[40:43], v[72:75], v[144:159]
  ds_read_b64_tr_b16 v[32:33], v16 offset:384
  ds_read_b64_tr_b16 v[34:35], v16 offset:2688
  s_add_u32 m0, s30, 0
  s_add_u32 s38, s34, 3538944
  buffer_load_dwordx4 v3, s[4:7], s38 offen lds
  s_waitcnt lgkmcnt(6)
  v_mfma_f32_32x32x16_bf16 v[160:175], v[44:47], v[72:75], v[160:175]
  ds_read_b64_tr_b16 v[36:37], v16 offset:448
  ds_read_b64_tr_b16 v[38:39], v16 offset:2752
  s_waitcnt lgkmcnt(6)
  v_mfma_f32_32x32x16_bf16 v[176:191], v[48:51], v[72:75], v[176:191]
  ds_read_b64_tr_b16 v[40:41], v16 offset:512
  ds_read_b64_tr_b16 v[42:43], v16 offset:2816
  s_waitcnt lgkmcnt(6)
  v_mfma_f32_32x32x16_bf16 v[192:207], v[52:55], v[72:75], v[192:207]
  ds_read_b64_tr_b16 v[44:45], v16 offset:9216
  ds_read_b64_tr_b16 v[46:47], v16 offset:11520
  buffer_load_dwordx4 v4, s[4:7], s38 offen offset:1024 lds
  s_waitcnt lgkmcnt(6)
  v_mfma_f32_32x32x16_bf16 v[208:223], v[32:35], v[72:75], v[208:223]
  ds_read_b64_tr_b16 v[48:49], v16 offset:9280
  ds_read_b64_tr_b16 v[50:51], v16 offset:11584
  s_waitcnt lgkmcnt(6)
  v_mfma_f32_32x32x16_bf16 v[224:239], v[36:39], v[72:75], v[224:239]
  ds_read_b64_tr_b16 v[52:53], v16 offset:9344
  ds_read_b64_tr_b16 v[54:55], v16 offset:11648
  buffer_load_dwordx4 v5, s[4:7], s38 offen offset:2048 lds
  s_waitcnt lgkmcnt(6)
  v_mfma_f32_32x32x16_bf16 v[240:255], v[40:43], v[72:75], v[240:255]
  ds_read_b64_tr_b16 v[32:33], v16 offset:9408
  ds_read_b64_tr_b16 v[34:35], v16 offset:11712
  s_waitcnt lgkmcnt(6)
  v_mfma_f32_32x32x16_bf16 v[112:127], v[44:47], v[76:79], v[112:127]
  ds_read_b64_tr_b16 v[36:37], v16 offset:9472
  ds_read_b64_tr_b16 v[38:39], v16 offset:11776
  s_waitcnt lgkmcnt(6)
  v_mfma_f32_32x32x16_bf16 v[128:143], v[48:51], v[76:79], v[128:143]
  ds_read_b64_tr_b16 v[40:41], v16 offset:9536
  ds_read_b64_tr_b16 v[42:43], v16 offset:11840
  buffer_load_dwordx4 v6, s[4:7], s38 offen offset:3072 lds
  s_waitcnt lgkmcnt(6)
  v_mfma_f32_32x32x16_bf16 v[144:159], v[52:55], v[76:79], v[144:159]
  ds_read_b64_tr_b16 v[44:45], v16 offset:9600
  ds_read_b64_tr_b16 v[46:47], v16 offset:11904
  s_waitcnt lgkmcnt(6)
  v_mfma_f32_32x32x16_bf16 v[160:175], v[32:35], v[76:79], v[160:175]
  ds_read_b64_tr_b16 v[48:49], v16 offset:9664
  ds_read_b64_tr_b16 v[50:51], v16 offset:11968
  s_add_u32 m0, m0, 4096
  s_mov_b32 exec_hi, 0
  buffer_load_dwordx4 v7, s[4:7], s38 offen lds
  s_mov_b32 exec_hi, -1
  s_waitcnt lgkmcnt(6)
  v_mfma_f32_32x32x16_bf16 v[176:191], v[36:39], v[76:79], v[176:191]
  ds_read_b64_tr_b16 v[52:53], v16 offset:9728
  ds_read_b64_tr_b16 v[54:55], v16 offset:12032
  s_waitcnt lgkmcnt(6)
  v_mfma_f32_32x32x16_bf16 v[192:207], v[40:43], v[76:79], v[192:207]
  s_waitcnt vmcnt(12)
  s_waitcnt lgkmcnt(0)
  s_barrier
  v_add_u32 v16, 36864, v16
  ds_read_b64_tr_b16 v[32:33], v16 offset:0
  ds_read_b64_tr_b16 v[34:35], v16 offset:2304
  v_mfma_f32_32x32x16_bf16 v[208:223], v[44:47], v[76:79], v[208:223]
  ds_read_b64_tr_b16 v[36:37], v16 offset:64
  ds_read_b64_tr_b16 v[38:39], v16 offset:2368
  s_add_u32 s40, s32, 6144
  buffer_load_dwordx4 v[64:67], v2, s[20:23], s40 offen sc1
  v_mfma_f32_32x32x16_bf16 v[224:239], v[48:51], v[76:79], v[224:239]
  ds_read_b64_tr_b16 v[40:41], v16 offset:128
  ds_read_b64_tr_b16 v[42:43], v16 offset:2432
  v_mfma_f32_32x32x16_bf16 v[240:255], v[52:55], v[76:79], v[240:255]
  ds_read_b64_tr_b16 v[44:45], v16 offset:192
  ds_read_b64_tr_b16 v[46:47], v16 offset:2496
  buffer_load_dwordx4 v[68:71], v2, s[20:23], s40 offen offset:256 sc1
  s_waitcnt lgkmcnt(6)
  v_mfma_f32_32x32x16_bf16 v[112:127], v[32:35], v[80:83], v[112:127]
  ds_read_b64_tr_b16 v[48:49], v16 offset:256
  ds_read_b64_tr_b16 v[50:51], v16 offset:2560
  s_waitcnt lgkmcnt(6)
  v_mfma_f32_32x32x16_bf16 v[128:143], v[36:39], v[80:83], v[128:143]
  ds_read_b64_tr_b16 v[52:53], v16 offset:320
  ds_read_b64_tr_b16 v[54:55], v16 offset:2624
  s_waitcnt lgkmcnt(6)
  v_mfma_f32_32x32x16_bf16 v[144:159], v[40:43], v[80:83], v[144:159]
  ds_read_b64_tr_b16 v[32:33], v16 offset:384
  ds_read_b64_tr_b16 v[34:35], v16 offset:2688
  s_add_u32 m0, s30, 36864
  s_add_u32 s38, s34, 3833856
  buffer_load_dwordx4 v3, s[4:7], s38 offen lds
  s_waitcnt lgkmcnt(6)
  v_mfma_f32_32x32x16_bf16 v[160:175], v[44:47], v[80:83], v[160:175]
  ds_read_b64_tr_b16 v[36:37], v16 offset:448
  ds_read_b64_tr_b16 v[38:39], v16 offset:2752
  s_waitcnt lgkmcnt(6)
  v_mfma_f32_32x32x16_bf16 v[176:191], v[48:51], v[80:83], v[176:191]
  ds_read_b64_tr_b16 v[40:41], v16 offset:512
  ds_read_b64_tr_b16 v[42:43], v16 offset:2816
  s_waitcnt lgkmcnt(6)
  v_mfma_f32_32x32x16_bf16 v[192:207], v[52:55], v[80:83], v[192:207]
  ds_read_b64_tr_b16 v[44:45], v16 offset:9216
  ds_read_b64_tr_b16 v[46:47], v16 offset:11520
  buffer_load_dwordx4 v4, s[4:7], s38 offen offset:1024 lds
  s_waitcnt lgkmcnt(6)
  v_mfma_f32_32x32x16_bf16 v[208:223], v[32:35], v[80:83], v[208:223]
  ds_read_b64_tr_b16 v[48:49], v16 offset:9280
  ds_read_b64_tr_b16 v[50:51], v16 offset:11584
  s_waitcnt lgkmcnt(6)
  v_mfma_f32_32x32x16_bf16 v[224:239], v[36:39], v[80:83], v[224:239]
  ds_read_b64_tr_b16 v[52:53], v16 offset:9344
  ds_read_b64_tr_b16 v[54:55], v16 offset:11648
  buffer_load_dwordx4 v5, s[4:7], s38 offen offset:2048 lds
  s_waitcnt lgkmcnt(6)
  v_mfma_f32_32x32x16_bf16 v[240:255], v[40:43], v[80:83], v[240:255]
  ds_read_b64_tr_b16 v[32:33], v16 offset:9408
  ds_read_b64_tr_b16 v[34:35], v16 offset:11712
  s_waitcnt lgkmcnt(6)
  v_mfma_f32_32x32x16_bf16 v[112:127], v[44:47], v[84:87], v[112:127]
  ds_read_b64_tr_b16 v[36:37], v16 offset:9472
  ds_read_b64_tr_b16 v[38:39], v16 offset:11776
  s_waitcnt lgkmcnt(6)
  v_mfma_f32_32x32x16_bf16 v[128:143], v[48:51], v[84:87], v[128:143]
  ds_read_b64_tr_b16 v[40:41], v16 offset:9536
  ds_read_b64_tr_b16 v[42:43], v16 offset:11840
  buffer_load_dwordx4 v6, s[4:7], s38 offen offset:3072 lds
  s_waitcnt lgkmcnt(6)
  v_mfma_f32_32x32x16_bf16 v[144:159], v[52:55], v[84:87], v[144:159]
  ds_read_b64_tr_b16 v[44:45], v16 offset:9600
  ds_read_b64_tr_b16 v[46:47], v16 offset:11904
  s_waitcnt lgkmcnt(6)
  v_mfma_f32_32x32x16_bf16 v[160:175], v[32:35], v[84:87], v[160:175]
  ds_read_b64_tr_b16 v[48:49], v16 offset:9664
  ds_read_b64_tr_b16 v[50:51], v16 offset:11968
  s_add_u32 m0, m0, 4096
  s_mov_b32 exec_hi, 0
  buffer_load_dwordx4 v7, s[4:7], s38 offen lds
  s_mov_b32 exec_hi, -1
  s_waitcnt lgkmcnt(6)
  v_mfma_f32_32x32x16_bf16 v[176:191], v[36:39], v[84:87], v[176:191]
  ds_read_b64_tr_b16 v[52:53], v16 offset:9728
  ds_read_b64_tr_b16 v[54:55], v16 offset:12032
  s_waitcnt lgkmcnt(6)
  v_mfma_f32_32x32x16_bf16 v[192:207], v[40:43], v[84:87], v[192:207]
  s_waitcnt vmcnt(12)
  s_waitcnt lgkmcnt(0)
  s_barrier
  v_add_u32 v16, 36864, v16
  ds_read_b64_tr_b16 v[32:33], v16 offset:0
  ds_read_b64_tr_b16 v[34:35], v16 offset:2304
  v_mfma_f32_32x32x16_bf16 v[208:223], v[44:47], v[84:87], v[208:223]
  ds_read_b64_tr_b16 v[36:37], v16 offset:64
  ds_read_b64_tr_b16 v[38:39], v16 offset:2368
  s_add_u32 s40, s32, 6656
  buffer_load_dwordx4 v[72:75], v2, s[20:23], s40 offen sc1
  v_mfma_f32_32x32x16_bf16 v[224:239], v[48:51], v[84:87], v[224:239]
  ds_read_b64_tr_b16 v[40:41], v16 offset:128
  ds_read_b64_tr_b16 v[42:43], v16 offset:2432
  v_mfma_f32_32x32x16_bf16 v[240:255], v[52:55], v[84:87], v[240:255]
  ds_read_b64_tr_b16 v[44:45], v16 offset:192
  ds_read_b64_tr_b16 v[46:47], v16 offset:2496
  buffer_load_dwordx4 v[76:79], v2, s[20:23], s40 offen offset:256 sc1
  s_waitcnt lgkmcnt(6)
  v_mfma_f32_32x32x16_bf16 v[112:127], v[32:35], v[88:91], v[112:127]
  ds_read_b64_tr_b16 v[48:49], v16 offset:256
  ds_read_b64_tr_b16 v[50:51], v16 offset:2560
  s_waitcnt lgkmcnt(6)
  v_mfma_f32_32x32x16_bf16 v[128:143], v[36:39], v[88:91], v[128:143]
  ds_read_b64_tr_b16 v[52:53], v16 offset:320
  ds_read_b64_tr_b16 v[54:55], v16 offset:2624
  s_waitcnt lgkmcnt(6)
  v_mfma_f32_32x32x16_bf16 v[144:159], v[40:43], v[88:91], v[144:159]
  ds_read_b64_tr_b16 v[32:33], v16 offset:384
  ds_read_b64_tr_b16 v[34:35], v16 offset:2688
  s_add_u32 m0, s30, 73728
  s_add_u32 s38, s34, 4128768
  buffer_load_dwordx4 v3, s[4:7], s38 offen lds
  s_waitcnt lgkmcnt(6)
  v_mfma_f32_32x32x16_bf16 v[160:175], v[44:47], v[88:91], v[160:175]
  ds_read_b64_tr_b16 v[36:37], v16 offset:448
  ds_read_b64_tr_b16 v[38:39], v16 offset:2752
  s_waitcnt lgkmcnt(6)
  v_mfma_f32_32x32x16_bf16 v[176:191], v[48:51], v[88:91], v[176:191]
  ds_read_b64_tr_b16 v[40:41], v16 offset:512
  ds_read_b64_tr_b16 v[42:43], v16 offset:2816
  s_waitcnt lgkmcnt(6)
  v_mfma_f32_32x32x16_bf16 v[192:207], v[52:55], v[88:91], v[192:207]
  ds_read_b64_tr_b16 v[44:45], v16 offset:9216
  ds_read_b64_tr_b16 v[46:47], v16 offset:11520
  buffer_load_dwordx4 v4, s[4:7], s38 offen offset:1024 lds
  s_waitcnt lgkmcnt(6)
  v_mfma_f32_32x32x16_bf16 v[208:223], v[32:35], v[88:91], v[208:223]
  ds_read_b64_tr_b16 v[48:49], v16 offset:9280
  ds_read_b64_tr_b16 v[50:51], v16 offset:11584
  s_waitcnt lgkmcnt(6)
  v_mfma_f32_32x32x16_bf16 v[224:239], v[36:39], v[88:91], v[224:239]
  ds_read_b64_tr_b16 v[52:53], v16 offset:9344
  ds_read_b64_tr_b16 v[54:55], v16 offset:11648
  buffer_load_dwordx4 v5, s[4:7], s38 offen offset:2048 lds
  s_waitcnt lgkmcnt(6)
  v_mfma_f32_32x32x16_bf16 v[240:255], v[40:43], v[88:91], v[240:255]
  ds_read_b64_tr_b16 v[32:33], v16 offset:9408
  ds_read_b64_tr_b16 v[34:35], v16 offset:11712
  s_waitcnt lgkmcnt(6)
  v_mfma_f32_32x32x16_bf16 v[112:127], v[44:47], v[92:95], v[112:127]
  ds_read_b64_tr_b16 v[36:37], v16 offset:9472
  ds_read_b64_tr_b16 v[38:39], v16 offset:11776
  s_waitcnt lgkmcnt(6)
  v_mfma_f32_32x32x16_bf16 v[128:143], v[48:51], v[92:95], v[128:143]
  ds_read_b64_tr_b16 v[40:41], v16 offset:9536
  ds_read_b64_tr_b16 v[42:43], v16 offset:11840
  buffer_load_dwordx4 v6, s[4:7], s38 offen offset:3072 lds
  s_waitcnt lgkmcnt(6)
  v_mfma_f32_32x32x16_bf16 v[144:159], v[52:55], v[92:95], v[144:159]
  ds_read_b64_tr_b16 v[44:45], v16 offset:9600
  ds_read_b64_tr_b16 v[46:47], v16 offset:11904
  s_waitcnt lgkmcnt(6)
  v_mfma_f32_32x32x16_bf16 v[160:175], v[32:35], v[92:95], v[160:175]
  ds_read_b64_tr_b16 v[48:49], v16 offset:9664
  ds_read_b64_tr_b16 v[50:51], v16 offset:11968
  s_add_u32 m0, m0, 4096
  s_mov_b32 exec_hi, 0
  buffer_load_dwordx4 v7, s[4:7], s38 offen lds
  s_mov_b32 exec_hi, -1
  s_waitcnt lgkmcnt(6)
  v_mfma_f32_32x32x16_bf16 v[176:191], v[36:39], v[92:95], v[176:191]
  ds_read_b64_tr_b16 v[52:53], v16 offset:9728
  ds_read_b64_tr_b16 v[54:55], v16 offset:12032
  s_waitcnt lgkmcnt(6)
  v_mfma_f32_32x32x16_bf16 v[192:207], v[40:43], v[92:95], v[192:207]
  s_waitcnt vmcnt(12)
  s_waitcnt lgkmcnt(0)
  s_barrier
  v_add_u32 v16, 4294856704, v16
  ds_read_b64_tr_b16 v[32:33], v16 offset:0
  ds_read_b64_tr_b16 v[34:35], v16 offset:2304
  v_mfma_f32_32x32x16_bf16 v[208:223], v[44:47], v[92:95], v[208:223]
  ds_read_b64_tr_b16 v[36:37], v16 offset:64
  ds_read_b64_tr_b16 v[38:39], v16 offset:2368
  s_add_u32 s40, s32, 7168
  buffer_load_dwordx4 v[80:83], v2, s[20:23], s40 offen sc1
  v_mfma_f32_32x32x16_bf16 v[224:239], v[48:51], v[92:95], v[224:239]
  ds_read_b64_tr_b16 v[40:41], v16 offset:128
  ds_read_b64_tr_b16 v[42:43], v16 offset:2432
  v_mfma_f32_32x32x16_bf16 v[240:255], v[52:55], v[92:95], v[240:255]
  ds_read_b64_tr_b16 v[44:45], v16 offset:192
  ds_read_b64_tr_b16 v[46:47], v16 offset:2496
  buffer_load_dwordx4 v[84:87], v2, s[20:23], s40 offen offset:256 sc1
  s_waitcnt lgkmcnt(6)
  v_mfma_f32_32x32x16_bf16 v[112:127], v[32:35], v[64:67], v[112:127]
  ds_read_b64_tr_b16 v[48:49], v16 offset:256
  ds_read_b64_tr_b16 v[50:51], v16 offset:2560
  s_waitcnt lgkmcnt(6)
  v_mfma_f32_32x32x16_bf16 v[128:143], v[36:39], v[64:67], v[128:143]
  ds_read_b64_tr_b16 v[52:53], v16 offset:320
  ds_read_b64_tr_b16 v[54:55], v16 offset:2624
  s_waitcnt lgkmcnt(6)
  v_mfma_f32_32x32x16_bf16 v[144:159], v[40:43], v[64:67], v[144:159]
  ds_read_b64_tr_b16 v[32:33], v16 offset:384
  ds_read_b64_tr_b16 v[34:35], v16 offset:2688
  s_add_u32 m0, s30, 110592
  s_add_u32 s38, s34, 4423680
  buffer_load_dwordx4 v3, s[4:7], s38 offen lds
  s_waitcnt lgkmcnt(6)
  v_mfma_f32_32x32x16_bf16 v[160:175], v[44:47], v[64:67], v[160:175]
  ds_read_b64_tr_b16 v[36:37], v16 offset:448
  ds_read_b64_tr_b16 v[38:39], v16 offset:2752
  s_waitcnt lgkmcnt(6)
  v_mfma_f32_32x32x16_bf16 v[176:191], v[48:51], v[64:67], v[176:191]
  ds_read_b64_tr_b16 v[40:41], v16 offset:512
  ds_read_b64_tr_b16 v[42:43], v16 offset:2816
  s_waitcnt lgkmcnt(6)
  v_mfma_f32_32x32x16_bf16 v[192:207], v[52:55], v[64:67], v[192:207]
  ds_read_b64_tr_b16 v[44:45], v16 offset:9216
  ds_read_b64_tr_b16 v[46:47], v16 offset:11520
  buffer_load_dwordx4 v4, s[4:7], s38 offen offset:1024 lds
  s_waitcnt lgkmcnt(6)
  v_mfma_f32_32x32x16_bf16 v[208:223], v[32:35], v[64:67], v[208:223]
  ds_read_b64_tr_b16 v[48:49], v16 offset:9280
  ds_read_b64_tr_b16 v[50:51], v16 offset:11584
  s_waitcnt lgkmcnt(6)
  v_mfma_f32_32x32x16_bf16 v[224:239], v[36:39], v[64:67], v[224:239]
  ds_read_b64_tr_b16 v[52:53], v16 offset:9344
  ds_read_b64_tr_b16 v[54:55], v16 offset:11648
  buffer_load_dwordx4 v5, s[4:7], s38 offen offset:2048 lds
  s_waitcnt lgkmcnt(6)
  v_mfma_f32_32x32x16_bf16 v[240:255], v[40:43], v[64:67], v[240:255]
  ds_read_b64_tr_b16 v[32:33], v16 offset:9408
  ds_read_b64_tr_b16 v[34:35], v16 offset:11712
  s_waitcnt lgkmcnt(6)
  v_mfma_f32_32x32x16_bf16 v[112:127], v[44:47], v[68:71], v[112:127]
  ds_read_b64_tr_b16 v[36:37], v16 offset:9472
  ds_read_b64_tr_b16 v[38:39], v16 offset:11776
  s_waitcnt lgkmcnt(6)
  v_mfma_f32_32x32x16_bf16 v[128:143], v[48:51], v[68:71], v[128:143]
  ds_read_b64_tr_b16 v[40:41], v16 offset:9536
  ds_read_b64_tr_b16 v[42:43], v16 offset:11840
  buffer_load_dwordx4 v6, s[4:7], s38 offen offset:3072 lds
  s_waitcnt lgkmcnt(6)
  v_mfma_f32_32x32x16_bf16 v[144:159], v[52:55], v[68:71], v[144:159]
  ds_read_b64_tr_b16 v[44:45], v16 offset:9600
  ds_read_b64_tr_b16 v[46:47], v16 offset:11904
  s_waitcnt lgkmcnt(6)
  v_mfma_f32_32x32x16_bf16 v[160:175], v[32:35], v[68:71], v[160:175]
  ds_read_b64_tr_b16 v[48:49], v16 offset:9664
  ds_read_b64_tr_b16 v[50:51], v16 offset:11968
  s_add_u32 m0, m0, 4096
  s_mov_b32 exec_hi, 0
  buffer_load_dwordx4 v7, s[4:7], s38 offen lds
  s_mov_b32 exec_hi, -1
  s_waitcnt lgkmcnt(6)
  v_mfma_f32_32x32x16_bf16 v[176:191], v[36:39], v[68:71], v[176:191]
  ds_read_b64_tr_b16 v[52:53], v16 offset:9728
  ds_read_b64_tr_b16 v[54:55], v16 offset:12032
  s_waitcnt lgkmcnt(6)
  v_mfma_f32_32x32x16_bf16 v[192:207], v[40:43], v[68:71], v[192:207]
  s_waitcnt vmcnt(12)
  s_waitcnt lgkmcnt(0)
  s_barrier
  v_add_u32 v16, 36864, v16
  ds_read_b64_tr_b16 v[32:33], v16 offset:0
  ds_read_b64_tr_b16 v[34:35], v16 offset:2304
  v_mfma_f32_32x32x16_bf16 v[208:223], v[44:47], v[68:71], v[208:223]
  ds_read_b64_tr_b16 v[36:37], v16 offset:64
  ds_read_b64_tr_b16 v[38:39], v16 offset:2368
  s_add_u32 s40, s32, 7680
  buffer_load_dwordx4 v[88:91], v2, s[20:23], s40 offen sc1
  v_mfma_f32_32x32x16_bf16 v[224:239], v[48:51], v[68:71], v[224:239]
  ds_read_b64_tr_b16 v[40:41], v16 offset:128
  ds_read_b64_tr_b16 v[42:43], v16 offset:2432
  v_mfma_f32_32x32x16_bf16 v[240:255], v[52:55], v[68:71], v[240:255]
  ds_read_b64_tr_b16 v[44:45], v16 offset:192
  ds_read_b64_tr_b16 v[46:47], v16 offset:2496
  buffer_load_dwordx4 v[92:95], v2, s[20:23], s40 offen offset:256 sc1
  s_waitcnt lgkmcnt(6)
  v_mfma_f32_32x32x16_bf16 v[112:127], v[32:35], v[72:75], v[112:127]
  ds_read_b64_tr_b16 v[48:49], v16 offset:256
  ds_read_b64_tr_b16 v[50:51], v16 offset:2560
  s_waitcnt lgkmcnt(6)
  v_mfma_f32_32x32x16_bf16 v[128:143], v[36:39], v[72:75], v[128:143]
  ds_read_b64_tr_b16 v[52:53], v16 offset:320
  ds_read_b64_tr_b16 v[54:55], v16 offset:2624
  s_waitcnt lgkmcnt(6)
  v_mfma_f32_32x32x16_bf16 v[144:159], v[40:43], v[72:75], v[144:159]
  ds_read_b64_tr_b16 v[32:33], v16 offset:384
  ds_read_b64_tr_b16 v[34:35], v16 offset:2688
  s_add_u32 m0, s30, 0
  s_add_u32 s38, s34, 4718592
  buffer_load_dwordx4 v3, s[4:7], s38 offen lds
  s_waitcnt lgkmcnt(6)
  v_mfma_f32_32x32x16_bf16 v[160:175], v[44:47], v[72:75], v[160:175]
  ds_read_b64_tr_b16 v[36:37], v16 offset:448
  ds_read_b64_tr_b16 v[38:39], v16 offset:2752
  s_waitcnt lgkmcnt(6)
  v_mfma_f32_32x32x16_bf16 v[176:191], v[48:51], v[72:75], v[176:191]
  ds_read_b64_tr_b16 v[40:41], v16 offset:512
  ds_read_b64_tr_b16 v[42:43], v16 offset:2816
  s_waitcnt lgkmcnt(6)
  v_mfma_f32_32x32x16_bf16 v[192:207], v[52:55], v[72:75], v[192:207]
  ds_read_b64_tr_b16 v[44:45], v16 offset:9216
  ds_read_b64_tr_b16 v[46:47], v16 offset:11520
  buffer_load_dwordx4 v4, s[4:7], s38 offen offset:1024 lds
  s_waitcnt lgkmcnt(6)
  v_mfma_f32_32x32x16_bf16 v[208:223], v[32:35], v[72:75], v[208:223]
  ds_read_b64_tr_b16 v[48:49], v16 offset:9280
  ds_read_b64_tr_b16 v[50:51], v16 offset:11584
  s_waitcnt lgkmcnt(6)
  v_mfma_f32_32x32x16_bf16 v[224:239], v[36:39], v[72:75], v[224:239]
  ds_read_b64_tr_b16 v[52:53], v16 offset:9344
  ds_read_b64_tr_b16 v[54:55], v16 offset:11648
  buffer_load_dwordx4 v5, s[4:7], s38 offen offset:2048 lds
  s_waitcnt lgkmcnt(6)
  v_mfma_f32_32x32x16_bf16 v[240:255], v[40:43], v[72:75], v[240:255]
  ds_read_b64_tr_b16 v[32:33], v16 offset:9408
  ds_read_b64_tr_b16 v[34:35], v16 offset:11712
  s_waitcnt lgkmcnt(6)
  v_mfma_f32_32x32x16_bf16 v[112:127], v[44:47], v[76:79], v[112:127]
  ds_read_b64_tr_b16 v[36:37], v16 offset:9472
  ds_read_b64_tr_b16 v[38:39], v16 offset:11776
  s_waitcnt lgkmcnt(6)
  v_mfma_f32_32x32x16_bf16 v[128:143], v[48:51], v[76:79], v[128:143]
  ds_read_b64_tr_b16 v[40:41], v16 offset:9536
  ds_read_b64_tr_b16 v[42:43], v16 offset:11840
  buffer_load_dwordx4 v6, s[4:7], s38 offen offset:3072 lds
  s_waitcnt lgkmcnt(6)
  v_mfma_f32_32x32x16_bf16 v[144:159], v[52:55], v[76:79], v[144:159]
  ds_read_b64_tr_b16 v[44:45], v16 offset:9600
  ds_read_b64_tr_b16 v[46:47], v16 offset:11904
  s_waitcnt lgkmcnt(6)
  v_mfma_f32_32x32x16_bf16 v[160:175], v[32:35], v[76:79], v[160:175]
  ds_read_b64_tr_b16 v[48:49], v16 offset:9664
  ds_read_b64_tr_b16 v[50:51], v16 offset:11968
  s_add_u32 m0, m0, 4096
  s_mov_b32 exec_hi, 0
  buffer_load_dwordx4 v7, s[4:7], s38 offen lds
  s_mov_b32 exec_hi, -1
  s_waitcnt lgkmcnt(6)
  v_mfma_f32_32x32x16_bf16 v[176:191], v[36:39], v[76:79], v[176:191]
  ds_read_b64_tr_b16 v[52:53], v16 offset:9728
  ds_read_b64_tr_b16 v[54:55], v16 offset:12032
  s_waitcnt lgkmcnt(6)
  v_mfma_f32_32x32x16_bf16 v[192:207], v[40:43], v[76:79], v[192:207]
  s_waitcnt vmcnt(12)
  s_waitcnt lgkmcnt(0)
  s_barrier
  v_add_u32 v16, 36864, v16
  ds_read_b64_tr_b16 v[32:33], v16 offset:0
  ds_read_b64_tr_b16 v[34:35], v16 offset:2304
  v_mfma_f32_32x32x16_bf16 v[208:223], v[44:47], v[76:79], v[208:223]
  ds_read_b64_tr_b16 v[36:37], v16 offset:64
  ds_read_b64_tr_b16 v[38:39], v16 offset:2368
  s_add_u32 s40, s32, 8192
  buffer_load_dwordx4 v[64:67], v2, s[20:23], s40 offen sc1
  v_mfma_f32_32x32x16_bf16 v[224:239], v[48:51], v[76:79], v[224:239]
  ds_read_b64_tr_b16 v[40:41], v16 offset:128
  ds_read_b64_tr_b16 v[42:43], v16 offset:2432
  v_mfma_f32_32x32x16_bf16 v[240:255], v[52:55], v[76:79], v[240:255]
  ds_read_b64_tr_b16 v[44:45], v16 offset:192
  ds_read_b64_tr_b16 v[46:47], v16 offset:2496
  buffer_load_dwordx4 v[68:71], v2, s[20:23], s40 offen offset:256 sc1
  s_waitcnt lgkmcnt(6)
  v_mfma_f32_32x32x16_bf16 v[112:127], v[32:35], v[80:83], v[112:127]
  ds_read_b64_tr_b16 v[48:49], v16 offset:256
  ds_read_b64_tr_b16 v[50:51], v16 offset:2560
  s_waitcnt lgkmcnt(6)
  v_mfma_f32_32x32x16_bf16 v[128:143], v[36:39], v[80:83], v[128:143]
  ds_read_b64_tr_b16 v[52:53], v16 offset:320
  ds_read_b64_tr_b16 v[54:55], v16 offset:2624
  s_waitcnt lgkmcnt(6)
  v_mfma_f32_32x32x16_bf16 v[144:159], v[40:43], v[80:83], v[144:159]
  ds_read_b64_tr_b16 v[32:33], v16 offset:384
  ds_read_b64_tr_b16 v[34:35], v16 offset:2688
  s_add_u32 m0, s30, 36864
  s_add_u32 s38, s34, 5013504
  buffer_load_dwordx4 v3, s[4:7], s38 offen lds
  s_waitcnt lgkmcnt(6)
  v_mfma_f32_32x32x16_bf16 v[160:175], v[44:47], v[80:83], v[160:175]
  ds_read_b64_tr_b16 v[36:37], v16 offset:448
  ds_read_b64_tr_b16 v[38:39], v16 offset:2752
  s_waitcnt lgkmcnt(6)
  v_mfma_f32_32x32x16_bf16 v[176:191], v[48:51], v[80:83], v[176:191]
  ds_read_b64_tr_b16 v[40:41], v16 offset:512
  ds_read_b64_tr_b16 v[42:43], v16 offset:2816
  s_waitcnt lgkmcnt(6)
  v_mfma_f32_32x32x16_bf16 v[192:207], v[52:55], v[80:83], v[192:207]
  ds_read_b64_tr_b16 v[44:45], v16 offset:9216
  ds_read_b64_tr_b16 v[46:47], v16 offset:11520
  buffer_load_dwordx4 v4, s[4:7], s38 offen offset:1024 lds
  s_waitcnt lgkmcnt(6)
  v_mfma_f32_32x32x16_bf16 v[208:223], v[32:35], v[80:83], v[208:223]
  ds_read_b64_tr_b16 v[48:49], v16 offset:9280
  ds_read_b64_tr_b16 v[50:51], v16 offset:11584
  s_waitcnt lgkmcnt(6)
  v_mfma_f32_32x32x16_bf16 v[224:239], v[36:39], v[80:83], v[224:239]
  ds_read_b64_tr_b16 v[52:53], v16 offset:9344
  ds_read_b64_tr_b16 v[54:55], v16 offset:11648
  buffer_load_dwordx4 v5, s[4:7], s38 offen offset:2048 lds
  s_waitcnt lgkmcnt(6)
  v_mfma_f32_32x32x16_bf16 v[240:255], v[40:43], v[80:83], v[240:255]
  ds_read_b64_tr_b16 v[32:33], v16 offset:9408
  ds_read_b64_tr_b16 v[34:35], v16 offset:11712
  s_waitcnt lgkmcnt(6)
  v_mfma_f32_32x32x16_bf16 v[112:127], v[44:47], v[84:87], v[112:127]
  ds_read_b64_tr_b16 v[36:37], v16 offset:9472
  ds_read_b64_tr_b16 v[38:39], v16 offset:11776
  s_waitcnt lgkmcnt(6)
  v_mfma_f32_32x32x16_bf16 v[128:143], v[48:51], v[84:87], v[128:143]
  ds_read_b64_tr_b16 v[40:41], v16 offset:9536
  ds_read_b64_tr_b16 v[42:43], v16 offset:11840
  buffer_load_dwordx4 v6, s[4:7], s38 offen offset:3072 lds
  s_waitcnt lgkmcnt(6)
  v_mfma_f32_32x32x16_bf16 v[144:159], v[52:55], v[84:87], v[144:159]
  ds_read_b64_tr_b16 v[44:45], v16 offset:9600
  ds_read_b64_tr_b16 v[46:47], v16 offset:11904
  s_waitcnt lgkmcnt(6)
  v_mfma_f32_32x32x16_bf16 v[160:175], v[32:35], v[84:87], v[160:175]
  ds_read_b64_tr_b16 v[48:49], v16 offset:9664
  ds_read_b64_tr_b16 v[50:51], v16 offset:11968
  s_add_u32 m0, m0, 4096
  s_mov_b32 exec_hi, 0
  buffer_load_dwordx4 v7, s[4:7], s38 offen lds
  s_mov_b32 exec_hi, -1
  s_waitcnt lgkmcnt(6)
  v_mfma_f32_32x32x16_bf16 v[176:191], v[36:39], v[84:87], v[176:191]
  ds_read_b64_tr_b16 v[52:53], v16 offset:9728
  ds_read_b64_tr_b16 v[54:55], v16 offset:12032
  s_waitcnt lgkmcnt(6)
  v_mfma_f32_32x32x16_bf16 v[192:207], v[40:43], v[84:87], v[192:207]
  s_waitcnt vmcnt(12)
  s_waitcnt lgkmcnt(0)
  s_barrier
  v_add_u32 v16, 36864, v16
  ds_read_b64_tr_b16 v[32:33], v16 offset:0
  ds_read_b64_tr_b16 v[34:35], v16 offset:2304
  v_mfma_f32_32x32x16_bf16 v[208:223], v[44:47], v[84:87], v[208:223]
  ds_read_b64_tr_b16 v[36:37], v16 offset:64
  ds_read_b64_tr_b16 v[38:39], v16 offset:2368
  s_add_u32 s40, s32, 8704
  buffer_load_dwordx4 v[72:75], v2, s[20:23], s40 offen sc1
  v_mfma_f32_32x32x16_bf16 v[224:239], v[48:51], v[84:87], v[224:239]
  ds_read_b64_tr_b16 v[40:41], v16 offset:128
  ds_read_b64_tr_b16 v[42:43], v16 offset:2432
  v_mfma_f32_32x32x16_bf16 v[240:255], v[52:55], v[84:87], v[240:255]
  ds_read_b64_tr_b16 v[44:45], v16 offset:192
  ds_read_b64_tr_b16 v[46:47], v16 offset:2496
  buffer_load_dwordx4 v[76:79], v2, s[20:23], s40 offen offset:256 sc1
  s_waitcnt lgkmcnt(6)
  v_mfma_f32_32x32x16_bf16 v[112:127], v[32:35], v[88:91], v[112:127]
  ds_read_b64_tr_b16 v[48:49], v16 offset:256
  ds_read_b64_tr_b16 v[50:51], v16 offset:2560
  s_waitcnt lgkmcnt(6)
  v_mfma_f32_32x32x16_bf16 v[128:143], v[36:39], v[88:91], v[128:143]
  ds_read_b64_tr_b16 v[52:53], v16 offset:320
  ds_read_b64_tr_b16 v[54:55], v16 offset:2624
  s_waitcnt lgkmcnt(6)
  v_mfma_f32_32x32x16_bf16 v[144:159], v[40:43], v[88:91], v[144:159]
  ds_read_b64_tr_b16 v[32:33], v16 offset:384
  ds_read_b64_tr_b16 v[34:35], v16 offset:2688
  s_add_u32 m0, s30, 73728
  s_add_u32 s38, s36, 0
  buffer_load_dwordx4 v19, s[16:19], s38 offen lds
  s_waitcnt lgkmcnt(6)
  v_mfma_f32_32x32x16_bf16 v[160:175], v[44:47], v[88:91], v[160:175]
  ds_read_b64_tr_b16 v[36:37], v16 offset:448
  ds_read_b64_tr_b16 v[38:39], v16 offset:2752
  s_waitcnt lgkmcnt(6)
  v_mfma_f32_32x32x16_bf16 v[176:191], v[48:51], v[88:91], v[176:191]
  ds_read_b64_tr_b16 v[40:41], v16 offset:512
  ds_read_b64_tr_b16 v[42:43], v16 offset:2816
  s_waitcnt lgkmcnt(6)
  v_mfma_f32_32x32x16_bf16 v[192:207], v[52:55], v[88:91], v[192:207]
  ds_read_b64_tr_b16 v[44:45], v16 offset:9216
  ds_read_b64_tr_b16 v[46:47], v16 offset:11520
  s_add_u32 m0, s30, 74752
  s_add_u32 s38, s36, 9216
  buffer_load_dwordx4 v19, s[16:19], s38 offen lds
  s_waitcnt lgkmcnt(6)
  v_mfma_f32_32x32x16_bf16 v[208:223], v[32:35], v[88:91], v[208:223]
  ds_read_b64_tr_b16 v[48:49], v16 offset:9280
  ds_read_b64_tr_b16 v[50:51], v16 offset:11584
  s_waitcnt lgkmcnt(6)
  v_mfma_f32_32x32x16_bf16 v[224:239], v[36:39], v[88:91], v[224:239]
  ds_read_b64_tr_b16 v[52:53], v16 offset:9344
  ds_read_b64_tr_b16 v[54:55], v16 offset:11648
  s_add_u32 m0, s30, 75776
  s_add_u32 s38, s36, 18432
  buffer_load_dwordx4 v19, s[16:19], s38 offen lds
  s_waitcnt lgkmcnt(6)
  v_mfma_f32_32x32x16_bf16 v[240:255], v[40:43], v[88:91], v[240:255]
  ds_read_b64_tr_b16 v[32:33], v16 offset:9408
  ds_read_b64_tr_b16 v[34:35], v16 offset:11712
  s_waitcnt lgkmcnt(6)
  v_mfma_f32_32x32x16_bf16 v[112:127], v[44:47], v[92:95], v[112:127]
  ds_read_b64_tr_b16 v[36:37], v16 offset:9472
  ds_read_b64_tr_b16 v[38:39], v16 offset:11776
  s_waitcnt lgkmcnt(6)
  v_mfma_f32_32x32x16_bf16 v[128:143], v[48:51], v[92:95], v[128:143]
  ds_read_b64_tr_b16 v[40:41], v16 offset:9536
  ds_read_b64_tr_b16 v[42:43], v16 offset:11840
  s_add_u32 m0, s30, 76800
  s_add_u32 s38, s36, 27648
  buffer_load_dwordx4 v19, s[16:19], s38 offen lds
  s_waitcnt lgkmcnt(6)
  v_mfma_f32_32x32x16_bf16 v[144:159], v[52:55], v[92:95], v[144:159]
  ds_read_b64_tr_b16 v[44:45], v16 offset:9600
  ds_read_b64_tr_b16 v[46:47], v16 offset:11904
  s_waitcnt lgkmcnt(6)
  v_mfma_f32_32x32x16_bf16 v[160:175], v[32:35], v[92:95], v[160:175]
  ds_read_b64_tr_b16 v[48:49], v16 offset:9664
  ds_read_b64_tr_b16 v[50:51], v16 offset:11968
  s_add_u32 m0, s30, 77824
  s_add_u32 s38, s36, 36864
  s_mov_b32 exec_hi, 0
  buffer_load_dwordx4 v19, s[16:19], s38 offen lds
  s_mov_b32 exec_hi, -1
  s_waitcnt lgkmcnt(6)
  v_mfma_f32_32x32x16_bf16 v[176:191], v[36:39], v[92:95], v[176:191]
  ds_read_b64_tr_b16 v[52:53], v16 offset:9728
  ds_read_b64_tr_b16 v[54:55], v16 offset:12032
  s_waitcnt lgkmcnt(6)
  v_mfma_f32_32x32x16_bf16 v[192:207], v[40:43], v[92:95], v[192:207]
  s_waitcnt vmcnt(12)
  s_waitcnt lgkmcnt(0)
  s_barrier
  v_add_u32 v16, 4294856704, v16
  ds_read_b64_tr_b16 v[32:33], v16 offset:0
  ds_read_b64_tr_b16 v[34:35], v16 offset:2304
  v_mfma_f32_32x32x16_bf16 v[208:223], v[44:47], v[92:95], v[208:223]
  ds_read_b64_tr_b16 v[36:37], v16 offset:64
  ds_read_b64_tr_b16 v[38:39], v16 offset:2368
  s_add_u32 m0, s30, 110592
  s_add_u32 s38, s36, 128
  buffer_load_dwordx4 v19, s[16:19], s38 offen lds
  v_mfma_f32_32x32x16_bf16 v[224:239], v[48:51], v[92:95], v[224:239]
  ds_read_b64_tr_b16 v[40:41], v16 offset:128
  ds_read_b64_tr_b16 v[42:43], v16 offset:2432
  v_mfma_f32_32x32x16_bf16 v[240:255], v[52:55], v[92:95], v[240:255]
  ds_read_b64_tr_b16 v[44:45], v16 offset:192
  ds_read_b64_tr_b16 v[46:47], v16 offset:2496
  s_add_u32 m0, s30, 111616
  s_add_u32 s38, s36, 9344
  buffer_load_dwordx4 v19, s[16:19], s38 offen lds
  s_waitcnt lgkmcnt(6)
  v_mfma_f32_32x32x16_bf16 v[112:127], v[32:35], v[64:67], v[112:127]
  ds_read_b64_tr_b16 v[48:49], v16 offset:256
  ds_read_b64_tr_b16 v[50:51], v16 offset:2560
  s_waitcnt lgkmcnt(6)
  v_mfma_f32_32x32x16_bf16 v[128:143], v[36:39], v[64:67], v[128:143]
  ds_read_b64_tr_b16 v[52:53], v16 offset:320
  ds_read_b64_tr_b16 v[54:55], v16 offset:2624
  s_waitcnt lgkmcnt(6)
  v_mfma_f32_32x32x16_bf16 v[144:159], v[40:43], v[64:67], v[144:159]
  ds_read_b64_tr_b16 v[32:33], v16 offset:384
  ds_read_b64_tr_b16 v[34:35], v16 offset:2688
  s_add_u32 m0, s30, 112640
  s_add_u32 s38, s36, 18560
  buffer_load_dwordx4 v19, s[16:19], s38 offen lds
  s_waitcnt lgkmcnt(6)
  v_mfma_f32_32x32x16_bf16 v[160:175], v[44:47], v[64:67], v[160:175]
  ds_read_b64_tr_b16 v[36:37], v16 offset:448
  ds_read_b64_tr_b16 v[38:39], v16 offset:2752
  s_waitcnt lgkmcnt(6)
  v_mfma_f32_32x32x16_bf16 v[176:191], v[48:51], v[64:67], v[176:191]
  ds_read_b64_tr_b16 v[40:41], v16 offset:512
  ds_read_b64_tr_b16 v[42:43], v16 offset:2816
  s_waitcnt lgkmcnt(6)
  v_mfma_f32_32x32x16_bf16 v[192:207], v[52:55], v[64:67], v[192:207]
  ds_read_b64_tr_b16 v[44:45], v16 offset:9216
  ds_read_b64_tr_b16 v[46:47], v16 offset:11520
  s_add_u32 m0, s30, 113664
  s_add_u32 s38, s36, 27776
  buffer_load_dwordx4 v19, s[16:19], s38 offen lds
  s_waitcnt lgkmcnt(6)
  v_mfma_f32_32x32x16_bf16 v[208:223], v[32:35], v[64:67], v[208:223]
  ds_read_b64_tr_b16 v[48:49], v16 offset:9280
  ds_read_b64_tr_b16 v[50:51], v16 offset:11584
  s_waitcnt lgkmcnt(6)
  v_mfma_f32_32x32x16_bf16 v[224:239], v[36:39], v[64:67], v[224:239]
  ds_read_b64_tr_b16 v[52:53], v16 offset:9344
  ds_read_b64_tr_b16 v[54:55], v16 offset:11648
  s_add_u32 m0, s30, 114688
  s_add_u32 s38, s36, 36992
  s_mov_b32 exec_hi, 0
  buffer_load_dwordx4 v19, s[16:19], s38 offen lds
  s_mov_b32 exec_hi, -1
  s_waitcnt lgkmcnt(6)
  v_mfma_f32_32x32x16_bf16 v[240:255], v[40:43], v[64:67], v[240:255]
  ds_read_b64_tr_b16 v[32:33], v16 offset:9408
  ds_read_b64_tr_b16 v[34:35], v16 offset:11712
  s_waitcnt lgkmcnt(6)
  v_mfma_f32_32x32x16_bf16 v[112:127], v[44:47], v[68:71], v[112:127]
  ds_read_b64_tr_b16 v[36:37], v16 offset:9472
  ds_read_b64_tr_b16 v[38:39], v16 offset:11776
  s_waitcnt lgkmcnt(6)
  v_mfma_f32_32x32x16_bf16 v[128:143], v[48:51], v[68:71], v[128:143]
  ds_read_b64_tr_b16 v[40:41], v16 offset:9536
  ds_read_b64_tr_b16 v[42:43], v16 offset:11840
  s_waitcnt lgkmcnt(6)
  v_mfma_f32_32x32x16_bf16 v[144:159], v[52:55], v[68:71], v[144:159]
  ds_read_b64_tr_b16 v[44:45], v16 offset:9600
  ds_read_b64_tr_b16 v[46:47], v16 offset:11904
  s_waitcnt lgkmcnt(6)
  v_mfma_f32_32x32x16_bf16 v[160:175], v[32:35], v[68:71], v[160:175]
  ds_read_b64_tr_b16 v[48:49], v16 offset:9664
  ds_read_b64_tr_b16 v[50:51], v16 offset:11968
  s_waitcnt lgkmcnt(6)
  v_mfma_f32_32x32x16_bf16 v[176:191], v[36:39], v[68:71], v[176:191]
  ds_read_b64_tr_b16 v[52:53], v16 offset:9728
  ds_read_b64_tr_b16 v[54:55], v16 offset:12032
  s_waitcnt lgkmcnt(6)
  v_mfma_f32_32x32x16_bf16 v[192:207], v[40:43], v[68:71], v[192:207]
  s_waitcnt vmcnt(10)
  s_waitcnt lgkmcnt(0)
  s_barrier
  v_add_u32 v16, 36864, v16
  ds_read_b64_tr_b16 v[32:33], v16 offset:0
  ds_read_b64_tr_b16 v[34:35], v16 offset:2304
  v_mfma_f32_32x32x16_bf16 v[208:223], v[44:47], v[68:71], v[208:223]
  ds_read_b64_tr_b16 v[36:37], v16 offset:64
  ds_read_b64_tr_b16 v[38:39], v16 offset:2368
  v_mfma_f32_32x32x16_bf16 v[224:239], v[48:51], v[68:71], v[224:239]
  ds_read_b64_tr_b16 v[40:41], v16 offset:128
  ds_read_b64_tr_b16 v[42:43], v16 offset:2432
  v_mfma_f32_32x32x16_bf16 v[240:255], v[52:55], v[68:71], v[240:255]
  ds_read_b64_tr_b16 v[44:45], v16 offset:192
  ds_read_b64_tr_b16 v[46:47], v16 offset:2496
  s_waitcnt lgkmcnt(6)
  v_mfma_f32_32x32x16_bf16 v[112:127], v[32:35], v[72:75], v[112:127]
  ds_read_b64_tr_b16 v[48:49], v16 offset:256
  ds_read_b64_tr_b16 v[50:51], v16 offset:2560
  s_waitcnt lgkmcnt(6)
  v_mfma_f32_32x32x16_bf16 v[128:143], v[36:39], v[72:75], v[128:143]
  ds_read_b64_tr_b16 v[52:53], v16 offset:320
  ds_read_b64_tr_b16 v[54:55], v16 offset:2624
  s_waitcnt lgkmcnt(6)
  v_mfma_f32_32x32x16_bf16 v[144:159], v[40:43], v[72:75], v[144:159]
  ds_read_b64_tr_b16 v[32:33], v16 offset:384
  ds_read_b64_tr_b16 v[34:35], v16 offset:2688
  s_waitcnt lgkmcnt(6)
  v_mfma_f32_32x32x16_bf16 v[160:175], v[44:47], v[72:75], v[160:175]
  ds_read_b64_tr_b16 v[36:37], v16 offset:448
  ds_read_b64_tr_b16 v[38:39], v16 offset:2752
  s_waitcnt lgkmcnt(6)
  v_mfma_f32_32x32x16_bf16 v[176:191], v[48:51], v[72:75], v[176:191]
  ds_read_b64_tr_b16 v[40:41], v16 offset:512
  ds_read_b64_tr_b16 v[42:43], v16 offset:2816
  s_waitcnt lgkmcnt(6)
  v_mfma_f32_32x32x16_bf16 v[192:207], v[52:55], v[72:75], v[192:207]
  ds_read_b64_tr_b16 v[44:45], v16 offset:9216
  ds_read_b64_tr_b16 v[46:47], v16 offset:11520
  s_waitcnt lgkmcnt(6)
  v_mfma_f32_32x32x16_bf16 v[208:223], v[32:35], v[72:75], v[208:223]
  ds_read_b64_tr_b16 v[48:49], v16 offset:9280
  ds_read_b64_tr_b16 v[50:51], v16 offset:11584
  s_waitcnt lgkmcnt(6)
  v_mfma_f32_32x32x16_bf16 v[224:239], v[36:39], v[72:75], v[224:239]
  ds_read_b64_tr_b16 v[52:53], v16 offset:9344
  ds_read_b64_tr_b16 v[54:55], v16 offset:11648
  s_waitcnt lgkmcnt(6)
  v_mfma_f32_32x32x16_bf16 v[240:255], v[40:43], v[72:75], v[240:255]
  ds_read_b64_tr_b16 v[32:33], v16 offset:9408
  ds_read_b64_tr_b16 v[34:35], v16 offset:11712
  s_waitcnt lgkmcnt(6)
  v_mfma_f32_32x32x16_bf16 v[112:127], v[44:47], v[76:79], v[112:127]
  ds_read_b64_tr_b16 v[36:37], v16 offset:9472
  ds_read_b64_tr_b16 v[38:39], v16 offset:11776
  s_waitcnt lgkmcnt(6)
  v_mfma_f32_32x32x16_bf16 v[128:143], v[48:51], v[76:79], v[128:143]
  ds_read_b64_tr_b16 v[40:41], v16 offset:9536
  ds_read_b64_tr_b16 v[42:43], v16 offset:11840
  s_waitcnt lgkmcnt(6)
  v_mfma_f32_32x32x16_bf16 v[144:159], v[52:55], v[76:79], v[144:159]
  ds_read_b64_tr_b16 v[44:45], v16 offset:9600
  ds_read_b64_tr_b16 v[46:47], v16 offset:11904
  s_nop 1
  v_pk_mul_f32 v[24:25], v[112:113], v[112:113]
  v_pk_mul_f32 v[26:27], v[114:115], v[114:115]
  v_pk_fma_f32 v[24:25], v[24:25], s[42:43], v[22:23] op_sel_hi:[1,0,0]
  v_pk_fma_f32 v[26:27], v[26:27], s[42:43], v[22:23] op_sel_hi:[1,0,0]
  v_pk_mul_f32 v[24:25], v[24:25], v[112:113]
  v_pk_mul_f32 v[26:27], v[26:27], v[114:115]
  v_exp_f32 v24, v24
  v_exp_f32 v25, v25
  v_exp_f32 v26, v26
  v_exp_f32 v27, v27
  v_pk_mul_f32 v[112:113], v[112:113], v[120:121]
  v_pk_mul_f32 v[114:115], v[114:115], v[122:123]
  v_pk_add_f32 v[24:25], v[24:25], 1.0 op_sel_hi:[1,0]
  v_pk_add_f32 v[26:27], v[26:27], 1.0 op_sel_hi:[1,0]
  v_rcp_f32 v24, v24
  v_rcp_f32 v25, v25
  v_rcp_f32 v26, v26
  v_rcp_f32 v27, v27
  v_pk_mul_f32 v[112:113], v[112:113], v[24:25]
  v_pk_mul_f32 v[114:115], v[114:115], v[26:27]
  v_cvt_pk_bf16_f32 v80, v112, v113
  v_cvt_pk_bf16_f32 v81, v114, v115
  v_pk_mul_f32 v[24:25], v[116:117], v[116:117]
  v_pk_mul_f32 v[26:27], v[118:119], v[118:119]
  v_pk_fma_f32 v[24:25], v[24:25], s[42:43], v[22:23] op_sel_hi:[1,0,0]
  v_pk_fma_f32 v[26:27], v[26:27], s[42:43], v[22:23] op_sel_hi:[1,0,0]
  v_pk_mul_f32 v[24:25], v[24:25], v[116:117]
  v_pk_mul_f32 v[26:27], v[26:27], v[118:119]
  v_exp_f32 v24, v24
  v_exp_f32 v25, v25
  v_exp_f32 v26, v26
  v_exp_f32 v27, v27
  v_pk_mul_f32 v[116:117], v[116:117], v[124:125]
  v_pk_mul_f32 v[118:119], v[118:119], v[126:127]
  v_pk_add_f32 v[24:25], v[24:25], 1.0 op_sel_hi:[1,0]
  v_pk_add_f32 v[26:27], v[26:27], 1.0 op_sel_hi:[1,0]
  v_rcp_f32 v24, v24
  v_rcp_f32 v25, v25
  v_rcp_f32 v26, v26
  v_rcp_f32 v27, v27
  v_pk_mul_f32 v[116:117], v[116:117], v[24:25]
  v_pk_mul_f32 v[118:119], v[118:119], v[26:27]
  v_cvt_pk_bf16_f32 v82, v116, v117
  v_cvt_pk_bf16_f32 v83, v118, v119
  s_waitcnt lgkmcnt(6)
  v_mfma_f32_32x32x16_bf16 v[160:175], v[32:35], v[76:79], v[160:175]
  ds_read_b64_tr_b16 v[48:49], v16 offset:9664
  ds_read_b64_tr_b16 v[50:51], v16 offset:11968
  v_pk_mul_f32 v[24:25], v[128:129], v[128:129]
  v_pk_mul_f32 v[26:27], v[130:131], v[130:131]
  v_pk_fma_f32 v[24:25], v[24:25], s[42:43], v[22:23] op_sel_hi:[1,0,0]
  v_pk_fma_f32 v[26:27], v[26:27], s[42:43], v[22:23] op_sel_hi:[1,0,0]
  v_pk_mul_f32 v[24:25], v[24:25], v[128:129]
  v_pk_mul_f32 v[26:27], v[26:27], v[130:131]
  v_exp_f32 v24, v24
  v_exp_f32 v25, v25
  v_exp_f32 v26, v26
  v_exp_f32 v27, v27
  v_pk_mul_f32 v[128:129], v[128:129], v[136:137]
  v_pk_mul_f32 v[130:131], v[130:131], v[138:139]
  v_pk_add_f32 v[24:25], v[24:25], 1.0 op_sel_hi:[1,0]
  v_pk_add_f32 v[26:27], v[26:27], 1.0 op_sel_hi:[1,0]
  v_rcp_f32 v24, v24
  v_rcp_f32 v25, v25
  v_rcp_f32 v26, v26
  v_rcp_f32 v27, v27
  v_pk_mul_f32 v[128:129], v[128:129], v[24:25]
  v_pk_mul_f32 v[130:131], v[130:131], v[26:27]
  v_cvt_pk_bf16_f32 v84, v128, v129
  v_cvt_pk_bf16_f32 v85, v130, v131
  v_pk_mul_f32 v[24:25], v[132:133], v[132:133]
  v_pk_mul_f32 v[26:27], v[134:135], v[134:135]
  v_pk_fma_f32 v[24:25], v[24:25], s[42:43], v[22:23] op_sel_hi:[1,0,0]
  v_pk_fma_f32 v[26:27], v[26:27], s[42:43], v[22:23] op_sel_hi:[1,0,0]
  v_pk_mul_f32 v[24:25], v[24:25], v[132:133]
  v_pk_mul_f32 v[26:27], v[26:27], v[134:135]
  v_exp_f32 v24, v24
  v_exp_f32 v25, v25
  v_exp_f32 v26, v26
  v_exp_f32 v27, v27
  v_pk_mul_f32 v[132:133], v[132:133], v[140:141]
  v_pk_mul_f32 v[134:135], v[134:135], v[142:143]
  v_pk_add_f32 v[24:25], v[24:25], 1.0 op_sel_hi:[1,0]
  v_pk_add_f32 v[26:27], v[26:27], 1.0 op_sel_hi:[1,0]
  v_rcp_f32 v24, v24
  v_rcp_f32 v25, v25
  v_rcp_f32 v26, v26
  v_rcp_f32 v27, v27
  v_pk_mul_f32 v[132:133], v[132:133], v[24:25]
  v_pk_mul_f32 v[134:135], v[134:135], v[26:27]
  v_cvt_pk_bf16_f32 v86, v132, v133
  v_cvt_pk_bf16_f32 v87, v134, v135
  s_waitcnt lgkmcnt(6)
  v_mfma_f32_32x32x16_bf16 v[176:191], v[36:39], v[76:79], v[176:191]
  ds_read_b64_tr_b16 v[52:53], v16 offset:9728
  ds_read_b64_tr_b16 v[54:55], v16 offset:12032
  v_pk_mul_f32 v[24:25], v[144:145], v[144:145]
  v_pk_mul_f32 v[26:27], v[146:147], v[146:147]
  v_pk_fma_f32 v[24:25], v[24:25], s[42:43], v[22:23] op_sel_hi:[1,0,0]
  v_pk_fma_f32 v[26:27], v[26:27], s[42:43], v[22:23] op_sel_hi:[1,0,0]
  v_pk_mul_f32 v[24:25], v[24:25], v[144:145]
  v_pk_mul_f32 v[26:27], v[26:27], v[146:147]
  v_exp_f32 v24, v24
  v_exp_f32 v25, v25
  v_exp_f32 v26, v26
  v_exp_f32 v27, v27
  v_pk_mul_f32 v[144:145], v[144:145], v[152:153]
  v_pk_mul_f32 v[146:147], v[146:147], v[154:155]
  v_pk_add_f32 v[24:25], v[24:25], 1.0 op_sel_hi:[1,0]
  v_pk_add_f32 v[26:27], v[26:27], 1.0 op_sel_hi:[1,0]
  v_rcp_f32 v24, v24
  v_rcp_f32 v25, v25
  v_rcp_f32 v26, v26
  v_rcp_f32 v27, v27
  v_pk_mul_f32 v[144:145], v[144:145], v[24:25]
  v_pk_mul_f32 v[146:147], v[146:147], v[26:27]
  v_cvt_pk_bf16_f32 v88, v144, v145
  v_cvt_pk_bf16_f32 v89, v146, v147
  v_pk_mul_f32 v[24:25], v[148:149], v[148:149]
  v_pk_mul_f32 v[26:27], v[150:151], v[150:151]
  v_pk_fma_f32 v[24:25], v[24:25], s[42:43], v[22:23] op_sel_hi:[1,0,0]
  v_pk_fma_f32 v[26:27], v[26:27], s[42:43], v[22:23] op_sel_hi:[1,0,0]
  v_pk_mul_f32 v[24:25], v[24:25], v[148:149]
  v_pk_mul_f32 v[26:27], v[26:27], v[150:151]
  v_exp_f32 v24, v24
  v_exp_f32 v25, v25
  v_exp_f32 v26, v26
  v_exp_f32 v27, v27
  v_pk_mul_f32 v[148:149], v[148:149], v[156:157]
  v_pk_mul_f32 v[150:151], v[150:151], v[158:159]
  v_pk_add_f32 v[24:25], v[24:25], 1.0 op_sel_hi:[1,0]
  v_pk_add_f32 v[26:27], v[26:27], 1.0 op_sel_hi:[1,0]
  v_rcp_f32 v24, v24
  v_rcp_f32 v25, v25
  v_rcp_f32 v26, v26
  v_rcp_f32 v27, v27
  v_pk_mul_f32 v[148:149], v[148:149], v[24:25]
  v_pk_mul_f32 v[150:151], v[150:151], v[26:27]
  v_cvt_pk_bf16_f32 v90, v148, v149
  v_cvt_pk_bf16_f32 v91, v150, v151
  s_waitcnt lgkmcnt(6)
  v_mfma_f32_32x32x16_bf16 v[192:207], v[40:43], v[76:79], v[192:207]
  v_pk_mul_f32 v[24:25], v[160:161], v[160:161]
  v_pk_mul_f32 v[26:27], v[162:163], v[162:163]
  v_pk_fma_f32 v[24:25], v[24:25], s[42:43], v[22:23] op_sel_hi:[1,0,0]
  v_pk_fma_f32 v[26:27], v[26:27], s[42:43], v[22:23] op_sel_hi:[1,0,0]
  v_pk_mul_f32 v[24:25], v[24:25], v[160:161]
  v_pk_mul_f32 v[26:27], v[26:27], v[162:163]
  v_exp_f32 v24, v24
  v_exp_f32 v25, v25
  v_exp_f32 v26, v26
  v_exp_f32 v27, v27
  v_pk_mul_f32 v[160:161], v[160:161], v[168:169]
  v_pk_mul_f32 v[162:163], v[162:163], v[170:171]
  v_pk_add_f32 v[24:25], v[24:25], 1.0 op_sel_hi:[1,0]
  v_pk_add_f32 v[26:27], v[26:27], 1.0 op_sel_hi:[1,0]
  v_rcp_f32 v24, v24
  v_rcp_f32 v25, v25
  v_rcp_f32 v26, v26
  v_rcp_f32 v27, v27
  v_pk_mul_f32 v[160:161], v[160:161], v[24:25]
  v_pk_mul_f32 v[162:163], v[162:163], v[26:27]
  v_cvt_pk_bf16_f32 v92, v160, v161
  v_cvt_pk_bf16_f32 v93, v162, v163
  v_pk_mul_f32 v[24:25], v[164:165], v[164:165]
  v_pk_mul_f32 v[26:27], v[166:167], v[166:167]
  v_pk_fma_f32 v[24:25], v[24:25], s[42:43], v[22:23] op_sel_hi:[1,0,0]
  v_pk_fma_f32 v[26:27], v[26:27], s[42:43], v[22:23] op_sel_hi:[1,0,0]
  v_pk_mul_f32 v[24:25], v[24:25], v[164:165]
  v_pk_mul_f32 v[26:27], v[26:27], v[166:167]
  v_exp_f32 v24, v24
  v_exp_f32 v25, v25
  v_exp_f32 v26, v26
  v_exp_f32 v27, v27
  v_pk_mul_f32 v[164:165], v[164:165], v[172:173]
  v_pk_mul_f32 v[166:167], v[166:167], v[174:175]
  v_pk_add_f32 v[24:25], v[24:25], 1.0 op_sel_hi:[1,0]
  v_pk_add_f32 v[26:27], v[26:27], 1.0 op_sel_hi:[1,0]
  v_rcp_f32 v24, v24
  v_rcp_f32 v25, v25
  v_rcp_f32 v26, v26
  v_rcp_f32 v27, v27
  v_pk_mul_f32 v[164:165], v[164:165], v[24:25]
  v_pk_mul_f32 v[166:167], v[166:167], v[26:27]
  v_cvt_pk_bf16_f32 v94, v164, v165
  v_cvt_pk_bf16_f32 v95, v166, v167
  s_waitcnt lgkmcnt(0)
  s_barrier
  ds_write_b128 v20, v[80:83] offset:0
  ds_write_b128 v20, v[84:87] offset:1024
  ds_write_b128 v20, v[88:91] offset:2048
  ds_write_b128 v20, v[92:95] offset:3072
  v_mfma_f32_32x32x16_bf16 v[208:223], v[44:47], v[76:79], v[208:223]
  v_pk_mul_f32 v[24:25], v[176:177], v[176:177]
  v_pk_mul_f32 v[26:27], v[178:179], v[178:179]
  v_pk_fma_f32 v[24:25], v[24:25], s[42:43], v[22:23] op_sel_hi:[1,0,0]
  v_pk_fma_f32 v[26:27], v[26:27], s[42:43], v[22:23] op_sel_hi:[1,0,0]
  v_pk_mul_f32 v[24:25], v[24:25], v[176:177]
  v_pk_mul_f32 v[26:27], v[26:27], v[178:179]
  v_exp_f32 v24, v24
  v_exp_f32 v25, v25
  v_exp_f32 v26, v26
  v_exp_f32 v27, v27
  v_pk_mul_f32 v[176:177], v[176:177], v[184:185]
  v_pk_mul_f32 v[178:179], v[178:179], v[186:187]
  v_pk_add_f32 v[24:25], v[24:25], 1.0 op_sel_hi:[1,0]
  v_pk_add_f32 v[26:27], v[26:27], 1.0 op_sel_hi:[1,0]
  v_rcp_f32 v24, v24
  v_rcp_f32 v25, v25
  v_rcp_f32 v26, v26
  v_rcp_f32 v27, v27
  v_pk_mul_f32 v[176:177], v[176:177], v[24:25]
  v_pk_mul_f32 v[178:179], v[178:179], v[26:27]
  v_cvt_pk_bf16_f32 v96, v176, v177
  v_cvt_pk_bf16_f32 v97, v178, v179
  v_pk_mul_f32 v[24:25], v[180:181], v[180:181]
  v_pk_mul_f32 v[26:27], v[182:183], v[182:183]
  v_pk_fma_f32 v[24:25], v[24:25], s[42:43], v[22:23] op_sel_hi:[1,0,0]
  v_pk_fma_f32 v[26:27], v[26:27], s[42:43], v[22:23] op_sel_hi:[1,0,0]
  v_pk_mul_f32 v[24:25], v[24:25], v[180:181]
  v_pk_mul_f32 v[26:27], v[26:27], v[182:183]
  v_exp_f32 v24, v24
  v_exp_f32 v25, v25
  v_exp_f32 v26, v26
  v_exp_f32 v27, v27
  v_pk_mul_f32 v[180:181], v[180:181], v[188:189]
  v_pk_mul_f32 v[182:183], v[182:183], v[190:191]
  v_pk_add_f32 v[24:25], v[24:25], 1.0 op_sel_hi:[1,0]
  v_pk_add_f32 v[26:27], v[26:27], 1.0 op_sel_hi:[1,0]
  v_rcp_f32 v24, v24
  v_rcp_f32 v25, v25
  v_rcp_f32 v26, v26
  v_rcp_f32 v27, v27
  v_pk_mul_f32 v[180:181], v[180:181], v[24:25]
  v_pk_mul_f32 v[182:183], v[182:183], v[26:27]
  v_cvt_pk_bf16_f32 v98, v180, v181
  v_cvt_pk_bf16_f32 v99, v182, v183
  ds_write_b128 v20, v[96:99] offset:4096
  v_mfma_f32_32x32x16_bf16 v[224:239], v[48:51], v[76:79], v[224:239]
  v_pk_mul_f32 v[24:25], v[192:193], v[192:193]
  v_pk_mul_f32 v[26:27], v[194:195], v[194:195]
  v_pk_fma_f32 v[24:25], v[24:25], s[42:43], v[22:23] op_sel_hi:[1,0,0]
  v_pk_fma_f32 v[26:27], v[26:27], s[42:43], v[22:23] op_sel_hi:[1,0,0]
  v_pk_mul_f32 v[24:25], v[24:25], v[192:193]
  v_pk_mul_f32 v[26:27], v[26:27], v[194:195]
  v_exp_f32 v24, v24
  v_exp_f32 v25, v25
  v_exp_f32 v26, v26
  v_exp_f32 v27, v27
  v_pk_mul_f32 v[192:193], v[192:193], v[200:201]
  v_pk_mul_f32 v[194:195], v[194:195], v[202:203]
  v_pk_add_f32 v[24:25], v[24:25], 1.0 op_sel_hi:[1,0]
  v_pk_add_f32 v[26:27], v[26:27], 1.0 op_sel_hi:[1,0]
  v_rcp_f32 v24, v24
  v_rcp_f32 v25, v25
  v_rcp_f32 v26, v26
  v_rcp_f32 v27, v27
  v_pk_mul_f32 v[192:193], v[192:193], v[24:25]
  v_pk_mul_f32 v[194:195], v[194:195], v[26:27]
  v_cvt_pk_bf16_f32 v100, v192, v193
  v_cvt_pk_bf16_f32 v101, v194, v195
  v_pk_mul_f32 v[24:25], v[196:197], v[196:197]
  v_pk_mul_f32 v[26:27], v[198:199], v[198:199]
  v_pk_fma_f32 v[24:25], v[24:25], s[42:43], v[22:23] op_sel_hi:[1,0,0]
  v_pk_fma_f32 v[26:27], v[26:27], s[42:43], v[22:23] op_sel_hi:[1,0,0]
  v_pk_mul_f32 v[24:25], v[24:25], v[196:197]
  v_pk_mul_f32 v[26:27], v[26:27], v[198:199]
  v_exp_f32 v24, v24
  v_exp_f32 v25, v25
  v_exp_f32 v26, v26
  v_exp_f32 v27, v27
  v_pk_mul_f32 v[196:197], v[196:197], v[204:205]
  v_pk_mul_f32 v[198:199], v[198:199], v[206:207]
  v_pk_add_f32 v[24:25], v[24:25], 1.0 op_sel_hi:[1,0]
  v_pk_add_f32 v[26:27], v[26:27], 1.0 op_sel_hi:[1,0]
  v_rcp_f32 v24, v24
  v_rcp_f32 v25, v25
  v_rcp_f32 v26, v26
  v_rcp_f32 v27, v27
  v_pk_mul_f32 v[196:197], v[196:197], v[24:25]
  v_pk_mul_f32 v[198:199], v[198:199], v[26:27]
  v_cvt_pk_bf16_f32 v102, v196, v197
  v_cvt_pk_bf16_f32 v103, v198, v199
  ds_write_b128 v20, v[100:103] offset:5120
  v_mfma_f32_32x32x16_bf16 v[240:255], v[52:55], v[76:79], v[240:255]
  v_pk_mul_f32 v[24:25], v[208:209], v[208:209]
  v_pk_mul_f32 v[26:27], v[210:211], v[210:211]
  v_pk_fma_f32 v[24:25], v[24:25], s[42:43], v[22:23] op_sel_hi:[1,0,0]
  v_pk_fma_f32 v[26:27], v[26:27], s[42:43], v[22:23] op_sel_hi:[1,0,0]
  v_pk_mul_f32 v[24:25], v[24:25], v[208:209]
  v_pk_mul_f32 v[26:27], v[26:27], v[210:211]
  v_exp_f32 v24, v24
  v_exp_f32 v25, v25
  v_exp_f32 v26, v26
  v_exp_f32 v27, v27
  v_pk_mul_f32 v[208:209], v[208:209], v[216:217]
  v_pk_mul_f32 v[210:211], v[210:211], v[218:219]
  v_pk_add_f32 v[24:25], v[24:25], 1.0 op_sel_hi:[1,0]
  v_pk_add_f32 v[26:27], v[26:27], 1.0 op_sel_hi:[1,0]
  v_rcp_f32 v24, v24
  v_rcp_f32 v25, v25
  v_rcp_f32 v26, v26
  v_rcp_f32 v27, v27
  v_pk_mul_f32 v[208:209], v[208:209], v[24:25]
  v_pk_mul_f32 v[210:211], v[210:211], v[26:27]
  v_cvt_pk_bf16_f32 v104, v208, v209
  v_cvt_pk_bf16_f32 v105, v210, v211
  v_pk_mul_f32 v[24:25], v[212:213], v[212:213]
  v_pk_mul_f32 v[26:27], v[214:215], v[214:215]
  v_pk_fma_f32 v[24:25], v[24:25], s[42:43], v[22:23] op_sel_hi:[1,0,0]
  v_pk_fma_f32 v[26:27], v[26:27], s[42:43], v[22:23] op_sel_hi:[1,0,0]
  v_pk_mul_f32 v[24:25], v[24:25], v[212:213]
  v_pk_mul_f32 v[26:27], v[26:27], v[214:215]
  v_exp_f32 v24, v24
  v_exp_f32 v25, v25
  v_exp_f32 v26, v26
  v_exp_f32 v27, v27
  v_pk_mul_f32 v[212:213], v[212:213], v[220:221]
  v_pk_mul_f32 v[214:215], v[214:215], v[222:223]
  v_pk_add_f32 v[24:25], v[24:25], 1.0 op_sel_hi:[1,0]
  v_pk_add_f32 v[26:27], v[26:27], 1.0 op_sel_hi:[1,0]
  v_rcp_f32 v24, v24
  v_rcp_f32 v25, v25
  v_rcp_f32 v26, v26
  v_rcp_f32 v27, v27
  v_pk_mul_f32 v[212:213], v[212:213], v[24:25]
  v_pk_mul_f32 v[214:215], v[214:215], v[26:27]
  v_cvt_pk_bf16_f32 v106, v212, v213
  v_cvt_pk_bf16_f32 v107, v214, v215
  ds_write_b128 v20, v[104:107] offset:6144
  v_pk_mul_f32 v[24:25], v[224:225], v[224:225]
  v_pk_mul_f32 v[26:27], v[226:227], v[226:227]
  v_pk_fma_f32 v[24:25], v[24:25], s[42:43], v[22:23] op_sel_hi:[1,0,0]
  v_pk_fma_f32 v[26:27], v[26:27], s[42:43], v[22:23] op_sel_hi:[1,0,0]
  v_pk_mul_f32 v[24:25], v[24:25], v[224:225]
  v_pk_mul_f32 v[26:27], v[26:27], v[226:227]
  v_exp_f32 v24, v24
  v_exp_f32 v25, v25
  v_exp_f32 v26, v26
  v_exp_f32 v27, v27
  v_pk_mul_f32 v[224:225], v[224:225], v[232:233]
  v_pk_mul_f32 v[226:227], v[226:227], v[234:235]
  v_pk_add_f32 v[24:25], v[24:25], 1.0 op_sel_hi:[1,0]
  v_pk_add_f32 v[26:27], v[26:27], 1.0 op_sel_hi:[1,0]
  v_rcp_f32 v24, v24
  v_rcp_f32 v25, v25
  v_rcp_f32 v26, v26
  v_rcp_f32 v27, v27
  v_pk_mul_f32 v[224:225], v[224:225], v[24:25]
  v_pk_mul_f32 v[226:227], v[226:227], v[26:27]
  v_cvt_pk_bf16_f32 v64, v224, v225
  v_cvt_pk_bf16_f32 v65, v226, v227
  v_pk_mul_f32 v[24:25], v[228:229], v[228:229]
  v_pk_mul_f32 v[26:27], v[230:231], v[230:231]
  v_pk_fma_f32 v[24:25], v[24:25], s[42:43], v[22:23] op_sel_hi:[1,0,0]
  v_pk_fma_f32 v[26:27], v[26:27], s[42:43], v[22:23] op_sel_hi:[1,0,0]
  v_pk_mul_f32 v[24:25], v[24:25], v[228:229]
  v_pk_mul_f32 v[26:27], v[26:27], v[230:231]
  v_exp_f32 v24, v24
  v_exp_f32 v25, v25
  v_exp_f32 v26, v26
  v_exp_f32 v27, v27
  v_pk_mul_f32 v[228:229], v[228:229], v[236:237]
  v_pk_mul_f32 v[230:231], v[230:231], v[238:239]
  v_pk_add_f32 v[24:25], v[24:25], 1.0 op_sel_hi:[1,0]
  v_pk_add_f32 v[26:27], v[26:27], 1.0 op_sel_hi:[1,0]
  v_rcp_f32 v24, v24
  v_rcp_f32 v25, v25
  v_rcp_f32 v26, v26
  v_rcp_f32 v27, v27
  v_pk_mul_f32 v[228:229], v[228:229], v[24:25]
  v_pk_mul_f32 v[230:231], v[230:231], v[26:27]
  v_cvt_pk_bf16_f32 v66, v228, v229
  v_cvt_pk_bf16_f32 v67, v230, v231
  ds_write_b128 v20, v[64:67] offset:7168
  v_pk_mul_f32 v[24:25], v[240:241], v[240:241]
  v_pk_mul_f32 v[26:27], v[242:243], v[242:243]
  v_pk_fma_f32 v[24:25], v[24:25], s[42:43], v[22:23] op_sel_hi:[1,0,0]
  v_pk_fma_f32 v[26:27], v[26:27], s[42:43], v[22:23] op_sel_hi:[1,0,0]
  v_pk_mul_f32 v[24:25], v[24:25], v[240:241]
  v_pk_mul_f32 v[26:27], v[26:27], v[242:243]
  v_exp_f32 v24, v24
  v_exp_f32 v25, v25
  v_exp_f32 v26, v26
  v_exp_f32 v27, v27
  v_pk_mul_f32 v[240:241], v[240:241], v[248:249]
  v_pk_mul_f32 v[242:243], v[242:243], v[250:251]
  v_pk_add_f32 v[24:25], v[24:25], 1.0 op_sel_hi:[1,0]
  v_pk_add_f32 v[26:27], v[26:27], 1.0 op_sel_hi:[1,0]
  v_rcp_f32 v24, v24
  v_rcp_f32 v25, v25
  v_rcp_f32 v26, v26
  v_rcp_f32 v27, v27
  v_pk_mul_f32 v[240:241], v[240:241], v[24:25]
  v_pk_mul_f32 v[242:243], v[242:243], v[26:27]
  v_cvt_pk_bf16_f32 v68, v240, v241
  v_cvt_pk_bf16_f32 v69, v242, v243
  v_pk_mul_f32 v[24:25], v[244:245], v[244:245]
  v_pk_mul_f32 v[26:27], v[246:247], v[246:247]
  v_pk_fma_f32 v[24:25], v[24:25], s[42:43], v[22:23] op_sel_hi:[1,0,0]
  v_pk_fma_f32 v[26:27], v[26:27], s[42:43], v[22:23] op_sel_hi:[1,0,0]
  v_pk_mul_f32 v[24:25], v[24:25], v[244:245]
  v_pk_mul_f32 v[26:27], v[26:27], v[246:247]
  v_exp_f32 v24, v24
  v_exp_f32 v25, v25
  v_exp_f32 v26, v26
  v_exp_f32 v27, v27
  v_pk_mul_f32 v[244:245], v[244:245], v[252:253]
  v_pk_mul_f32 v[246:247], v[246:247], v[254:255]
  v_pk_add_f32 v[24:25], v[24:25], 1.0 op_sel_hi:[1,0]
  v_pk_add_f32 v[26:27], v[26:27], 1.0 op_sel_hi:[1,0]
  v_rcp_f32 v24, v24
  v_rcp_f32 v25, v25
  v_rcp_f32 v26, v26
  v_rcp_f32 v27, v27
  v_pk_mul_f32 v[244:245], v[244:245], v[24:25]
  v_pk_mul_f32 v[246:247], v[246:247], v[26:27]
  v_cvt_pk_bf16_f32 v70, v244, v245
  v_cvt_pk_bf16_f32 v71, v246, v247
  ds_write_b128 v20, v[68:71] offset:8192
  s_waitcnt vmcnt(5)
  s_waitcnt lgkmcnt(0)
  s_barrier
  ds_read_b64_tr_b16 v[32:33], v17 offset:0
  ds_read_b64_tr_b16 v[34:35], v17 offset:1024
  ds_read_b64_tr_b16 v[36:37], v17 offset:4096
  ds_read_b64_tr_b16 v[38:39], v17 offset:5120
  ds_read_b64_tr_b16 v[40:41], v17 offset:8192
  ds_read_b64_tr_b16 v[42:43], v17 offset:9216
  ds_read_b64_tr_b16 v[44:45], v17 offset:12288
  ds_read_b64_tr_b16 v[46:47], v17 offset:13312
  s_waitcnt lgkmcnt(6)
  v_mfma_f32_32x32x16_bf16 v[160:175], v[32:35], v[80:83], 0
  ds_read_b64_tr_b16 v[48:49], v17 offset:16384
  ds_read_b64_tr_b16 v[50:51], v17 offset:17408
  ds_read_b128 v[112:115], v21 offset:0
  ds_read_b128 v[116:119], v21 offset:1024
  ds_read_b128 v[120:123], v21 offset:2048
  ds_read_b128 v[124:127], v21 offset:3072
  ds_read_b128 v[128:131], v21 offset:4096
  ds_read_b128 v[132:135], v21 offset:5120
  ds_read_b128 v[136:139], v21 offset:6144
  ds_read_b128 v[140:143], v21 offset:7168
  ds_read_b128 v[144:147], v21 offset:8192
  s_waitcnt lgkmcnt(15)
  v_mfma_f32_32x32x16_bf16 v[160:175], v[36:39], v[84:87], v[160:175]
  ds_read_b64_tr_b16 v[52:53], v17 offset:20480
  ds_read_b64_tr_b16 v[54:55], v17 offset:21504
  s_waitcnt lgkmcnt(15)
  v_mfma_f32_32x32x16_bf16 v[160:175], v[40:43], v[88:91], v[160:175]
  ds_read_b64_tr_b16 v[32:33], v17 offset:24576
  ds_read_b64_tr_b16 v[34:35], v17 offset:25600
  s_waitcnt lgkmcnt(15)
  v_mfma_f32_32x32x16_bf16 v[160:175], v[44:47], v[92:95], v[160:175]
  ds_read_b64_tr_b16 v[36:37], v17 offset:28672
  ds_read_b64_tr_b16 v[38:39], v17 offset:29696
  s_waitcnt lgkmcnt(15)
  v_mfma_f32_32x32x16_bf16 v[160:175], v[48:51], v[96:99], v[160:175]
  ds_read_b64_tr_b16 v[40:41], v17 offset:32768
  ds_read_b64_tr_b16 v[42:43], v17 offset:33792
  s_waitcnt lgkmcnt(6)
  v_mfma_f32_32x32x16_bf16 v[160:175], v[52:55], v[100:103], v[160:175]
  ds_read_b64_tr_b16 v[44:45], v18 offset:0
  ds_read_b64_tr_b16 v[46:47], v18 offset:1024
  s_barrier
  s_add_u32 m0, s30, 0
  s_add_u32 s38, s36, 256
  buffer_load_dwordx4 v19, s[16:19], s38 offen lds
  s_waitcnt lgkmcnt(6)
  v_mfma_f32_32x32x16_bf16 v[160:175], v[32:35], v[104:107], v[160:175]
  ds_read_b64_tr_b16 v[48:49], v18 offset:4096
  ds_read_b64_tr_b16 v[50:51], v18 offset:5120
  s_add_u32 m0, s30, 1024
  s_add_u32 s38, s36, 9472
  buffer_load_dwordx4 v19, s[16:19], s38 offen lds
  s_waitcnt lgkmcnt(6)
  v_mfma_f32_32x32x16_bf16 v[160:175], v[36:39], v[64:67], v[160:175]
  ds_read_b64_tr_b16 v[52:53], v18 offset:8192
  ds_read_b64_tr_b16 v[54:55], v18 offset:9216
  s_add_u32 m0, s30, 2048
  s_add_u32 s38, s36, 18688
  buffer_load_dwordx4 v19, s[16:19], s38 offen lds
  s_waitcnt lgkmcnt(6)
  v_mfma_f32_32x32x16_bf16 v[160:175], v[40:43], v[68:71], v[160:175]
  ds_read_b64_tr_b16 v[32:33], v18 offset:12288
  ds_read_b64_tr_b16 v[34:35], v18 offset:13312
  s_add_u32 m0, s30, 3072
  s_add_u32 s38, s36, 27904
  buffer_load_dwordx4 v19, s[16:19], s38 offen lds
  s_waitcnt lgkmcnt(6)
  v_mfma_f32_32x32x16_bf16 v[160:175], v[44:47], v[112:115], v[160:175]
  ds_read_b64_tr_b16 v[36:37], v18 offset:16384
  ds_read_b64_tr_b16 v[38:39], v18 offset:17408
  s_add_u32 m0, s30, 4096
  s_add_u32 s38, s36, 37120
  s_mov_b32 exec_hi, 0
  buffer_load_dwordx4 v19, s[16:19], s38 offen lds
  s_mov_b32 exec_hi, -1
  s_waitcnt lgkmcnt(6)
  v_mfma_f32_32x32x16_bf16 v[160:175], v[48:51], v[116:119], v[160:175]
  ds_read_b64_tr_b16 v[40:41], v18 offset:20480
  ds_read_b64_tr_b16 v[42:43], v18 offset:21504
  s_add_u32 m0, s30, 36864
  s_add_u32 s38, s36, 384
  buffer_load_dwordx4 v19, s[16:19], s38 offen lds
  s_waitcnt lgkmcnt(6)
  v_mfma_f32_32x32x16_bf16 v[160:175], v[52:55], v[120:123], v[160:175]
  ds_read_b64_tr_b16 v[44:45], v18 offset:24576
  ds_read_b64_tr_b16 v[46:47], v18 offset:25600
  s_add_u32 m0, s30, 37888
  s_add_u32 s38, s36, 9600
  buffer_load_dwordx4 v19, s[16:19], s38 offen lds
  s_waitcnt lgkmcnt(6)
  v_mfma_f32_32x32x16_bf16 v[160:175], v[32:35], v[124:127], v[160:175]
  ds_read_b64_tr_b16 v[48:49], v18 offset:28672
  ds_read_b64_tr_b16 v[50:51], v18 offset:29696
  s_add_u32 m0, s30, 38912
  s_add_u32 s38, s36, 18816
  buffer_load_dwordx4 v19, s[16:19], s38 offen lds
  s_waitcnt lgkmcnt(6)
  v_mfma_f32_32x32x16_bf16 v[160:175], v[36:39], v[128:131], v[160:175]
  ds_read_b64_tr_b16 v[52:53], v18 offset:32768
  ds_read_b64_tr_b16 v[54:55], v18 offset:33792
  s_add_u32 m0, s30, 39936
  s_add_u32 s38, s36, 28032
  buffer_load_dwordx4 v19, s[16:19], s38 offen lds
  s_waitcnt lgkmcnt(6)
  v_mfma_f32_32x32x16_bf16 v[160:175], v[40:43], v[132:135], v[160:175]
  s_waitcnt vmcnt(9)
  s_waitcnt lgkmcnt(0)
  s_barrier
  v_add_u32 v17, 36864, v17
  v_add_u32 v18, 36864, v18
  ds_read_b64_tr_b16 v[32:33], v17 offset:0
  ds_read_b64_tr_b16 v[34:35], v17 offset:1024
  s_add_u32 m0, s30, 40960
  s_add_u32 s38, s36, 37248
  s_mov_b32 exec_hi, 0
  buffer_load_dwordx4 v19, s[16:19], s38 offen lds
  s_mov_b32 exec_hi, -1
  v_mfma_f32_32x32x16_bf16 v[160:175], v[44:47], v[136:139], v[160:175]
  ds_read_b64_tr_b16 v[36:37], v17 offset:4096
  ds_read_b64_tr_b16 v[38:39], v17 offset:5120
  s_add_u32 m0, s30, 73728
  s_add_u32 s38, s36, 512
  buffer_load_dwordx4 v19, s[16:19], s38 offen lds
  v_mfma_f32_32x32x16_bf16 v[160:175], v[48:51], v[140:143], v[160:175]
  ds_read_b64_tr_b16 v[40:41], v17 offset:8192
  ds_read_b64_tr_b16 v[42:43], v17 offset:9216
  s_add_u32 m0, s30, 74752
  s_add_u32 s38, s36, 9728
  buffer_load_dwordx4 v19, s[16:19], s38 offen lds
  v_mfma_f32_32x32x16_bf16 v[160:175], v[52:55], v[144:147], v[160:175]
  ds_read_b64_tr_b16 v[44:45], v17 offset:12288
  ds_read_b64_tr_b16 v[46:47], v17 offset:13312
  s_add_u32 m0, s30, 75776
  s_add_u32 s38, s36, 18944
  buffer_load_dwordx4 v19, s[16:19], s38 offen lds
  s_waitcnt lgkmcnt(6)
  v_mfma_f32_32x32x16_bf16 v[176:191], v[32:35], v[80:83], 0
  ds_read_b64_tr_b16 v[48:49], v17 offset:16384
  ds_read_b64_tr_b16 v[50:51], v17 offset:17408
  s_add_u32 m0, s30, 76800
  s_add_u32 s38, s36, 28160
  buffer_load_dwordx4 v19, s[16:19], s38 offen lds
  s_waitcnt lgkmcnt(6)
  v_mfma_f32_32x32x16_bf16 v[176:191], v[36:39], v[84:87], v[176:191]
  ds_read_b64_tr_b16 v[52:53], v17 offset:20480
  ds_read_b64_tr_b16 v[54:55], v17 offset:21504
  s_waitcnt lgkmcnt(6)
  v_mfma_f32_32x32x16_bf16 v[176:191], v[40:43], v[88:91], v[176:191]
  ds_read_b64_tr_b16 v[32:33], v17 offset:24576
  ds_read_b64_tr_b16 v[34:35], v17 offset:25600
  s_add_u32 m0, s30, 77824
  s_add_u32 s38, s36, 37376
  s_mov_b32 exec_hi, 0
  buffer_load_dwordx4 v19, s[16:19], s38 offen lds
  s_mov_b32 exec_hi, -1
  s_waitcnt lgkmcnt(6)
  v_mfma_f32_32x32x16_bf16 v[176:191], v[44:47], v[92:95], v[176:191]
  ds_read_b64_tr_b16 v[36:37], v17 offset:28672
  ds_read_b64_tr_b16 v[38:39], v17 offset:29696
  v_cvt_pk_bf16_f32 v192, v160, v161
  v_cvt_pk_bf16_f32 v193, v162, v163
  s_waitcnt lgkmcnt(6)
  v_mfma_f32_32x32x16_bf16 v[176:191], v[48:51], v[96:99], v[176:191]
  ds_read_b64_tr_b16 v[40:41], v17 offset:32768
  ds_read_b64_tr_b16 v[42:43], v17 offset:33792
  v_cvt_pk_bf16_f32 v194, v164, v165
  v_cvt_pk_bf16_f32 v195, v166, v167
  s_waitcnt lgkmcnt(6)
  v_mfma_f32_32x32x16_bf16 v[176:191], v[52:55], v[100:103], v[176:191]
  ds_read_b64_tr_b16 v[44:45], v18 offset:0
  ds_read_b64_tr_b16 v[46:47], v18 offset:1024
  s_add_u32 s46, s33, 0
  buffer_store_dwordx4 v[192:195], v2, s[20:23], s46 offen sc1
  v_cvt_pk_bf16_f32 v196, v168, v169
  s_waitcnt lgkmcnt(6)
  v_mfma_f32_32x32x16_bf16 v[176:191], v[32:35], v[104:107], v[176:191]
  ds_read_b64_tr_b16 v[48:49], v18 offset:4096
  ds_read_b64_tr_b16 v[50:51], v18 offset:5120
  v_cvt_pk_bf16_f32 v197, v170, v171
  v_cvt_pk_bf16_f32 v198, v172, v173
  s_waitcnt lgkmcnt(6)
  v_mfma_f32_32x32x16_bf16 v[176:191], v[36:39], v[64:67], v[176:191]
  ds_read_b64_tr_b16 v[52:53], v18 offset:8192
  ds_read_b64_tr_b16 v[54:55], v18 offset:9216
  v_cvt_pk_bf16_f32 v199, v174, v175
  buffer_store_dwordx4 v[196:199], v2, s[20:23], s46 offen offset:256 sc1
  s_waitcnt lgkmcnt(6)
  v_mfma_f32_32x32x16_bf16 v[176:191], v[40:43], v[68:71], v[176:191]
  ds_read_b64_tr_b16 v[32:33], v18 offset:12288
  ds_read_b64_tr_b16 v[34:35], v18 offset:13312
  s_waitcnt lgkmcnt(6)
  v_mfma_f32_32x32x16_bf16 v[176:191], v[44:47], v[112:115], v[176:191]
  ds_read_b64_tr_b16 v[36:37], v18 offset:16384
  ds_read_b64_tr_b16 v[38:39], v18 offset:17408
  s_waitcnt lgkmcnt(6)
  v_mfma_f32_32x32x16_bf16 v[176:191], v[48:51], v[116:119], v[176:191]
  ds_read_b64_tr_b16 v[40:41], v18 offset:20480
  ds_read_b64_tr_b16 v[42:43], v18 offset:21504
  s_waitcnt lgkmcnt(6)
  v_mfma_f32_32x32x16_bf16 v[176:191], v[52:55], v[120:123], v[176:191]
  ds_read_b64_tr_b16 v[44:45], v18 offset:24576
  ds_read_b64_tr_b16 v[46:47], v18 offset:25600
  s_waitcnt lgkmcnt(6)
  v_mfma_f32_32x32x16_bf16 v[176:191], v[32:35], v[124:127], v[176:191]
  ds_read_b64_tr_b16 v[48:49], v18 offset:28672
  ds_read_b64_tr_b16 v[50:51], v18 offset:29696
  s_waitcnt lgkmcnt(6)
  v_mfma_f32_32x32x16_bf16 v[176:191], v[36:39], v[128:131], v[176:191]
  ds_read_b64_tr_b16 v[52:53], v18 offset:32768
  ds_read_b64_tr_b16 v[54:55], v18 offset:33792
  s_waitcnt lgkmcnt(6)
  v_mfma_f32_32x32x16_bf16 v[176:191], v[40:43], v[132:135], v[176:191]
  s_waitcnt vmcnt(12)
  s_waitcnt lgkmcnt(0)
  s_barrier
  v_add_u32 v17, 4294856704, v17
  v_add_u32 v18, 4294856704, v18
  ds_read_b64_tr_b16 v[32:33], v17 offset:0
  ds_read_b64_tr_b16 v[34:35], v17 offset:1024
  s_add_u32 m0, s30, 110592
  s_add_u32 s38, s36, 640
  buffer_load_dwordx4 v19, s[16:19], s38 offen lds
  v_mfma_f32_32x32x16_bf16 v[176:191], v[44:47], v[136:139], v[176:191]
  ds_read_b64_tr_b16 v[36:37], v17 offset:4096
  ds_read_b64_tr_b16 v[38:39], v17 offset:5120
  v_mfma_f32_32x32x16_bf16 v[176:191], v[48:51], v[140:143], v[176:191]
  ds_read_b64_tr_b16 v[40:41], v17 offset:8192
  ds_read_b64_tr_b16 v[42:43], v17 offset:9216
  s_add_u32 m0, s30, 111616
  s_add_u32 s38, s36, 9856
  buffer_load_dwordx4 v19, s[16:19], s38 offen lds
  v_mfma_f32_32x32x16_bf16 v[176:191], v[52:55], v[144:147], v[176:191]
  ds_read_b64_tr_b16 v[44:45], v17 offset:12288
  ds_read_b64_tr_b16 v[46:47], v17 offset:13312
  s_waitcnt lgkmcnt(6)
  v_mfma_f32_32x32x16_bf16 v[160:175], v[32:35], v[80:83], 0
  ds_read_b64_tr_b16 v[48:49], v17 offset:16384
  ds_read_b64_tr_b16 v[50:51], v17 offset:17408
  s_add_u32 m0, s30, 112640
  s_add_u32 s38, s36, 19072
  buffer_load_dwordx4 v19, s[16:19], s38 offen lds
  s_waitcnt lgkmcnt(6)
  v_mfma_f32_32x32x16_bf16 v[160:175], v[36:39], v[84:87], v[160:175]
  ds_read_b64_tr_b16 v[52:53], v17 offset:20480
  ds_read_b64_tr_b16 v[54:55], v17 offset:21504
  s_waitcnt lgkmcnt(6)
  v_mfma_f32_32x32x16_bf16 v[160:175], v[40:43], v[88:91], v[160:175]
  ds_read_b64_tr_b16 v[32:33], v17 offset:24576
  ds_read_b64_tr_b16 v[34:35], v17 offset:25600
  s_add_u32 m0, s30, 113664
  s_add_u32 s38, s36, 28288
  buffer_load_dwordx4 v19, s[16:19], s38 offen lds
  s_waitcnt lgkmcnt(6)
  v_mfma_f32_32x32x16_bf16 v[160:175], v[44:47], v[92:95], v[160:175]
  ds_read_b64_tr_b16 v[36:37], v17 offset:28672
  ds_read_b64_tr_b16 v[38:39], v17 offset:29696
  v_cvt_pk_bf16_f32 v200, v176, v177
  v_cvt_pk_bf16_f32 v201, v178, v179
  s_waitcnt lgkmcnt(6)
  v_mfma_f32_32x32x16_bf16 v[160:175], v[48:51], v[96:99], v[160:175]
  ds_read_b64_tr_b16 v[40:41], v17 offset:32768
  ds_read_b64_tr_b16 v[42:43], v17 offset:33792
  v_cvt_pk_bf16_f32 v202, v180, v181
  v_cvt_pk_bf16_f32 v203, v182, v183
  s_waitcnt lgkmcnt(6)
  v_mfma_f32_32x32x16_bf16 v[160:175], v[52:55], v[100:103], v[160:175]
  ds_read_b64_tr_b16 v[44:45], v18 offset:0
  ds_read_b64_tr_b16 v[46:47], v18 offset:1024
  s_add_u32 s46, s33, 1024
  buffer_store_dwordx4 v[200:203], v2, s[20:23], s46 offen sc1
  v_cvt_pk_bf16_f32 v204, v184, v185
  s_waitcnt lgkmcnt(6)
  v_mfma_f32_32x32x16_bf16 v[160:175], v[32:35], v[104:107], v[160:175]
  ds_read_b64_tr_b16 v[48:49], v18 offset:4096
  ds_read_b64_tr_b16 v[50:51], v18 offset:5120
  v_cvt_pk_bf16_f32 v205, v186, v187
  v_cvt_pk_bf16_f32 v206, v188, v189
  s_waitcnt lgkmcnt(6)
  v_mfma_f32_32x32x16_bf16 v[160:175], v[36:39], v[64:67], v[160:175]
  ds_read_b64_tr_b16 v[52:53], v18 offset:8192
  ds_read_b64_tr_b16 v[54:55], v18 offset:9216
  v_cvt_pk_bf16_f32 v207, v190, v191
  buffer_store_dwordx4 v[204:207], v2, s[20:23], s46 offen offset:256 sc1
  s_waitcnt lgkmcnt(6)
  v_mfma_f32_32x32x16_bf16 v[160:175], v[40:43], v[68:71], v[160:175]
  ds_read_b64_tr_b16 v[32:33], v18 offset:12288
  ds_read_b64_tr_b16 v[34:35], v18 offset:13312
  s_add_u32 m0, s30, 114688
  s_add_u32 s38, s36, 37504
  s_mov_b32 exec_hi, 0
  buffer_load_dwordx4 v19, s[16:19], s38 offen lds
  s_mov_b32 exec_hi, -1
  s_waitcnt lgkmcnt(6)
  v_mfma_f32_32x32x16_bf16 v[160:175], v[44:47], v[112:115], v[160:175]
  ds_read_b64_tr_b16 v[36:37], v18 offset:16384
  ds_read_b64_tr_b16 v[38:39], v18 offset:17408
  s_waitcnt lgkmcnt(6)
  v_mfma_f32_32x32x16_bf16 v[160:175], v[48:51], v[116:119], v[160:175]
  ds_read_b64_tr_b16 v[40:41], v18 offset:20480
  ds_read_b64_tr_b16 v[42:43], v18 offset:21504
  s_waitcnt lgkmcnt(6)
  v_mfma_f32_32x32x16_bf16 v[160:175], v[52:55], v[120:123], v[160:175]
  ds_read_b64_tr_b16 v[44:45], v18 offset:24576
  ds_read_b64_tr_b16 v[46:47], v18 offset:25600
  s_waitcnt lgkmcnt(6)
  v_mfma_f32_32x32x16_bf16 v[160:175], v[32:35], v[124:127], v[160:175]
  ds_read_b64_tr_b16 v[48:49], v18 offset:28672
  ds_read_b64_tr_b16 v[50:51], v18 offset:29696
  s_waitcnt lgkmcnt(6)
  v_mfma_f32_32x32x16_bf16 v[160:175], v[36:39], v[128:131], v[160:175]
  ds_read_b64_tr_b16 v[52:53], v18 offset:32768
  ds_read_b64_tr_b16 v[54:55], v18 offset:33792
  s_waitcnt lgkmcnt(6)
  v_mfma_f32_32x32x16_bf16 v[160:175], v[40:43], v[132:135], v[160:175]
  s_waitcnt vmcnt(14)
  s_waitcnt lgkmcnt(0)
  s_barrier
  v_add_u32 v17, 36864, v17
  v_add_u32 v18, 36864, v18
  ds_read_b64_tr_b16 v[32:33], v17 offset:0
  ds_read_b64_tr_b16 v[34:35], v17 offset:1024
  s_add_u32 m0, s30, 0
  s_add_u32 s38, s36, 768
  buffer_load_dwordx4 v19, s[16:19], s38 offen lds
  v_mfma_f32_32x32x16_bf16 v[160:175], v[44:47], v[136:139], v[160:175]
  ds_read_b64_tr_b16 v[36:37], v17 offset:4096
  ds_read_b64_tr_b16 v[38:39], v17 offset:5120
  v_mfma_f32_32x32x16_bf16 v[160:175], v[48:51], v[140:143], v[160:175]
  ds_read_b64_tr_b16 v[40:41], v17 offset:8192
  ds_read_b64_tr_b16 v[42:43], v17 offset:9216
  s_add_u32 m0, s30, 1024
  s_add_u32 s38, s36, 9984
  buffer_load_dwordx4 v19, s[16:19], s38 offen lds
  v_mfma_f32_32x32x16_bf16 v[160:175], v[52:55], v[144:147], v[160:175]
  ds_read_b64_tr_b16 v[44:45], v17 offset:12288
  ds_read_b64_tr_b16 v[46:47], v17 offset:13312
  s_waitcnt lgkmcnt(6)
  v_mfma_f32_32x32x16_bf16 v[176:191], v[32:35], v[80:83], 0
  ds_read_b64_tr_b16 v[48:49], v17 offset:16384
  ds_read_b64_tr_b16 v[50:51], v17 offset:17408
  s_add_u32 m0, s30, 2048
  s_add_u32 s38, s36, 19200
  buffer_load_dwordx4 v19, s[16:19], s38 offen lds
  s_waitcnt lgkmcnt(6)
  v_mfma_f32_32x32x16_bf16 v[176:191], v[36:39], v[84:87], v[176:191]
  ds_read_b64_tr_b16 v[52:53], v17 offset:20480
  ds_read_b64_tr_b16 v[54:55], v17 offset:21504
  s_waitcnt lgkmcnt(6)
  v_mfma_f32_32x32x16_bf16 v[176:191], v[40:43], v[88:91], v[176:191]
  ds_read_b64_tr_b16 v[32:33], v17 offset:24576
  ds_read_b64_tr_b16 v[34:35], v17 offset:25600
  s_add_u32 m0, s30, 3072
  s_add_u32 s38, s36, 28416
  buffer_load_dwordx4 v19, s[16:19], s38 offen lds
  s_waitcnt lgkmcnt(6)
  v_mfma_f32_32x32x16_bf16 v[176:191], v[44:47], v[92:95], v[176:191]
  ds_read_b64_tr_b16 v[36:37], v17 offset:28672
  ds_read_b64_tr_b16 v[38:39], v17 offset:29696
  v_cvt_pk_bf16_f32 v192, v160, v161
  v_cvt_pk_bf16_f32 v193, v162, v163
  s_waitcnt lgkmcnt(6)
  v_mfma_f32_32x32x16_bf16 v[176:191], v[48:51], v[96:99], v[176:191]
  ds_read_b64_tr_b16 v[40:41], v17 offset:32768
  ds_read_b64_tr_b16 v[42:43], v17 offset:33792
  v_cvt_pk_bf16_f32 v194, v164, v165
  v_cvt_pk_bf16_f32 v195, v166, v167
  s_waitcnt lgkmcnt(6)
  v_mfma_f32_32x32x16_bf16 v[176:191], v[52:55], v[100:103], v[176:191]
  ds_read_b64_tr_b16 v[44:45], v18 offset:0
  ds_read_b64_tr_b16 v[46:47], v18 offset:1024
  s_add_u32 s46, s33, 2048
  buffer_store_dwordx4 v[192:195], v2, s[20:23], s46 offen sc1
  v_cvt_pk_bf16_f32 v196, v168, v169
  s_waitcnt lgkmcnt(6)
  v_mfma_f32_32x32x16_bf16 v[176:191], v[32:35], v[104:107], v[176:191]
  ds_read_b64_tr_b16 v[48:49], v18 offset:4096
  ds_read_b64_tr_b16 v[50:51], v18 offset:5120
  v_cvt_pk_bf16_f32 v197, v170, v171
  v_cvt_pk_bf16_f32 v198, v172, v173
  s_waitcnt lgkmcnt(6)
  v_mfma_f32_32x32x16_bf16 v[176:191], v[36:39], v[64:67], v[176:191]
  ds_read_b64_tr_b16 v[52:53], v18 offset:8192
  ds_read_b64_tr_b16 v[54:55], v18 offset:9216
  v_cvt_pk_bf16_f32 v199, v174, v175
  buffer_store_dwordx4 v[196:199], v2, s[20:23], s46 offen offset:256 sc1
  s_waitcnt lgkmcnt(6)
  v_mfma_f32_32x32x16_bf16 v[176:191], v[40:43], v[68:71], v[176:191]
  ds_read_b64_tr_b16 v[32:33], v18 offset:12288
  ds_read_b64_tr_b16 v[34:35], v18 offset:13312
  s_add_u32 m0, s30, 4096
  s_add_u32 s38, s36, 37632
  s_mov_b32 exec_hi, 0
  buffer_load_dwordx4 v19, s[16:19], s38 offen lds
  s_mov_b32 exec_hi, -1
  s_waitcnt lgkmcnt(6)
  v_mfma_f32_32x32x16_bf16 v[176:191], v[44:47], v[112:115], v[176:191]
  ds_read_b64_tr_b16 v[36:37], v18 offset:16384
  ds_read_b64_tr_b16 v[38:39], v18 offset:17408
  s_waitcnt lgkmcnt(6)
  v_mfma_f32_32x32x16_bf16 v[176:191], v[48:51], v[116:119], v[176:191]
  ds_read_b64_tr_b16 v[40:41], v18 offset:20480
  ds_read_b64_tr_b16 v[42:43], v18 offset:21504
  s_waitcnt lgkmcnt(6)
  v_mfma_f32_32x32x16_bf16 v[176:191], v[52:55], v[120:123], v[176:191]
  ds_read_b64_tr_b16 v[44:45], v18 offset:24576
  ds_read_b64_tr_b16 v[46:47], v18 offset:25600
  s_waitcnt lgkmcnt(6)
  v_mfma_f32_32x32x16_bf16 v[176:191], v[32:35], v[124:127], v[176:191]
  ds_read_b64_tr_b16 v[48:49], v18 offset:28672
  ds_read_b64_tr_b16 v[50:51], v18 offset:29696
  s_waitcnt lgkmcnt(6)
  v_mfma_f32_32x32x16_bf16 v[176:191], v[36:39], v[128:131], v[176:191]
  ds_read_b64_tr_b16 v[52:53], v18 offset:32768
  ds_read_b64_tr_b16 v[54:55], v18 offset:33792
  s_waitcnt lgkmcnt(6)
  v_mfma_f32_32x32x16_bf16 v[176:191], v[40:43], v[132:135], v[176:191]
  s_waitcnt vmcnt(16)
  s_waitcnt lgkmcnt(0)
  s_barrier
  v_add_u32 v17, 36864, v17
  v_add_u32 v18, 36864, v18
  ds_read_b64_tr_b16 v[32:33], v17 offset:0
  ds_read_b64_tr_b16 v[34:35], v17 offset:1024
  s_add_u32 m0, s30, 36864
  s_add_u32 s38, s36, 896
  buffer_load_dwordx4 v19, s[16:19], s38 offen lds
  v_mfma_f32_32x32x16_bf16 v[176:191], v[44:47], v[136:139], v[176:191]
  ds_read_b64_tr_b16 v[36:37], v17 offset:4096
  ds_read_b64_tr_b16 v[38:39], v17 offset:5120
  v_mfma_f32_32x32x16_bf16 v[176:191], v[48:51], v[140:143], v[176:191]
  ds_read_b64_tr_b16 v[40:41], v17 offset:8192
  ds_read_b64_tr_b16 v[42:43], v17 offset:9216
  s_add_u32 m0, s30, 37888
  s_add_u32 s38, s36, 10112
  buffer_load_dwordx4 v19, s[16:19], s38 offen lds
  v_mfma_f32_32x32x16_bf16 v[176:191], v[52:55], v[144:147], v[176:191]
  ds_read_b64_tr_b16 v[44:45], v17 offset:12288
  ds_read_b64_tr_b16 v[46:47], v17 offset:13312
  s_waitcnt lgkmcnt(6)
  v_mfma_f32_32x32x16_bf16 v[160:175], v[32:35], v[80:83], 0
  ds_read_b64_tr_b16 v[48:49], v17 offset:16384
  ds_read_b64_tr_b16 v[50:51], v17 offset:17408
  s_add_u32 m0, s30, 38912
  s_add_u32 s38, s36, 19328
  buffer_load_dwordx4 v19, s[16:19], s38 offen lds
  s_waitcnt lgkmcnt(6)
  v_mfma_f32_32x32x16_bf16 v[160:175], v[36:39], v[84:87], v[160:175]
  ds_read_b64_tr_b16 v[52:53], v17 offset:20480
  ds_read_b64_tr_b16 v[54:55], v17 offset:21504
  s_waitcnt lgkmcnt(6)
  v_mfma_f32_32x32x16_bf16 v[160:175], v[40:43], v[88:91], v[160:175]
  ds_read_b64_tr_b16 v[32:33], v17 offset:24576
  ds_read_b64_tr_b16 v[34:35], v17 offset:25600
  s_add_u32 m0, s30, 39936
  s_add_u32 s38, s36, 28544
  buffer_load_dwordx4 v19, s[16:19], s38 offen lds
  s_waitcnt lgkmcnt(6)
  v_mfma_f32_32x32x16_bf16 v[160:175], v[44:47], v[92:95], v[160:175]
  ds_read_b64_tr_b16 v[36:37], v17 offset:28672
  ds_read_b64_tr_b16 v[38:39], v17 offset:29696
  v_cvt_pk_bf16_f32 v200, v176, v177
  v_cvt_pk_bf16_f32 v201, v178, v179
  s_waitcnt lgkmcnt(6)
  v_mfma_f32_32x32x16_bf16 v[160:175], v[48:51], v[96:99], v[160:175]
  ds_read_b64_tr_b16 v[40:41], v17 offset:32768
  ds_read_b64_tr_b16 v[42:43], v17 offset:33792
  v_cvt_pk_bf16_f32 v202, v180, v181
  v_cvt_pk_bf16_f32 v203, v182, v183
  s_waitcnt lgkmcnt(6)
  v_mfma_f32_32x32x16_bf16 v[160:175], v[52:55], v[100:103], v[160:175]
  ds_read_b64_tr_b16 v[44:45], v18 offset:0
  ds_read_b64_tr_b16 v[46:47], v18 offset:1024
  s_add_u32 s46, s33, 3072
  buffer_store_dwordx4 v[200:203], v2, s[20:23], s46 offen sc1
  v_cvt_pk_bf16_f32 v204, v184, v185
  s_waitcnt lgkmcnt(6)
  v_mfma_f32_32x32x16_bf16 v[160:175], v[32:35], v[104:107], v[160:175]
  ds_read_b64_tr_b16 v[48:49], v18 offset:4096
  ds_read_b64_tr_b16 v[50:51], v18 offset:5120
  v_cvt_pk_bf16_f32 v205, v186, v187
  v_cvt_pk_bf16_f32 v206, v188, v189
  s_waitcnt lgkmcnt(6)
  v_mfma_f32_32x32x16_bf16 v[160:175], v[36:39], v[64:67], v[160:175]
  ds_read_b64_tr_b16 v[52:53], v18 offset:8192
  ds_read_b64_tr_b16 v[54:55], v18 offset:9216
  v_cvt_pk_bf16_f32 v207, v190, v191
  buffer_store_dwordx4 v[204:207], v2, s[20:23], s46 offen offset:256 sc1
  s_waitcnt lgkmcnt(6)
  v_mfma_f32_32x32x16_bf16 v[160:175], v[40:43], v[68:71], v[160:175]
  ds_read_b64_tr_b16 v[32:33], v18 offset:12288
  ds_read_b64_tr_b16 v[34:35], v18 offset:13312
  s_add_u32 m0, s30, 40960
  s_add_u32 s38, s36, 37760
  s_mov_b32 exec_hi, 0
  buffer_load_dwordx4 v19, s[16:19], s38 offen lds
  s_mov_b32 exec_hi, -1
  s_waitcnt lgkmcnt(6)
  v_mfma_f32_32x32x16_bf16 v[160:175], v[44:47], v[112:115], v[160:175]
  ds_read_b64_tr_b16 v[36:37], v18 offset:16384
  ds_read_b64_tr_b16 v[38:39], v18 offset:17408
  s_waitcnt lgkmcnt(6)
  v_mfma_f32_32x32x16_bf16 v[160:175], v[48:51], v[116:119], v[160:175]
  ds_read_b64_tr_b16 v[40:41], v18 offset:20480
  ds_read_b64_tr_b16 v[42:43], v18 offset:21504
  s_waitcnt lgkmcnt(6)
  v_mfma_f32_32x32x16_bf16 v[160:175], v[52:55], v[120:123], v[160:175]
  ds_read_b64_tr_b16 v[44:45], v18 offset:24576
  ds_read_b64_tr_b16 v[46:47], v18 offset:25600
  s_waitcnt lgkmcnt(6)
  v_mfma_f32_32x32x16_bf16 v[160:175], v[32:35], v[124:127], v[160:175]
  ds_read_b64_tr_b16 v[48:49], v18 offset:28672
  ds_read_b64_tr_b16 v[50:51], v18 offset:29696
  s_waitcnt lgkmcnt(6)
  v_mfma_f32_32x32x16_bf16 v[160:175], v[36:39], v[128:131], v[160:175]
  ds_read_b64_tr_b16 v[52:53], v18 offset:32768
  ds_read_b64_tr_b16 v[54:55], v18 offset:33792
  s_waitcnt lgkmcnt(6)
  v_mfma_f32_32x32x16_bf16 v[160:175], v[40:43], v[132:135], v[160:175]
  s_waitcnt vmcnt(14)
  s_waitcnt lgkmcnt(0)
  s_barrier
  v_add_u32 v17, 36864, v17
  v_add_u32 v18, 36864, v18
  ds_read_b64_tr_b16 v[32:33], v17 offset:0
  ds_read_b64_tr_b16 v[34:35], v17 offset:1024
  s_add_u32 m0, s30, 73728
  s_add_u32 s38, s36, 1024
  buffer_load_dwordx4 v19, s[16:19], s38 offen lds
  v_mfma_f32_32x32x16_bf16 v[160:175], v[44:47], v[136:139], v[160:175]
  ds_read_b64_tr_b16 v[36:37], v17 offset:4096
  ds_read_b64_tr_b16 v[38:39], v17 offset:5120
  v_mfma_f32_32x32x16_bf16 v[160:175], v[48:51], v[140:143], v[160:175]
  ds_read_b64_tr_b16 v[40:41], v17 offset:8192
  ds_read_b64_tr_b16 v[42:43], v17 offset:9216
  s_add_u32 m0, s30, 74752
  s_add_u32 s38, s36, 10240
  buffer_load_dwordx4 v19, s[16:19], s38 offen lds
  v_mfma_f32_32x32x16_bf16 v[160:175], v[52:55], v[144:147], v[160:175]
  ds_read_b64_tr_b16 v[44:45], v17 offset:12288
  ds_read_b64_tr_b16 v[46:47], v17 offset:13312
  s_waitcnt lgkmcnt(6)
  v_mfma_f32_32x32x16_bf16 v[176:191], v[32:35], v[80:83], 0
  ds_read_b64_tr_b16 v[48:49], v17 offset:16384
  ds_read_b64_tr_b16 v[50:51], v17 offset:17408
  s_add_u32 m0, s30, 75776
  s_add_u32 s38, s36, 19456
  buffer_load_dwordx4 v19, s[16:19], s38 offen lds
  s_waitcnt lgkmcnt(6)
  v_mfma_f32_32x32x16_bf16 v[176:191], v[36:39], v[84:87], v[176:191]
  ds_read_b64_tr_b16 v[52:53], v17 offset:20480
  ds_read_b64_tr_b16 v[54:55], v17 offset:21504
  s_waitcnt lgkmcnt(6)
  v_mfma_f32_32x32x16_bf16 v[176:191], v[40:43], v[88:91], v[176:191]
  ds_read_b64_tr_b16 v[32:33], v17 offset:24576
  ds_read_b64_tr_b16 v[34:35], v17 offset:25600
  s_add_u32 m0, s30, 76800
  s_add_u32 s38, s36, 28672
  buffer_load_dwordx4 v19, s[16:19], s38 offen lds
  s_waitcnt lgkmcnt(6)
  v_mfma_f32_32x32x16_bf16 v[176:191], v[44:47], v[92:95], v[176:191]
  ds_read_b64_tr_b16 v[36:37], v17 offset:28672
  ds_read_b64_tr_b16 v[38:39], v17 offset:29696
  v_cvt_pk_bf16_f32 v192, v160, v161
  v_cvt_pk_bf16_f32 v193, v162, v163
  s_waitcnt lgkmcnt(6)
  v_mfma_f32_32x32x16_bf16 v[176:191], v[48:51], v[96:99], v[176:191]
  ds_read_b64_tr_b16 v[40:41], v17 offset:32768
  ds_read_b64_tr_b16 v[42:43], v17 offset:33792
  v_cvt_pk_bf16_f32 v194, v164, v165
  v_cvt_pk_bf16_f32 v195, v166, v167
  s_waitcnt lgkmcnt(6)
  v_mfma_f32_32x32x16_bf16 v[176:191], v[52:55], v[100:103], v[176:191]
  ds_read_b64_tr_b16 v[44:45], v18 offset:0
  ds_read_b64_tr_b16 v[46:47], v18 offset:1024
  s_add_u32 s46, s33, 4096
  buffer_store_dwordx4 v[192:195], v2, s[20:23], s46 offen sc1
  v_cvt_pk_bf16_f32 v196, v168, v169
  s_waitcnt lgkmcnt(6)
  v_mfma_f32_32x32x16_bf16 v[176:191], v[32:35], v[104:107], v[176:191]
  ds_read_b64_tr_b16 v[48:49], v18 offset:4096
  ds_read_b64_tr_b16 v[50:51], v18 offset:5120
  v_cvt_pk_bf16_f32 v197, v170, v171
  v_cvt_pk_bf16_f32 v198, v172, v173
  s_waitcnt lgkmcnt(6)
  v_mfma_f32_32x32x16_bf16 v[176:191], v[36:39], v[64:67], v[176:191]
  ds_read_b64_tr_b16 v[52:53], v18 offset:8192
  ds_read_b64_tr_b16 v[54:55], v18 offset:9216
  v_cvt_pk_bf16_f32 v199, v174, v175
  buffer_store_dwordx4 v[196:199], v2, s[20:23], s46 offen offset:256 sc1
  s_waitcnt lgkmcnt(6)
  v_mfma_f32_32x32x16_bf16 v[176:191], v[40:43], v[68:71], v[176:191]
  ds_read_b64_tr_b16 v[32:33], v18 offset:12288
  ds_read_b64_tr_b16 v[34:35], v18 offset:13312
  s_add_u32 m0, s30, 77824
  s_add_u32 s38, s36, 37888
  s_mov_b32 exec_hi, 0
  buffer_load_dwordx4 v19, s[16:19], s38 offen lds
  s_mov_b32 exec_hi, -1
  s_waitcnt lgkmcnt(6)
  v_mfma_f32_32x32x16_bf16 v[176:191], v[44:47], v[112:115], v[176:191]
  ds_read_b64_tr_b16 v[36:37], v18 offset:16384
  ds_read_b64_tr_b16 v[38:39], v18 offset:17408
  s_waitcnt lgkmcnt(6)
  v_mfma_f32_32x32x16_bf16 v[176:191], v[48:51], v[116:119], v[176:191]
  ds_read_b64_tr_b16 v[40:41], v18 offset:20480
  ds_read_b64_tr_b16 v[42:43], v18 offset:21504
  s_waitcnt lgkmcnt(6)
  v_mfma_f32_32x32x16_bf16 v[176:191], v[52:55], v[120:123], v[176:191]
  ds_read_b64_tr_b16 v[44:45], v18 offset:24576
  ds_read_b64_tr_b16 v[46:47], v18 offset:25600
  s_waitcnt lgkmcnt(6)
  v_mfma_f32_32x32x16_bf16 v[176:191], v[32:35], v[124:127], v[176:191]
  ds_read_b64_tr_b16 v[48:49], v18 offset:28672
  ds_read_b64_tr_b16 v[50:51], v18 offset:29696
  s_waitcnt lgkmcnt(6)
  v_mfma_f32_32x32x16_bf16 v[176:191], v[36:39], v[128:131], v[176:191]
  ds_read_b64_tr_b16 v[52:53], v18 offset:32768
  ds_read_b64_tr_b16 v[54:55], v18 offset:33792
  s_waitcnt lgkmcnt(6)
  v_mfma_f32_32x32x16_bf16 v[176:191], v[40:43], v[132:135], v[176:191]
  s_waitcnt vmcnt(14)
  s_waitcnt lgkmcnt(0)
  s_barrier
  v_add_u32 v17, 4294856704, v17
  v_add_u32 v18, 4294856704, v18
  ds_read_b64_tr_b16 v[32:33], v17 offset:0
  ds_read_b64_tr_b16 v[34:35], v17 offset:1024
  v_mfma_f32_32x32x16_bf16 v[176:191], v[44:47], v[136:139], v[176:191]
  ds_read_b64_tr_b16 v[36:37], v17 offset:4096
  ds_read_b64_tr_b16 v[38:39], v17 offset:5120
  v_mfma_f32_32x32x16_bf16 v[176:191], v[48:51], v[140:143], v[176:191]
  ds_read_b64_tr_b16 v[40:41], v17 offset:8192
  ds_read_b64_tr_b16 v[42:43], v17 offset:9216
  v_mfma_f32_32x32x16_bf16 v[176:191], v[52:55], v[144:147], v[176:191]
  ds_read_b64_tr_b16 v[44:45], v17 offset:12288
  ds_read_b64_tr_b16 v[46:47], v17 offset:13312
  s_waitcnt lgkmcnt(6)
  v_mfma_f32_32x32x16_bf16 v[160:175], v[32:35], v[80:83], 0
  ds_read_b64_tr_b16 v[48:49], v17 offset:16384
  ds_read_b64_tr_b16 v[50:51], v17 offset:17408
  s_waitcnt lgkmcnt(6)
  v_mfma_f32_32x32x16_bf16 v[160:175], v[36:39], v[84:87], v[160:175]
  ds_read_b64_tr_b16 v[52:53], v17 offset:20480
  ds_read_b64_tr_b16 v[54:55], v17 offset:21504
  s_waitcnt lgkmcnt(6)
  v_mfma_f32_32x32x16_bf16 v[160:175], v[40:43], v[88:91], v[160:175]
  ds_read_b64_tr_b16 v[32:33], v17 offset:24576
  ds_read_b64_tr_b16 v[34:35], v17 offset:25600
  s_waitcnt lgkmcnt(6)
  v_mfma_f32_32x32x16_bf16 v[160:175], v[44:47], v[92:95], v[160:175]
  ds_read_b64_tr_b16 v[36:37], v17 offset:28672
  ds_read_b64_tr_b16 v[38:39], v17 offset:29696
  v_cvt_pk_bf16_f32 v200, v176, v177
  v_cvt_pk_bf16_f32 v201, v178, v179
  s_waitcnt lgkmcnt(6)
  v_mfma_f32_32x32x16_bf16 v[160:175], v[48:51], v[96:99], v[160:175]
  ds_read_b64_tr_b16 v[40:41], v17 offset:32768
  ds_read_b64_tr_b16 v[42:43], v17 offset:33792
  v_cvt_pk_bf16_f32 v202, v180, v181
  v_cvt_pk_bf16_f32 v203, v182, v183
  s_waitcnt lgkmcnt(6)
  v_mfma_f32_32x32x16_bf16 v[160:175], v[52:55], v[100:103], v[160:175]
  ds_read_b64_tr_b16 v[44:45], v18 offset:0
  ds_read_b64_tr_b16 v[46:47], v18 offset:1024
  s_add_u32 s46, s33, 5120
  buffer_store_dwordx4 v[200:203], v2, s[20:23], s46 offen sc1
  v_cvt_pk_bf16_f32 v204, v184, v185
  s_waitcnt lgkmcnt(6)
  v_mfma_f32_32x32x16_bf16 v[160:175], v[32:35], v[104:107], v[160:175]
  ds_read_b64_tr_b16 v[48:49], v18 offset:4096
  ds_read_b64_tr_b16 v[50:51], v18 offset:5120
  v_cvt_pk_bf16_f32 v205, v186, v187
  v_cvt_pk_bf16_f32 v206, v188, v189
  s_waitcnt lgkmcnt(6)
  v_mfma_f32_32x32x16_bf16 v[160:175], v[36:39], v[64:67], v[160:175]
  ds_read_b64_tr_b16 v[52:53], v18 offset:8192
  ds_read_b64_tr_b16 v[54:55], v18 offset:9216
  v_cvt_pk_bf16_f32 v207, v190, v191
  buffer_store_dwordx4 v[204:207], v2, s[20:23], s46 offen offset:256 sc1
  s_waitcnt lgkmcnt(6)
  v_mfma_f32_32x32x16_bf16 v[160:175], v[40:43], v[68:71], v[160:175]
  ds_read_b64_tr_b16 v[32:33], v18 offset:12288
  ds_read_b64_tr_b16 v[34:35], v18 offset:13312
  s_waitcnt lgkmcnt(6)
  v_mfma_f32_32x32x16_bf16 v[160:175], v[44:47], v[112:115], v[160:175]
  ds_read_b64_tr_b16 v[36:37], v18 offset:16384
  ds_read_b64_tr_b16 v[38:39], v18 offset:17408
  s_waitcnt lgkmcnt(6)
  v_mfma_f32_32x32x16_bf16 v[160:175], v[48:51], v[116:119], v[160:175]
  ds_read_b64_tr_b16 v[40:41], v18 offset:20480
  ds_read_b64_tr_b16 v[42:43], v18 offset:21504
  s_waitcnt lgkmcnt(6)
  v_mfma_f32_32x32x16_bf16 v[160:175], v[52:55], v[120:123], v[160:175]
  ds_read_b64_tr_b16 v[44:45], v18 offset:24576
  ds_read_b64_tr_b16 v[46:47], v18 offset:25600
  s_waitcnt lgkmcnt(6)
  v_mfma_f32_32x32x16_bf16 v[160:175], v[32:35], v[124:127], v[160:175]
  ds_read_b64_tr_b16 v[48:49], v18 offset:28672
  ds_read_b64_tr_b16 v[50:51], v18 offset:29696
  s_waitcnt lgkmcnt(6)
  v_mfma_f32_32x32x16_bf16 v[160:175], v[36:39], v[128:131], v[160:175]
  ds_read_b64_tr_b16 v[52:53], v18 offset:32768
  ds_read_b64_tr_b16 v[54:55], v18 offset:33792
  s_waitcnt lgkmcnt(6)
  v_mfma_f32_32x32x16_bf16 v[160:175], v[40:43], v[132:135], v[160:175]
  s_waitcnt vmcnt(9)
  s_waitcnt lgkmcnt(0)
  s_barrier
  v_add_u32 v17, 36864, v17
  v_add_u32 v18, 36864, v18
  ds_read_b64_tr_b16 v[32:33], v17 offset:0
  ds_read_b64_tr_b16 v[34:35], v17 offset:1024
  v_mfma_f32_32x32x16_bf16 v[160:175], v[44:47], v[136:139], v[160:175]
  ds_read_b64_tr_b16 v[36:37], v17 offset:4096
  ds_read_b64_tr_b16 v[38:39], v17 offset:5120
  v_mfma_f32_32x32x16_bf16 v[160:175], v[48:51], v[140:143], v[160:175]
  ds_read_b64_tr_b16 v[40:41], v17 offset:8192
  ds_read_b64_tr_b16 v[42:43], v17 offset:9216
  v_mfma_f32_32x32x16_bf16 v[160:175], v[52:55], v[144:147], v[160:175]
  ds_read_b64_tr_b16 v[44:45], v17 offset:12288
  ds_read_b64_tr_b16 v[46:47], v17 offset:13312
  s_waitcnt lgkmcnt(6)
  v_mfma_f32_32x32x16_bf16 v[176:191], v[32:35], v[80:83], 0
  ds_read_b64_tr_b16 v[48:49], v17 offset:16384
  ds_read_b64_tr_b16 v[50:51], v17 offset:17408
  s_waitcnt lgkmcnt(6)
  v_mfma_f32_32x32x16_bf16 v[176:191], v[36:39], v[84:87], v[176:191]
  ds_read_b64_tr_b16 v[52:53], v17 offset:20480
  ds_read_b64_tr_b16 v[54:55], v17 offset:21504
  s_waitcnt lgkmcnt(6)
  v_mfma_f32_32x32x16_bf16 v[176:191], v[40:43], v[88:91], v[176:191]
  ds_read_b64_tr_b16 v[32:33], v17 offset:24576
  ds_read_b64_tr_b16 v[34:35], v17 offset:25600
  s_waitcnt lgkmcnt(6)
  v_mfma_f32_32x32x16_bf16 v[176:191], v[44:47], v[92:95], v[176:191]
  ds_read_b64_tr_b16 v[36:37], v17 offset:28672
  ds_read_b64_tr_b16 v[38:39], v17 offset:29696
  v_cvt_pk_bf16_f32 v192, v160, v161
  v_cvt_pk_bf16_f32 v193, v162, v163
  s_waitcnt lgkmcnt(6)
  v_mfma_f32_32x32x16_bf16 v[176:191], v[48:51], v[96:99], v[176:191]
  ds_read_b64_tr_b16 v[40:41], v17 offset:32768
  ds_read_b64_tr_b16 v[42:43], v17 offset:33792
  v_cvt_pk_bf16_f32 v194, v164, v165
  v_cvt_pk_bf16_f32 v195, v166, v167
  s_waitcnt lgkmcnt(6)
  v_mfma_f32_32x32x16_bf16 v[176:191], v[52:55], v[100:103], v[176:191]
  ds_read_b64_tr_b16 v[44:45], v18 offset:0
  ds_read_b64_tr_b16 v[46:47], v18 offset:1024
  s_add_u32 s46, s33, 6144
  buffer_store_dwordx4 v[192:195], v2, s[20:23], s46 offen sc1
  v_cvt_pk_bf16_f32 v196, v168, v169
  s_waitcnt lgkmcnt(6)
  v_mfma_f32_32x32x16_bf16 v[176:191], v[32:35], v[104:107], v[176:191]
  ds_read_b64_tr_b16 v[48:49], v18 offset:4096
  ds_read_b64_tr_b16 v[50:51], v18 offset:5120
  v_cvt_pk_bf16_f32 v197, v170, v171
  v_cvt_pk_bf16_f32 v198, v172, v173
  s_waitcnt lgkmcnt(6)
  v_mfma_f32_32x32x16_bf16 v[176:191], v[36:39], v[64:67], v[176:191]
  ds_read_b64_tr_b16 v[52:53], v18 offset:8192
  ds_read_b64_tr_b16 v[54:55], v18 offset:9216
  v_cvt_pk_bf16_f32 v199, v174, v175
  buffer_store_dwordx4 v[196:199], v2, s[20:23], s46 offen offset:256 sc1
  s_waitcnt lgkmcnt(6)
  v_mfma_f32_32x32x16_bf16 v[176:191], v[40:43], v[68:71], v[176:191]
  ds_read_b64_tr_b16 v[32:33], v18 offset:12288
  ds_read_b64_tr_b16 v[34:35], v18 offset:13312
  s_waitcnt lgkmcnt(6)
  v_mfma_f32_32x32x16_bf16 v[176:191], v[44:47], v[112:115], v[176:191]
  ds_read_b64_tr_b16 v[36:37], v18 offset:16384
  ds_read_b64_tr_b16 v[38:39], v18 offset:17408
  s_waitcnt lgkmcnt(6)
  v_mfma_f32_32x32x16_bf16 v[176:191], v[48:51], v[116:119], v[176:191]
  ds_read_b64_tr_b16 v[40:41], v18 offset:20480
  ds_read_b64_tr_b16 v[42:43], v18 offset:21504
  s_waitcnt lgkmcnt(6)
  v_mfma_f32_32x32x16_bf16 v[176:191], v[52:55], v[120:123], v[176:191]
  ds_read_b64_tr_b16 v[44:45], v18 offset:24576
  ds_read_b64_tr_b16 v[46:47], v18 offset:25600
  s_waitcnt lgkmcnt(6)
  v_mfma_f32_32x32x16_bf16 v[176:191], v[32:35], v[124:127], v[176:191]
  ds_read_b64_tr_b16 v[48:49], v18 offset:28672
  ds_read_b64_tr_b16 v[50:51], v18 offset:29696
  s_waitcnt lgkmcnt(6)
  v_mfma_f32_32x32x16_bf16 v[176:191], v[36:39], v[128:131], v[176:191]
  ds_read_b64_tr_b16 v[52:53], v18 offset:32768
  ds_read_b64_tr_b16 v[54:55], v18 offset:33792
  s_waitcnt lgkmcnt(6)
  v_mfma_f32_32x32x16_bf16 v[176:191], v[40:43], v[132:135], v[176:191]
  s_waitcnt vmcnt(4)
  s_waitcnt lgkmcnt(0)
  s_barrier
  v_add_u32 v17, 36864, v17
  v_add_u32 v18, 36864, v18
  ds_read_b64_tr_b16 v[32:33], v17 offset:0
  ds_read_b64_tr_b16 v[34:35], v17 offset:1024
  v_mfma_f32_32x32x16_bf16 v[176:191], v[44:47], v[136:139], v[176:191]
  ds_read_b64_tr_b16 v[36:37], v17 offset:4096
  ds_read_b64_tr_b16 v[38:39], v17 offset:5120
  v_mfma_f32_32x32x16_bf16 v[176:191], v[48:51], v[140:143], v[176:191]
  ds_read_b64_tr_b16 v[40:41], v17 offset:8192
  ds_read_b64_tr_b16 v[42:43], v17 offset:9216
  v_mfma_f32_32x32x16_bf16 v[176:191], v[52:55], v[144:147], v[176:191]
  ds_read_b64_tr_b16 v[44:45], v17 offset:12288
  ds_read_b64_tr_b16 v[46:47], v17 offset:13312
  s_waitcnt lgkmcnt(6)
  v_mfma_f32_32x32x16_bf16 v[160:175], v[32:35], v[80:83], 0
  ds_read_b64_tr_b16 v[48:49], v17 offset:16384
  ds_read_b64_tr_b16 v[50:51], v17 offset:17408
  s_waitcnt lgkmcnt(6)
  v_mfma_f32_32x32x16_bf16 v[160:175], v[36:39], v[84:87], v[160:175]
  ds_read_b64_tr_b16 v[52:53], v17 offset:20480
  ds_read_b64_tr_b16 v[54:55], v17 offset:21504
  s_waitcnt lgkmcnt(6)
  v_mfma_f32_32x32x16_bf16 v[160:175], v[40:43], v[88:91], v[160:175]
  ds_read_b64_tr_b16 v[32:33], v17 offset:24576
  ds_read_b64_tr_b16 v[34:35], v17 offset:25600
  s_waitcnt lgkmcnt(6)
  v_mfma_f32_32x32x16_bf16 v[160:175], v[44:47], v[92:95], v[160:175]
  ds_read_b64_tr_b16 v[36:37], v17 offset:28672
  ds_read_b64_tr_b16 v[38:39], v17 offset:29696
  v_cvt_pk_bf16_f32 v200, v176, v177
  v_cvt_pk_bf16_f32 v201, v178, v179
  s_waitcnt lgkmcnt(6)
  v_mfma_f32_32x32x16_bf16 v[160:175], v[48:51], v[96:99], v[160:175]
  ds_read_b64_tr_b16 v[40:41], v17 offset:32768
  ds_read_b64_tr_b16 v[42:43], v17 offset:33792
  v_cvt_pk_bf16_f32 v202, v180, v181
  v_cvt_pk_bf16_f32 v203, v182, v183
  s_waitcnt lgkmcnt(6)
  v_mfma_f32_32x32x16_bf16 v[160:175], v[52:55], v[100:103], v[160:175]
  ds_read_b64_tr_b16 v[44:45], v18 offset:0
  ds_read_b64_tr_b16 v[46:47], v18 offset:1024
  s_add_u32 s46, s33, 7168
  buffer_store_dwordx4 v[200:203], v2, s[20:23], s46 offen sc1
  v_cvt_pk_bf16_f32 v204, v184, v185
  s_waitcnt lgkmcnt(6)
  v_mfma_f32_32x32x16_bf16 v[160:175], v[32:35], v[104:107], v[160:175]
  ds_read_b64_tr_b16 v[48:49], v18 offset:4096
  ds_read_b64_tr_b16 v[50:51], v18 offset:5120
  v_cvt_pk_bf16_f32 v205, v186, v187
  v_cvt_pk_bf16_f32 v206, v188, v189
  s_waitcnt lgkmcnt(6)
  v_mfma_f32_32x32x16_bf16 v[160:175], v[36:39], v[64:67], v[160:175]
  ds_read_b64_tr_b16 v[52:53], v18 offset:8192
  ds_read_b64_tr_b16 v[54:55], v18 offset:9216
  v_cvt_pk_bf16_f32 v207, v190, v191
  buffer_store_dwordx4 v[204:207], v2, s[20:23], s46 offen offset:256 sc1
  s_waitcnt lgkmcnt(6)
  v_mfma_f32_32x32x16_bf16 v[160:175], v[40:43], v[68:71], v[160:175]
  ds_read_b64_tr_b16 v[32:33], v18 offset:12288
  ds_read_b64_tr_b16 v[34:35], v18 offset:13312
  s_waitcnt lgkmcnt(6)
  v_mfma_f32_32x32x16_bf16 v[160:175], v[44:47], v[112:115], v[160:175]
  ds_read_b64_tr_b16 v[36:37], v18 offset:16384
  ds_read_b64_tr_b16 v[38:39], v18 offset:17408
  s_waitcnt lgkmcnt(6)
  v_mfma_f32_32x32x16_bf16 v[160:175], v[48:51], v[116:119], v[160:175]
  ds_read_b64_tr_b16 v[40:41], v18 offset:20480
  ds_read_b64_tr_b16 v[42:43], v18 offset:21504
  s_waitcnt lgkmcnt(6)
  v_mfma_f32_32x32x16_bf16 v[160:175], v[52:55], v[120:123], v[160:175]
  ds_read_b64_tr_b16 v[44:45], v18 offset:24576
  ds_read_b64_tr_b16 v[46:47], v18 offset:25600
  s_waitcnt lgkmcnt(6)
  v_mfma_f32_32x32x16_bf16 v[160:175], v[32:35], v[124:127], v[160:175]
  ds_read_b64_tr_b16 v[48:49], v18 offset:28672
  ds_read_b64_tr_b16 v[50:51], v18 offset:29696
  s_waitcnt lgkmcnt(6)
  v_mfma_f32_32x32x16_bf16 v[160:175], v[36:39], v[128:131], v[160:175]
  ds_read_b64_tr_b16 v[52:53], v18 offset:32768
  ds_read_b64_tr_b16 v[54:55], v18 offset:33792
  s_waitcnt lgkmcnt(6)
  v_mfma_f32_32x32x16_bf16 v[160:175], v[40:43], v[132:135], v[160:175]
  s_waitcnt lgkmcnt(4)
  v_mfma_f32_32x32x16_bf16 v[160:175], v[44:47], v[136:139], v[160:175]
  s_waitcnt lgkmcnt(2)
  v_mfma_f32_32x32x16_bf16 v[160:175], v[48:51], v[140:143], v[160:175]
  s_waitcnt lgkmcnt(0)
  v_mfma_f32_32x32x16_bf16 v[160:175], v[52:55], v[144:147], v[160:175]
  s_nop 11
  v_cvt_pk_bf16_f32 v192, v160, v161
  v_cvt_pk_bf16_f32 v193, v162, v163
  v_cvt_pk_bf16_f32 v194, v164, v165
  v_cvt_pk_bf16_f32 v195, v166, v167
  s_add_u32 s46, s33, 8192
  buffer_store_dwordx4 v[192:195], v2, s[20:23], s46 offen sc1
  v_cvt_pk_bf16_f32 v196, v168, v169
  v_cvt_pk_bf16_f32 v197, v170, v171
  v_cvt_pk_bf16_f32 v198, v172, v173
  v_cvt_pk_bf16_f32 v199, v174, v175
  buffer_store_dwordx4 v[196:199], v2, s[20:23], s46 offen offset:256 sc1
  s_load_dwordx2 s[4:5], s[0:1], 0
  s_mov_b32 s6, 2359296
  s_mov_b32 s7, 0x00020000
  s_load_dwordx2 s[8:9], s[0:1], 88
  s_mov_b32 s10, 2359296
  s_mov_b32 s11, 0x00020000
  v_mbcnt_lo_u32_b32 v0, -1, 0
  v_mbcnt_hi_u32_b32 v0, -1, v0
  s_lshl_b32 s16, s24, 6
  v_add_u32 v0, s16, v0
  v_lshlrev_b32 v1, 4, v0
  v_and_b32 v2, 7, v0
  v_lshrrev_b32 v5, 3, v0
  v_mul_u32_u24 v4, 1152, v2
  v_lshl_add_u32 v158, v5, 2, v4
  v_add_u32 v158, 1024, v158
  v_lshl_add_u32 v4, v5, 4, v4
  v_lshlrev_b32 v159, 3, v5
  v_add_u32 v159, 2048, v159
  v_and_b32 v157, 3, v5
  v_lshlrev_b32 v157, 2, v157
  v_lshl_add_u32 v157, v2, 4, v157
  v_lshrrev_b32 v3, 5, v0
  v_lshl_add_u32 v157, v3, 7, v157
  v_add_u32 v157, 8192, v157
  v_lshlrev_b32 v5, 5, v5
  v_lshlrev_b32 v2, 6, v2
  s_lshl_b32 s17, s24, 2
  v_add_u32 v3, s17, v2
  s_lshl_b32 s16, s26, 4
  s_add_u32 s16, s16, s25
  s_mul_i32 s16, s16, 9216
  s_cmp_lt_u32 s24, 4
  s_cselect_b32 s44, 1.0, 0
  s_cselect_b64 s[40:41], -1, 0
  v_mov_b32 v12, 0
  v_mov_b32 v140, 0
  v_mov_b32 v141, 0
  v_mov_b32 v142, 0
  v_mov_b32 v143, 0
  v_mov_b32 v144, 0
  v_mov_b32 v145, 0
  v_mov_b32 v146, 0
  v_mov_b32 v147, 0
  v_mov_b32 v148, 0
  v_mov_b32 v149, 0
  v_mov_b32 v150, 0
  v_mov_b32 v151, 0
  v_mov_b32 v152, 0
  v_mov_b32 v153, 0
  v_mov_b32 v154, 0
  v_mov_b32 v155, 0
  v_mov_b32 v40, 0
  v_mov_b32 v41, 0
  v_mov_b32 v7, 1024
  v_mov_b32 v6, 0
  ds_write_b32 v7, v6
  s_mov_b32 s45, 0
  s_mov_b32 s46, 0
  s_add_u32 s47, s16, 67108864
  s_waitcnt vmcnt(0) lgkmcnt(0)
  s_barrier
  s_cmp_eq_u32 s24, 0
  s_cbranch_scc0 k2_pg5_d
  s_lshl_b32 s17, s26, 8
  s_add_u32 s17, s17, 36864
  s_lshl_b32 s19, s25, 2
  s_add_u32 s19, s19, s17
  s_mov_b32 s18, 0x40000
  v_mov_b32 v6, 1
  v_lshlrev_b32 v156, 2, v0
  s_mov_b64 exec, 1
  buffer_store_dword v6, v156, s[20:23], s19 offen sc1
  s_mov_b64 exec, 0xffff
k2_pg5_p:
  buffer_load_dword v6, v156, s[20:23], s17 offen sc1
  s_waitcnt vmcnt(0)
  v_cmp_eq_u32 vcc, 1, v6
  s_sub_u32 s18, s18, 1
  s_cselect_b32 s45, 0xffff, vcc_lo
  v_mov_b32 v6, s45
  ds_write_b32 v7, v6
  s_cmp_eq_u32 s45, 0xffff
  s_cbranch_scc1 k2_pg5_x
  s_sleep 2
  s_branch k2_pg5_p
k2_pg5_x:
  s_mov_b64 exec, -1
k2_pg5_d:
  s_waitcnt lgkmcnt(0)
  s_add_u32 s17, s16, 3145728
  s_mov_b64 exec, s[40:41]
  buffer_load_dword v12, v157, s[20:23], s17 offen  sc1
  s_movk_i32 s18, 11520
  buffer_load_dwordx2 v[40:41], v159, s[20:23], s18 offen
  s_mov_b64 exec, -1
  buffer_load_dwordx4 v[8:11], v1, s[20:23], s17 offen  sc1
  s_movk_i32 s18, 11520
  buffer_load_dwordx4 v[16:19], v5, s[20:23], s18 offen
  buffer_load_dwordx4 v[20:23], v5, s[20:23], s18 offen offset:16
k2_pg5_l0:
  s_andn2_b32 s18, s45, s46
  s_cbranch_scc1 k2_pg5_g0
  s_sleep 1
  ds_read_b32 v6, v7
  s_waitcnt lgkmcnt(0)
  v_readfirstlane_b32 s45, v6
  s_branch k2_pg5_l0
k2_pg5_g0:
  s_ff1_i32_b32 s18, s18
  s_bitset1_b32 s46, s18
  s_mul_i32 s17, s18, 2359296
  s_add_u32 s17, s17, s47
  s_mov_b64 exec, s[40:41]
  buffer_load_dword v140, v157, s[20:23], s17 offen sc1
  s_mov_b64 exec, -1
  buffer_load_dwordx4 v[48:51], v1, s[20:23], s17 offen sc1
k2_pg5_l1:
  s_andn2_b32 s18, s45, s46
  s_cbranch_scc1 k2_pg5_g1
  s_sleep 1
  ds_read_b32 v6, v7
  s_waitcnt lgkmcnt(0)
  v_readfirstlane_b32 s45, v6
  s_branch k2_pg5_l1
k2_pg5_g1:
  s_ff1_i32_b32 s18, s18
  s_bitset1_b32 s46, s18
  s_mul_i32 s17, s18, 2359296
  s_add_u32 s17, s17, s47
  s_mov_b64 exec, s[40:41]
  buffer_load_dword v141, v157, s[20:23], s17 offen sc1
  s_mov_b64 exec, -1
  buffer_load_dwordx4 v[52:55], v1, s[20:23], s17 offen sc1
k2_pg5_l2:
  s_andn2_b32 s18, s45, s46
  s_cbranch_scc1 k2_pg5_g2
  s_sleep 1
  ds_read_b32 v6, v7
  s_waitcnt lgkmcnt(0)
  v_readfirstlane_b32 s45, v6
  s_branch k2_pg5_l2
k2_pg5_g2:
  s_ff1_i32_b32 s18, s18
  s_bitset1_b32 s46, s18
  s_mul_i32 s17, s18, 2359296
  s_add_u32 s17, s17, s47
  s_mov_b64 exec, s[40:41]
  buffer_load_dword v142, v157, s[20:23], s17 offen sc1
  s_mov_b64 exec, -1
  buffer_load_dwordx4 v[56:59], v1, s[20:23], s17 offen sc1
k2_pg5_l3:
  s_andn2_b32 s18, s45, s46
  s_cbranch_scc1 k2_pg5_g3
  s_sleep 1
  ds_read_b32 v6, v7
  s_waitcnt lgkmcnt(0)
  v_readfirstlane_b32 s45, v6
  s_branch k2_pg5_l3
k2_pg5_g3:
  s_ff1_i32_b32 s18, s18
  s_bitset1_b32 s46, s18
  s_mul_i32 s17, s18, 2359296
  s_add_u32 s17, s17, s47
  s_mov_b64 exec, s[40:41]
  buffer_load_dword v143, v157, s[20:23], s17 offen sc1
  s_mov_b64 exec, -1
  buffer_load_dwordx4 v[60:63], v1, s[20:23], s17 offen sc1
k2_pg5_l4:
  s_andn2_b32 s18, s45, s46
  s_cbranch_scc1 k2_pg5_g4
  s_sleep 1
  ds_read_b32 v6, v7
  s_waitcnt lgkmcnt(0)
  v_readfirstlane_b32 s45, v6
  s_branch k2_pg5_l4
k2_pg5_g4:
  s_ff1_i32_b32 s18, s18
  s_bitset1_b32 s46, s18
  s_mul_i32 s17, s18, 2359296
  s_add_u32 s17, s17, s47
  s_mov_b64 exec, s[40:41]
  buffer_load_dword v144, v157, s[20:23], s17 offen sc1
  s_mov_b64 exec, -1
  buffer_load_dwordx4 v[64:67], v1, s[20:23], s17 offen sc1
k2_pg5_l5:
  s_andn2_b32 s18, s45, s46
  s_cbranch_scc1 k2_pg5_g5
  s_sleep 1
  ds_read_b32 v6, v7
  s_waitcnt lgkmcnt(0)
  v_readfirstlane_b32 s45, v6
  s_branch k2_pg5_l5
k2_pg5_g5:
  s_ff1_i32_b32 s18, s18
  s_bitset1_b32 s46, s18
  s_mul_i32 s17, s18, 2359296
  s_add_u32 s17, s17, s47
  s_mov_b64 exec, s[40:41]
  buffer_load_dword v145, v157, s[20:23], s17 offen sc1
  s_mov_b64 exec, -1
  buffer_load_dwordx4 v[68:71], v1, s[20:23], s17 offen sc1
k2_pg5_l6:
  s_andn2_b32 s18, s45, s46
  s_cbranch_scc1 k2_pg5_g6
  s_sleep 1
  ds_read_b32 v6, v7
  s_waitcnt lgkmcnt(0)
  v_readfirstlane_b32 s45, v6
  s_branch k2_pg5_l6
k2_pg5_g6:
  s_ff1_i32_b32 s18, s18
  s_bitset1_b32 s46, s18
  s_mul_i32 s17, s18, 2359296
  s_add_u32 s17, s17, s47
  s_mov_b64 exec, s[40:41]
  buffer_load_dword v146, v157, s[20:23], s17 offen sc1
  s_mov_b64 exec, -1
  buffer_load_dwordx4 v[72:75], v1, s[20:23], s17 offen sc1
k2_pg5_l7:
  s_andn2_b32 s18, s45, s46
  s_cbranch_scc1 k2_pg5_g7
  s_sleep 1
  ds_read_b32 v6, v7
  s_waitcnt lgkmcnt(0)
  v_readfirstlane_b32 s45, v6
  s_branch k2_pg5_l7
k2_pg5_g7:
  s_ff1_i32_b32 s18, s18
  s_bitset1_b32 s46, s18
  s_mul_i32 s17, s18, 2359296
  s_add_u32 s17, s17, s47
  s_mov_b64 exec, s[40:41]
  buffer_load_dword v147, v157, s[20:23], s17 offen sc1
  s_mov_b64 exec, -1
  buffer_load_dwordx4 v[76:79], v1, s[20:23], s17 offen sc1
k2_pg5_l8:
  s_andn2_b32 s18, s45, s46
  s_cbranch_scc1 k2_pg5_g8
  s_sleep 1
  ds_read_b32 v6, v7
  s_waitcnt lgkmcnt(0)
  v_readfirstlane_b32 s45, v6
  s_branch k2_pg5_l8
k2_pg5_g8:
  s_ff1_i32_b32 s18, s18
  s_bitset1_b32 s46, s18
  s_mul_i32 s17, s18, 2359296
  s_add_u32 s17, s17, s47
  s_mov_b64 exec, s[40:41]
  buffer_load_dword v148, v157, s[20:23], s17 offen sc1
  s_mov_b64 exec, -1
  buffer_load_dwordx4 v[80:83], v1, s[20:23], s17 offen sc1
k2_pg5_l9:
  s_andn2_b32 s18, s45, s46
  s_cbranch_scc1 k2_pg5_g9
  s_sleep 1
  ds_read_b32 v6, v7
  s_waitcnt lgkmcnt(0)
  v_readfirstlane_b32 s45, v6
  s_branch k2_pg5_l9
k2_pg5_g9:
  s_ff1_i32_b32 s18, s18
  s_bitset1_b32 s46, s18
  s_mul_i32 s17, s18, 2359296
  s_add_u32 s17, s17, s47
  s_mov_b64 exec, s[40:41]
  buffer_load_dword v149, v157, s[20:23], s17 offen sc1
  s_mov_b64 exec, -1
  buffer_load_dwordx4 v[84:87], v1, s[20:23], s17 offen sc1
k2_pg5_l10:
  s_andn2_b32 s18, s45, s46
  s_cbranch_scc1 k2_pg5_g10
  s_sleep 1
  ds_read_b32 v6, v7
  s_waitcnt lgkmcnt(0)
  v_readfirstlane_b32 s45, v6
  s_branch k2_pg5_l10
k2_pg5_g10:
  s_ff1_i32_b32 s18, s18
  s_bitset1_b32 s46, s18
  s_mul_i32 s17, s18, 2359296
  s_add_u32 s17, s17, s47
  s_mov_b64 exec, s[40:41]
  buffer_load_dword v150, v157, s[20:23], s17 offen sc1
  s_mov_b64 exec, -1
  buffer_load_dwordx4 v[88:91], v1, s[20:23], s17 offen sc1
k2_pg5_l11:
  s_andn2_b32 s18, s45, s46
  s_cbranch_scc1 k2_pg5_g11
  s_sleep 1
  ds_read_b32 v6, v7
  s_waitcnt lgkmcnt(0)
  v_readfirstlane_b32 s45, v6
  s_branch k2_pg5_l11
k2_pg5_g11:
  s_ff1_i32_b32 s18, s18
  s_bitset1_b32 s46, s18
  s_mul_i32 s17, s18, 2359296
  s_add_u32 s17, s17, s47
  s_mov_b64 exec, s[40:41]
  buffer_load_dword v151, v157, s[20:23], s17 offen sc1
  s_mov_b64 exec, -1
  buffer_load_dwordx4 v[92:95], v1, s[20:23], s17 offen sc1
k2_pg5_l12:
  s_andn2_b32 s18, s45, s46
  s_cbranch_scc1 k2_pg5_g12
  s_sleep 1
  ds_read_b32 v6, v7
  s_waitcnt lgkmcnt(0)
  v_readfirstlane_b32 s45, v6
  s_branch k2_pg5_l12
k2_pg5_g12:
  s_ff1_i32_b32 s18, s18
  s_bitset1_b32 s46, s18
  s_mul_i32 s17, s18, 2359296
  s_add_u32 s17, s17, s47
  s_mov_b64 exec, s[40:41]
  buffer_load_dword v152, v157, s[20:23], s17 offen sc1
  s_mov_b64 exec, -1
  buffer_load_dwordx4 v[96:99], v1, s[20:23], s17 offen sc1
k2_pg5_l13:
  s_andn2_b32 s18, s45, s46
  s_cbranch_scc1 k2_pg5_g13
  s_sleep 1
  ds_read_b32 v6, v7
  s_waitcnt lgkmcnt(0)
  v_readfirstlane_b32 s45, v6
  s_branch k2_pg5_l13
k2_pg5_g13:
  s_ff1_i32_b32 s18, s18
  s_bitset1_b32 s46, s18
  s_mul_i32 s17, s18, 2359296
  s_add_u32 s17, s17, s47
  s_mov_b64 exec, s[40:41]
  buffer_load_dword v153, v157, s[20:23], s17 offen sc1
  s_mov_b64 exec, -1
  buffer_load_dwordx4 v[100:103], v1, s[20:23], s17 offen sc1
k2_pg5_l14:
  s_andn2_b32 s18, s45, s46
  s_cbranch_scc1 k2_pg5_g14
  s_sleep 1
  ds_read_b32 v6, v7
  s_waitcnt lgkmcnt(0)
  v_readfirstlane_b32 s45, v6
  s_branch k2_pg5_l14
k2_pg5_g14:
  s_ff1_i32_b32 s18, s18
  s_bitset1_b32 s46, s18
  s_mul_i32 s17, s18, 2359296
  s_add_u32 s17, s17, s47
  s_mov_b64 exec, s[40:41]
  buffer_load_dword v154, v157, s[20:23], s17 offen sc1
  s_mov_b64 exec, -1
  buffer_load_dwordx4 v[104:107], v1, s[20:23], s17 offen sc1
k2_pg5_l15:
  s_andn2_b32 s18, s45, s46
  s_cbranch_scc1 k2_pg5_g15
  s_sleep 1
  ds_read_b32 v6, v7
  s_waitcnt lgkmcnt(0)
  v_readfirstlane_b32 s45, v6
  s_branch k2_pg5_l15
k2_pg5_g15:
  s_ff1_i32_b32 s18, s18
  s_bitset1_b32 s46, s18
  s_mul_i32 s17, s18, 2359296
  s_add_u32 s17, s17, s47
  s_mov_b64 exec, s[40:41]
  buffer_load_dword v155, v157, s[20:23], s17 offen sc1
  s_mov_b64 exec, -1
  buffer_load_dwordx4 v[108:111], v1, s[20:23], s17 offen sc1
  s_waitcnt vmcnt(15)
  v_lshlrev_b32 v112, 16, v48
  v_and_b32 v113, 0xffff0000, v48
  v_lshlrev_b32 v114, 16, v49
  v_and_b32 v115, 0xffff0000, v49
  v_lshlrev_b32 v116, 16, v50
  v_and_b32 v117, 0xffff0000, v50
  v_lshlrev_b32 v118, 16, v51
  v_and_b32 v119, 0xffff0000, v51
  v_lshlrev_b32 v120, 16, v140
  v_and_b32 v121, 0xffff0000, v140
  s_waitcnt vmcnt(14)
  v_lshlrev_b32 v124, 16, v52
  v_and_b32 v125, 0xffff0000, v52
  v_lshlrev_b32 v126, 16, v53
  v_and_b32 v127, 0xffff0000, v53
  v_lshlrev_b32 v128, 16, v54
  v_and_b32 v129, 0xffff0000, v54
  v_lshlrev_b32 v130, 16, v55
  v_and_b32 v131, 0xffff0000, v55
  v_lshlrev_b32 v132, 16, v141
  v_and_b32 v133, 0xffff0000, v141
  v_add_f32 v112, v112, v124
  v_add_f32 v113, v113, v125
  v_add_f32 v114, v114, v126
  v_add_f32 v115, v115, v127
  v_add_f32 v116, v116, v128
  v_add_f32 v117, v117, v129
  v_add_f32 v118, v118, v130
  v_add_f32 v119, v119, v131
  v_add_f32 v120, v120, v132
  v_add_f32 v121, v121, v133
  s_waitcnt vmcnt(13)
  v_lshlrev_b32 v124, 16, v56
  v_and_b32 v125, 0xffff0000, v56
  v_lshlrev_b32 v126, 16, v57
  v_and_b32 v127, 0xffff0000, v57
  v_lshlrev_b32 v128, 16, v58
  v_and_b32 v129, 0xffff0000, v58
  v_lshlrev_b32 v130, 16, v59
  v_and_b32 v131, 0xffff0000, v59
  v_lshlrev_b32 v132, 16, v142
  v_and_b32 v133, 0xffff0000, v142
  v_add_f32 v112, v112, v124
  v_add_f32 v113, v113, v125
  v_add_f32 v114, v114, v126
  v_add_f32 v115, v115, v127
  v_add_f32 v116, v116, v128
  v_add_f32 v117, v117, v129
  v_add_f32 v118, v118, v130
  v_add_f32 v119, v119, v131
  v_add_f32 v120, v120, v132
  v_add_f32 v121, v121, v133
  s_waitcnt vmcnt(12)
  v_lshlrev_b32 v124, 16, v60
  v_and_b32 v125, 0xffff0000, v60
  v_lshlrev_b32 v126, 16, v61
  v_and_b32 v127, 0xffff0000, v61
  v_lshlrev_b32 v128, 16, v62
  v_and_b32 v129, 0xffff0000, v62
  v_lshlrev_b32 v130, 16, v63
  v_and_b32 v131, 0xffff0000, v63
  v_lshlrev_b32 v132, 16, v143
  v_and_b32 v133, 0xffff0000, v143
  v_add_f32 v112, v112, v124
  v_add_f32 v113, v113, v125
  v_add_f32 v114, v114, v126
  v_add_f32 v115, v115, v127
  v_add_f32 v116, v116, v128
  v_add_f32 v117, v117, v129
  v_add_f32 v118, v118, v130
  v_add_f32 v119, v119, v131
  v_add_f32 v120, v120, v132
  v_add_f32 v121, v121, v133
  s_waitcnt vmcnt(11)
  v_lshlrev_b32 v124, 16, v64
  v_and_b32 v125, 0xffff0000, v64
  v_lshlrev_b32 v126, 16, v65
  v_and_b32 v127, 0xffff0000, v65
  v_lshlrev_b32 v128, 16, v66
  v_and_b32 v129, 0xffff0000, v66
  v_lshlrev_b32 v130, 16, v67
  v_and_b32 v131, 0xffff0000, v67
  v_lshlrev_b32 v132, 16, v144
  v_and_b32 v133, 0xffff0000, v144
  v_add_f32 v112, v112, v124
  v_add_f32 v113, v113, v125
  v_add_f32 v114, v114, v126
  v_add_f32 v115, v115, v127
  v_add_f32 v116, v116, v128
  v_add_f32 v117, v117, v129
  v_add_f32 v118, v118, v130
  v_add_f32 v119, v119, v131
  v_add_f32 v120, v120, v132
  v_add_f32 v121, v121, v133
  s_waitcnt vmcnt(10)
  v_lshlrev_b32 v124, 16, v68
  v_and_b32 v125, 0xffff0000, v68
  v_lshlrev_b32 v126, 16, v69
  v_and_b32 v127, 0xffff0000, v69
  v_lshlrev_b32 v128, 16, v70
  v_and_b32 v129, 0xffff0000, v70
  v_lshlrev_b32 v130, 16, v71
  v_and_b32 v131, 0xffff0000, v71
  v_lshlrev_b32 v132, 16, v145
  v_and_b32 v133, 0xffff0000, v145
  v_add_f32 v112, v112, v124
  v_add_f32 v113, v113, v125
  v_add_f32 v114, v114, v126
  v_add_f32 v115, v115, v127
  v_add_f32 v116, v116, v128
  v_add_f32 v117, v117, v129
  v_add_f32 v118, v118, v130
  v_add_f32 v119, v119, v131
  v_add_f32 v120, v120, v132
  v_add_f32 v121, v121, v133
  s_waitcnt vmcnt(9)
  v_lshlrev_b32 v124, 16, v72
  v_and_b32 v125, 0xffff0000, v72
  v_lshlrev_b32 v126, 16, v73
  v_and_b32 v127, 0xffff0000, v73
  v_lshlrev_b32 v128, 16, v74
  v_and_b32 v129, 0xffff0000, v74
  v_lshlrev_b32 v130, 16, v75
  v_and_b32 v131, 0xffff0000, v75
  v_lshlrev_b32 v132, 16, v146
  v_and_b32 v133, 0xffff0000, v146
  v_add_f32 v112, v112, v124
  v_add_f32 v113, v113, v125
  v_add_f32 v114, v114, v126
  v_add_f32 v115, v115, v127
  v_add_f32 v116, v116, v128
  v_add_f32 v117, v117, v129
  v_add_f32 v118, v118, v130
  v_add_f32 v119, v119, v131
  v_add_f32 v120, v120, v132
  v_add_f32 v121, v121, v133
  s_waitcnt vmcnt(8)
  v_lshlrev_b32 v124, 16, v76
  v_and_b32 v125, 0xffff0000, v76
  v_lshlrev_b32 v126, 16, v77
  v_and_b32 v127, 0xffff0000, v77
  v_lshlrev_b32 v128, 16, v78
  v_and_b32 v129, 0xffff0000, v78
  v_lshlrev_b32 v130, 16, v79
  v_and_b32 v131, 0xffff0000, v79
  v_lshlrev_b32 v132, 16, v147
  v_and_b32 v133, 0xffff0000, v147
  v_add_f32 v112, v112, v124
  v_add_f32 v113, v113, v125
  v_add_f32 v114, v114, v126
  v_add_f32 v115, v115, v127
  v_add_f32 v116, v116, v128
  v_add_f32 v117, v117, v129
  v_add_f32 v118, v118, v130
  v_add_f32 v119, v119, v131
  v_add_f32 v120, v120, v132
  v_add_f32 v121, v121, v133
  s_waitcnt vmcnt(7)
  v_lshlrev_b32 v124, 16, v80
  v_and_b32 v125, 0xffff0000, v80
  v_lshlrev_b32 v126, 16, v81
  v_and_b32 v127, 0xffff0000, v81
  v_lshlrev_b32 v128, 16, v82
  v_and_b32 v129, 0xffff0000, v82
  v_lshlrev_b32 v130, 16, v83
  v_and_b32 v131, 0xffff0000, v83
  v_lshlrev_b32 v132, 16, v148
  v_and_b32 v133, 0xffff0000, v148
  v_add_f32 v112, v112, v124
  v_add_f32 v113, v113, v125
  v_add_f32 v114, v114, v126
  v_add_f32 v115, v115, v127
  v_add_f32 v116, v116, v128
  v_add_f32 v117, v117, v129
  v_add_f32 v118, v118, v130
  v_add_f32 v119, v119, v131
  v_add_f32 v120, v120, v132
  v_add_f32 v121, v121, v133
  s_waitcnt vmcnt(6)
  v_lshlrev_b32 v124, 16, v84
  v_and_b32 v125, 0xffff0000, v84
  v_lshlrev_b32 v126, 16, v85
  v_and_b32 v127, 0xffff0000, v85
  v_lshlrev_b32 v128, 16, v86
  v_and_b32 v129, 0xffff0000, v86
  v_lshlrev_b32 v130, 16, v87
  v_and_b32 v131, 0xffff0000, v87
  v_lshlrev_b32 v132, 16, v149
  v_and_b32 v133, 0xffff0000, v149
  v_add_f32 v112, v112, v124
  v_add_f32 v113, v113, v125
  v_add_f32 v114, v114, v126
  v_add_f32 v115, v115, v127
  v_add_f32 v116, v116, v128
  v_add_f32 v117, v117, v129
  v_add_f32 v118, v118, v130
  v_add_f32 v119, v119, v131
  v_add_f32 v120, v120, v132
  v_add_f32 v121, v121, v133
  s_waitcnt vmcnt(5)
  v_lshlrev_b32 v124, 16, v88
  v_and_b32 v125, 0xffff0000, v88
  v_lshlrev_b32 v126, 16, v89
  v_and_b32 v127, 0xffff0000, v89
  v_lshlrev_b32 v128, 16, v90
  v_and_b32 v129, 0xffff0000, v90
  v_lshlrev_b32 v130, 16, v91
  v_and_b32 v131, 0xffff0000, v91
  v_lshlrev_b32 v132, 16, v150
  v_and_b32 v133, 0xffff0000, v150
  v_add_f32 v112, v112, v124
  v_add_f32 v113, v113, v125
  v_add_f32 v114, v114, v126
  v_add_f32 v115, v115, v127
  v_add_f32 v116, v116, v128
  v_add_f32 v117, v117, v129
  v_add_f32 v118, v118, v130
  v_add_f32 v119, v119, v131
  v_add_f32 v120, v120, v132
  v_add_f32 v121, v121, v133
  s_waitcnt vmcnt(4)
  v_lshlrev_b32 v124, 16, v92
  v_and_b32 v125, 0xffff0000, v92
  v_lshlrev_b32 v126, 16, v93
  v_and_b32 v127, 0xffff0000, v93
  v_lshlrev_b32 v128, 16, v94
  v_and_b32 v129, 0xffff0000, v94
  v_lshlrev_b32 v130, 16, v95
  v_and_b32 v131, 0xffff0000, v95
  v_lshlrev_b32 v132, 16, v151
  v_and_b32 v133, 0xffff0000, v151
  v_add_f32 v112, v112, v124
  v_add_f32 v113, v113, v125
  v_add_f32 v114, v114, v126
  v_add_f32 v115, v115, v127
  v_add_f32 v116, v116, v128
  v_add_f32 v117, v117, v129
  v_add_f32 v118, v118, v130
  v_add_f32 v119, v119, v131
  v_add_f32 v120, v120, v132
  v_add_f32 v121, v121, v133
  s_waitcnt vmcnt(3)
  v_lshlrev_b32 v124, 16, v96
  v_and_b32 v125, 0xffff0000, v96
  v_lshlrev_b32 v126, 16, v97
  v_and_b32 v127, 0xffff0000, v97
  v_lshlrev_b32 v128, 16, v98
  v_and_b32 v129, 0xffff0000, v98
  v_lshlrev_b32 v130, 16, v99
  v_and_b32 v131, 0xffff0000, v99
  v_lshlrev_b32 v132, 16, v152
  v_and_b32 v133, 0xffff0000, v152
  v_add_f32 v112, v112, v124
  v_add_f32 v113, v113, v125
  v_add_f32 v114, v114, v126
  v_add_f32 v115, v115, v127
  v_add_f32 v116, v116, v128
  v_add_f32 v117, v117, v129
  v_add_f32 v118, v118, v130
  v_add_f32 v119, v119, v131
  v_add_f32 v120, v120, v132
  v_add_f32 v121, v121, v133
  s_waitcnt vmcnt(2)
  v_lshlrev_b32 v124, 16, v100
  v_and_b32 v125, 0xffff0000, v100
  v_lshlrev_b32 v126, 16, v101
  v_and_b32 v127, 0xffff0000, v101
  v_lshlrev_b32 v128, 16, v102
  v_and_b32 v129, 0xffff0000, v102
  v_lshlrev_b32 v130, 16, v103
  v_and_b32 v131, 0xffff0000, v103
  v_lshlrev_b32 v132, 16, v153
  v_and_b32 v133, 0xffff0000, v153
  v_add_f32 v112, v112, v124
  v_add_f32 v113, v113, v125
  v_add_f32 v114, v114, v126
  v_add_f32 v115, v115, v127
  v_add_f32 v116, v116, v128
  v_add_f32 v117, v117, v129
  v_add_f32 v118, v118, v130
  v_add_f32 v119, v119, v131
  v_add_f32 v120, v120, v132
  v_add_f32 v121, v121, v133
  s_waitcnt vmcnt(1)
  v_lshlrev_b32 v124, 16, v104
  v_and_b32 v125, 0xffff0000, v104
  v_lshlrev_b32 v126, 16, v105
  v_and_b32 v127, 0xffff0000, v105
  v_lshlrev_b32 v128, 16, v106
  v_and_b32 v129, 0xffff0000, v106
  v_lshlrev_b32 v130, 16, v107
  v_and_b32 v131, 0xffff0000, v107
  v_lshlrev_b32 v132, 16, v154
  v_and_b32 v133, 0xffff0000, v154
  v_add_f32 v112, v112, v124
  v_add_f32 v113, v113, v125
  v_add_f32 v114, v114, v126
  v_add_f32 v115, v115, v127
  v_add_f32 v116, v116, v128
  v_add_f32 v117, v117, v129
  v_add_f32 v118, v118, v130
  v_add_f32 v119, v119, v131
  v_add_f32 v120, v120, v132
  v_add_f32 v121, v121, v133
  s_waitcnt vmcnt(0)
  v_lshlrev_b32 v124, 16, v108
  v_and_b32 v125, 0xffff0000, v108
  v_lshlrev_b32 v126, 16, v109
  v_and_b32 v127, 0xffff0000, v109
  v_lshlrev_b32 v128, 16, v110
  v_and_b32 v129, 0xffff0000, v110
  v_lshlrev_b32 v130, 16, v111
  v_and_b32 v131, 0xffff0000, v111
  v_lshlrev_b32 v132, 16, v155
  v_and_b32 v133, 0xffff0000, v155
  v_add_f32 v112, v112, v124
  v_add_f32 v113, v113, v125
  v_add_f32 v114, v114, v126
  v_add_f32 v115, v115, v127
  v_add_f32 v116, v116, v128
  v_add_f32 v117, v117, v129
  v_add_f32 v118, v118, v130
  v_add_f32 v119, v119, v131
  v_add_f32 v120, v120, v132
  v_add_f32 v121, v121, v133
  v_lshlrev_b32 v124, 16, v8
  v_and_b32 v125, 0xffff0000, v8
  v_lshlrev_b32 v126, 16, v9
  v_and_b32 v127, 0xffff0000, v9
  v_lshlrev_b32 v128, 16, v10
  v_and_b32 v129, 0xffff0000, v10
  v_lshlrev_b32 v130, 16, v11
  v_and_b32 v131, 0xffff0000, v11
  v_lshlrev_b32 v132, 16, v12
  v_and_b32 v133, 0xffff0000, v12
  v_fma_f32 v112, v112, v16, v124
  v_fma_f32 v113, v113, v17, v125
  v_fma_f32 v114, v114, v18, v126
  v_fma_f32 v115, v115, v19, v127
  v_fma_f32 v116, v116, v20, v128
  v_fma_f32 v117, v117, v21, v129
  v_fma_f32 v118, v118, v22, v130
  v_fma_f32 v119, v119, v23, v131
  v_fma_f32 v120, v120, v40, v132
  v_fma_f32 v121, v121, v41, v133
  v_cvt_pk_bf16_f32 v8, v112, v113
  v_cvt_pk_bf16_f32 v9, v114, v115
  v_cvt_pk_bf16_f32 v10, v116, v117
  v_cvt_pk_bf16_f32 v11, v118, v119
  v_cvt_pk_bf16_f32 v12, v120, v121
  buffer_store_dwordx4 v[8:11], v4, s[8:11], s16 offen
  s_mov_b64 exec, s[40:41]
  buffer_store_dword v12, v158, s[8:11], s16 offen
  s_mov_b64 exec, -1
  s_endpgm
k2_att_sw:
  s_cmp_eq_u32 s27, 4
  s_cselect_b32 s38, 131072, 0
  s_sub_u32 s43, s43, s38
  s_cmp_eq_u32 s27, 5
  s_cbranch_scc0 k2_att_swb
  v_mov_b32 v4, v6
  v_mov_b32 v5, v6
  s_mov_b64 s[8:9], s[16:17]
  s_mov_b64 s[10:11], s[18:19]
  s_mov_b64 s[12:13], s[16:17]
  s_mov_b64 s[14:15], s[18:19]
  s_mov_b32 s42, s36
  s_add_u32 s43, s36, 147456
  s_mov_b32 s46, 73728
  s_movk_i32 s47, 128
  s_branch k2_att_swb
k2_rare_3:
  s_nop 11
  v_mov_b32 v9, v8
  s_nop 1
  v_permlane32_swap_b32 v8, v9
  v_max3_f32 v8, v8, v9, 0
  v_sub_f32 v9, 0, v8
  v_exp_f32 v9, v9
  v_sub_f32 v128, v128, v8
  v_sub_f32 v144, v144, v8
  v_sub_f32 v129, v129, v8
  v_sub_f32 v145, v145, v8
  v_sub_f32 v130, v130, v8
  v_sub_f32 v146, v146, v8
  v_sub_f32 v131, v131, v8
  v_sub_f32 v147, v147, v8
  v_sub_f32 v132, v132, v8
  v_sub_f32 v148, v148, v8
  v_sub_f32 v133, v133, v8
  v_sub_f32 v149, v149, v8
  v_sub_f32 v134, v134, v8
  v_sub_f32 v150, v150, v8
  v_sub_f32 v135, v135, v8
  v_sub_f32 v151, v151, v8
  v_sub_f32 v136, v136, v8
  v_sub_f32 v152, v152, v8
  v_sub_f32 v137, v137, v8
  v_sub_f32 v153, v153, v8
  v_sub_f32 v138, v138, v8
  v_sub_f32 v154, v154, v8
  v_sub_f32 v139, v139, v8
  v_sub_f32 v155, v155, v8
  v_sub_f32 v140, v140, v8
  v_sub_f32 v156, v156, v8
  v_sub_f32 v141, v141, v8
  v_sub_f32 v157, v157, v8
  v_sub_f32 v142, v142, v8
  v_sub_f32 v158, v158, v8
  v_sub_f32 v143, v143, v8
  v_sub_f32 v159, v159, v8
  v_mul_f32 v48, v9, v48
  v_mul_f32 v49, v9, v49
  v_mul_f32 v50, v9, v50
  v_mul_f32 v51, v9, v51
  v_mul_f32 v52, v9, v52
  v_mul_f32 v53, v9, v53
  v_mul_f32 v54, v9, v54
  v_mul_f32 v55, v9, v55
  v_mul_f32 v56, v9, v56
  v_mul_f32 v57, v9, v57
  v_mul_f32 v58, v9, v58
  v_mul_f32 v59, v9, v59
  v_mul_f32 v60, v9, v60
  v_mul_f32 v61, v9, v61
  v_mul_f32 v62, v9, v62
  v_mul_f32 v63, v9, v63
  v_mul_f32 v64, v9, v64
  v_mul_f32 v65, v9, v65
  v_mul_f32 v66, v9, v66
  v_mul_f32 v67, v9, v67
  v_mul_f32 v68, v9, v68
  v_mul_f32 v69, v9, v69
  v_mul_f32 v70, v9, v70
  v_mul_f32 v71, v9, v71
  v_mul_f32 v72, v9, v72
  v_mul_f32 v73, v9, v73
  v_mul_f32 v74, v9, v74
  v_mul_f32 v75, v9, v75
  v_mul_f32 v76, v9, v76
  v_mul_f32 v77, v9, v77
  v_mul_f32 v78, v9, v78
  v_mul_f32 v79, v9, v79
  v_mul_f32 v80, v9, v80
  v_mul_f32 v81, v9, v81
  v_mul_f32 v82, v9, v82
  v_mul_f32 v83, v9, v83
  v_mul_f32 v84, v9, v84
  v_mul_f32 v85, v9, v85
  v_mul_f32 v86, v9, v86
  v_mul_f32 v87, v9, v87
  v_mul_f32 v88, v9, v88
  v_mul_f32 v89, v9, v89
  v_mul_f32 v90, v9, v90
  v_mul_f32 v91, v9, v91
  v_mul_f32 v92, v9, v92
  v_mul_f32 v93, v9, v93
  v_mul_f32 v94, v9, v94
  v_mul_f32 v95, v9, v95
  v_mul_f32 v96, v9, v96
  v_mul_f32 v97, v9, v97
  v_mul_f32 v98, v9, v98
  v_mul_f32 v99, v9, v99
  v_mul_f32 v100, v9, v100
  v_mul_f32 v101, v9, v101
  v_mul_f32 v102, v9, v102
  v_mul_f32 v103, v9, v103
  v_mul_f32 v104, v9, v104
  v_mul_f32 v105, v9, v105
  v_mul_f32 v106, v9, v106
  v_mul_f32 v107, v9, v107
  v_mul_f32 v108, v9, v108
  v_mul_f32 v109, v9, v109
  v_mul_f32 v110, v9, v110
  v_mul_f32 v111, v9, v111
  v_mul_f32 v7, v9, v7
  s_nop 1
  s_branch k2_back_4
k2_rare_5:
  s_nop 11
  v_mov_b32 v9, v8
  s_nop 1
  v_permlane32_swap_b32 v8, v9
  v_max3_f32 v8, v8, v9, 0
  v_sub_f32 v9, 0, v8
  v_exp_f32 v9, v9
  v_sub_f32 v112, v112, v8
  v_sub_f32 v144, v144, v8
  v_sub_f32 v113, v113, v8
  v_sub_f32 v145, v145, v8
  v_sub_f32 v114, v114, v8
  v_sub_f32 v146, v146, v8
  v_sub_f32 v115, v115, v8
  v_sub_f32 v147, v147, v8
  v_sub_f32 v116, v116, v8
  v_sub_f32 v148, v148, v8
  v_sub_f32 v117, v117, v8
  v_sub_f32 v149, v149, v8
  v_sub_f32 v118, v118, v8
  v_sub_f32 v150, v150, v8
  v_sub_f32 v119, v119, v8
  v_sub_f32 v151, v151, v8
  v_sub_f32 v120, v120, v8
  v_sub_f32 v152, v152, v8
  v_sub_f32 v121, v121, v8
  v_sub_f32 v153, v153, v8
  v_sub_f32 v122, v122, v8
  v_sub_f32 v154, v154, v8
  v_sub_f32 v123, v123, v8
  v_sub_f32 v155, v155, v8
  v_sub_f32 v124, v124, v8
  v_sub_f32 v156, v156, v8
  v_sub_f32 v125, v125, v8
  v_sub_f32 v157, v157, v8
  v_sub_f32 v126, v126, v8
  v_sub_f32 v158, v158, v8
  v_sub_f32 v127, v127, v8
  v_sub_f32 v159, v159, v8
  v_mul_f32 v48, v9, v48
  v_mul_f32 v49, v9, v49
  v_mul_f32 v50, v9, v50
  v_mul_f32 v51, v9, v51
  v_mul_f32 v52, v9, v52
  v_mul_f32 v53, v9, v53
  v_mul_f32 v54, v9, v54
  v_mul_f32 v55, v9, v55
  v_mul_f32 v56, v9, v56
  v_mul_f32 v57, v9, v57
  v_mul_f32 v58, v9, v58
  v_mul_f32 v59, v9, v59
  v_mul_f32 v60, v9, v60
  v_mul_f32 v61, v9, v61
  v_mul_f32 v62, v9, v62
  v_mul_f32 v63, v9, v63
  v_mul_f32 v64, v9, v64
  v_mul_f32 v65, v9, v65
  v_mul_f32 v66, v9, v66
  v_mul_f32 v67, v9, v67
  v_mul_f32 v68, v9, v68
  v_mul_f32 v69, v9, v69
  v_mul_f32 v70, v9, v70
  v_mul_f32 v71, v9, v71
  v_mul_f32 v72, v9, v72
  v_mul_f32 v73, v9, v73
  v_mul_f32 v74, v9, v74
  v_mul_f32 v75, v9, v75
  v_mul_f32 v76, v9, v76
  v_mul_f32 v77, v9, v77
  v_mul_f32 v78, v9, v78
  v_mul_f32 v79, v9, v79
  v_mul_f32 v80, v9, v80
  v_mul_f32 v81, v9, v81
  v_mul_f32 v82, v9, v82
  v_mul_f32 v83, v9, v83
  v_mul_f32 v84, v9, v84
  v_mul_f32 v85, v9, v85
  v_mul_f32 v86, v9, v86
  v_mul_f32 v87, v9, v87
  v_mul_f32 v88, v9, v88
  v_mul_f32 v89, v9, v89
  v_mul_f32 v90, v9, v90
  v_mul_f32 v91, v9, v91
  v_mul_f32 v92, v9, v92
  v_mul_f32 v93, v9, v93
  v_mul_f32 v94, v9, v94
  v_mul_f32 v95, v9, v95
  v_mul_f32 v96, v9, v96
  v_mul_f32 v97, v9, v97
  v_mul_f32 v98, v9, v98
  v_mul_f32 v99, v9, v99
  v_mul_f32 v100, v9, v100
  v_mul_f32 v101, v9, v101
  v_mul_f32 v102, v9, v102
  v_mul_f32 v103, v9, v103
  v_mul_f32 v104, v9, v104
  v_mul_f32 v105, v9, v105
  v_mul_f32 v106, v9, v106
  v_mul_f32 v107, v9, v107
  v_mul_f32 v108, v9, v108
  v_mul_f32 v109, v9, v109
  v_mul_f32 v110, v9, v110
  v_mul_f32 v111, v9, v111
  v_mul_f32 v7, v9, v7
  s_nop 1
  s_branch k2_back_6
k2_rare_7:
  s_nop 11
  v_mov_b32 v9, v8
  s_nop 1
  v_permlane32_swap_b32 v8, v9
  v_max3_f32 v8, v8, v9, 0
  v_sub_f32 v9, 0, v8
  v_exp_f32 v9, v9
  v_sub_f32 v128, v128, v8
  v_sub_f32 v144, v144, v8
  v_sub_f32 v129, v129, v8
  v_sub_f32 v145, v145, v8
  v_sub_f32 v130, v130, v8
  v_sub_f32 v146, v146, v8
  v_sub_f32 v131, v131, v8
  v_sub_f32 v147, v147, v8
  v_sub_f32 v132, v132, v8
  v_sub_f32 v148, v148, v8
  v_sub_f32 v133, v133, v8
  v_sub_f32 v149, v149, v8
  v_sub_f32 v134, v134, v8
  v_sub_f32 v150, v150, v8
  v_sub_f32 v135, v135, v8
  v_sub_f32 v151, v151, v8
  v_sub_f32 v136, v136, v8
  v_sub_f32 v152, v152, v8
  v_sub_f32 v137, v137, v8
  v_sub_f32 v153, v153, v8
  v_sub_f32 v138, v138, v8
  v_sub_f32 v154, v154, v8
  v_sub_f32 v139, v139, v8
  v_sub_f32 v155, v155, v8
  v_sub_f32 v140, v140, v8
  v_sub_f32 v156, v156, v8
  v_sub_f32 v141, v141, v8
  v_sub_f32 v157, v157, v8
  v_sub_f32 v142, v142, v8
  v_sub_f32 v158, v158, v8
  v_sub_f32 v143, v143, v8
  v_sub_f32 v159, v159, v8
  v_mul_f32 v48, v9, v48
  v_mul_f32 v49, v9, v49
  v_mul_f32 v50, v9, v50
  v_mul_f32 v51, v9, v51
  v_mul_f32 v52, v9, v52
  v_mul_f32 v53, v9, v53
  v_mul_f32 v54, v9, v54
  v_mul_f32 v55, v9, v55
  v_mul_f32 v56, v9, v56
  v_mul_f32 v57, v9, v57
  v_mul_f32 v58, v9, v58
  v_mul_f32 v59, v9, v59
  v_mul_f32 v60, v9, v60
  v_mul_f32 v61, v9, v61
  v_mul_f32 v62, v9, v62
  v_mul_f32 v63, v9, v63
  v_mul_f32 v64, v9, v64
  v_mul_f32 v65, v9, v65
  v_mul_f32 v66, v9, v66
  v_mul_f32 v67, v9, v67
  v_mul_f32 v68, v9, v68
  v_mul_f32 v69, v9, v69
  v_mul_f32 v70, v9, v70
  v_mul_f32 v71, v9, v71
  v_mul_f32 v72, v9, v72
  v_mul_f32 v73, v9, v73
  v_mul_f32 v74, v9, v74
  v_mul_f32 v75, v9, v75
  v_mul_f32 v76, v9, v76
  v_mul_f32 v77, v9, v77
  v_mul_f32 v78, v9, v78
  v_mul_f32 v79, v9, v79
  v_mul_f32 v80, v9, v80
  v_mul_f32 v81, v9, v81
  v_mul_f32 v82, v9, v82
  v_mul_f32 v83, v9, v83
  v_mul_f32 v84, v9, v84
  v_mul_f32 v85, v9, v85
  v_mul_f32 v86, v9, v86
  v_mul_f32 v87, v9, v87
  v_mul_f32 v88, v9, v88
  v_mul_f32 v89, v9, v89
  v_mul_f32 v90, v9, v90
  v_mul_f32 v91, v9, v91
  v_mul_f32 v92, v9, v92
  v_mul_f32 v93, v9, v93
  v_mul_f32 v94, v9, v94
  v_mul_f32 v95, v9, v95
  v_mul_f32 v96, v9, v96
  v_mul_f32 v97, v9, v97
  v_mul_f32 v98, v9, v98
  v_mul_f32 v99, v9, v99
  v_mul_f32 v100, v9, v100
  v_mul_f32 v101, v9, v101
  v_mul_f32 v102, v9, v102
  v_mul_f32 v103, v9, v103
  v_mul_f32 v104, v9, v104
  v_mul_f32 v105, v9, v105
  v_mul_f32 v106, v9, v106
  v_mul_f32 v107, v9, v107
  v_mul_f32 v108, v9, v108
  v_mul_f32 v109, v9, v109
  v_mul_f32 v110, v9, v110
  v_mul_f32 v111, v9, v111
  v_mul_f32 v7, v9, v7
  s_nop 1
  s_branch k2_back_8
.section .rodata,"a"
.p2align 6
.amdhsa_kernel k1_kernel
  .amdhsa_next_free_vgpr 72
  .amdhsa_next_free_sgpr 102
  .amdhsa_accum_offset 72
  .amdhsa_group_segment_fixed_size 0
  .amdhsa_kernarg_size 112
  .amdhsa_user_sgpr_count 2
  .amdhsa_user_sgpr_kernarg_segment_ptr 1
  .amdhsa_system_sgpr_workgroup_id_x 1
.end_amdhsa_kernel
.p2align 6
.amdhsa_kernel k2_kernel
  .amdhsa_next_free_vgpr 256
  .amdhsa_next_free_sgpr 102
  .amdhsa_accum_offset 256
  .amdhsa_group_segment_fixed_size 0
  .amdhsa_kernarg_size 112
  .amdhsa_user_sgpr_count 2
  .amdhsa_user_sgpr_kernarg_segment_ptr 1
  .amdhsa_system_sgpr_workgroup_id_x 1
.end_amdhsa_kernel
```
